```python
import torch

def _softmax(x, axis=-1):
    return torch.softmax(x, dim=axis)
def _gelu(x):
    return torch.nn.functional.gelu(x, approximate="tanh")
def _silu(x):
    return torch.nn.functional.silu(x)
def _sigmoid(x):
    return torch.sigmoid(x)
def _layernorm(x, axis=-1, eps=1e-5):
    m = x.mean(dim=axis, keepdim=True)
    v = x.var(dim=axis, keepdim=True, unbiased=False)
    return (x - m) / torch.sqrt(v + eps)
def _scatter_add(tgt, idx, src, axis=0):
    return tgt.clone().index_add_(axis, idx, src)
def _segment_sum(src, seg, n):
    out = torch.zeros((n,) + src.shape[1:], dtype=src.dtype)
    return out.index_add_(0, seg, src)
def _pad(x, pw):
    flat = tuple(v for pair in reversed(pw) for v in pair)
    return torch.nn.functional.pad(x, flat)

kernel_name = 'gated_mix__ssm_conv_s4__dense_activation_silu__prompt'

def setup_inputs():

    _w = (lambda a: (lambda t: t.to(torch.bfloat16) if t.is_floating_point() else t)(torch.as_tensor(a)))
    def _A_setup():
        B, L, D, N = 1, 2048, 640, 192
        A_re = -(lambda _x: torch.exp(torch.as_tensor(_x)))((lambda *s: torch.randn(*s, dtype=torch.bfloat16) * 6.4)(D, N))
        A_im = torch.pi * (lambda *s: torch.randn(*s, dtype=torch.bfloat16) * 0.05)(D, N)
        B_re = (lambda *s: torch.randn(*s, dtype=torch.bfloat16) * 0.2)(D, N)
        B_im = (lambda *s: torch.randn(*s, dtype=torch.bfloat16) * 0.2)(D, N)
        C_re = (lambda *s: torch.randn(*s, dtype=torch.bfloat16) * 0.2)(D, N)
        C_im = (lambda *s: torch.randn(*s, dtype=torch.bfloat16) * 0.2)(D, N)
        log_dt = (lambda *s: torch.randn(*s, dtype=torch.bfloat16) * 0.05)(D) * 0.5 - 4.0
        Dskip = (lambda *s: torch.randn(*s, dtype=torch.bfloat16) * 0.05)(D)
        return {
            "u": _w((lambda *s: torch.randn(*s, dtype=torch.bfloat16) * 0.05)(B, L, D)),
            "A_re": _w(A_re),
            "A_im": _w(A_im),
            "B_re": _w(B_re),
            "B_im": _w(B_im),
            "C_re": _w(C_re),
            "C_im": _w(C_im),
            "log_dt": _w(log_dt),
            "Dskip": _w(Dskip),
        }
    _A_in = _A_setup()

    def _B_setup():
        B, S, D, F = 1, 2048, 640, 1536
        return {
            "x": _w((lambda *s: torch.randn(*s, dtype=torch.bfloat16) * 0.05)(B, S, D)),
            "w1": _w((lambda *s: torch.randn(*s, dtype=torch.bfloat16) * 6.4)(D, F) * (D ** -0.5)),
            "w2": _w((lambda *s: torch.randn(*s, dtype=torch.bfloat16) * 0.2)(F, D) * (F ** -0.5)),
        }
    _B_in = _B_setup()

    return {
        "A_u": _A_in["u"],
        "A_A_re": _A_in["A_re"],
        "A_A_im": _A_in["A_im"],
        "A_B_re": _A_in["B_re"],
        "A_B_im": _A_in["B_im"],
        "A_C_re": _A_in["C_re"],
        "A_C_im": _A_in["C_im"],
        "A_log_dt": _A_in["log_dt"],
        "A_Dskip": _A_in["Dskip"],
        "B_x": _B_in["x"],
        "B_w1": _B_in["w1"],
        "B_w2": _B_in["w2"],
        "gate_w": _w((lambda *s: torch.randn(*s, dtype=torch.bfloat16) * 0.05)(640) * 16.0),
    }

def reference(A_u, A_A_re, A_A_im, A_B_re, A_B_im, A_C_re, A_C_im, A_log_dt, A_Dskip, B_x, B_w1, B_w2, gate_w):
    def _A_ref(u, A_re, A_im, B_re, B_im, C_re, C_im, log_dt, Dskip):
        Bsz, L, D = u.shape
        dt = torch.exp(log_dt)[:, None]
        A = A_re + 1j * A_im
        Bc = B_re + 1j * B_im
        Cc = C_re + 1j * C_im
        logdA = dt * A
        dB = dt * Bc
        l = (lambda x, dt: x.to(dt))(torch.arange(L), A_re.dtype)
        P = torch.exp(logdA[:, :, None] * l[None, None, :])
        K = torch.einsum("dn,dnl,dn->dl", Cc, P, dB).real
        L2 = 2 * L
        Kp = _pad(K, ((0, 0), (0, L)))
        up = (lambda x, *d: x.permute(*d))(u, 0, 2, 1)
        up = _pad(up, ((0, 0), (0, 0), (0, L)))
        Kf = (lambda x, axes=(-2,-1): torch.fft.rfft2(x.float(), dim=axes))(Kp[:, None, :], axes=(-2, -1))
        Uf = (lambda x, axes=(-2,-1): torch.fft.rfft2(x.float(), dim=axes))(up[:, :, None, :], axes=(-2, -1))
        Yf = Uf * Kf[None, :, :, :]
        y = (lambda x, s, axes=(-2,-1): torch.fft.irfft2(x, s=s, dim=axes).to(torch.bfloat16))(Yf, (1, L2), axes=(-2, -1))[:, :, 0, :L]
        y = (lambda x, *d: x.permute(*d))(y, 0, 2, 1) + u * Dskip[None, None, :]
        return y

    def _B_ref(x, w1, w2):
        h = torch.einsum("bsd,df->bsf", x, w1)
        h = _silu(h)
        out = torch.einsum("bsf,fd->bsd", h, w2)
        return out

    x = A_u
    g = _sigmoid((x * gate_w).sum(-1, keepdims=True))
    a = _A_ref(x, A_A_re, A_A_im, A_B_re, A_B_im, A_C_re, A_C_im, A_log_dt, A_Dskip)
    b = _B_ref(x, B_w1, B_w2)
    return g * a + (1 - g) * b
```

```asm
; @launch grid=(256,1,1) block=(256,1,1) lds=163840
.amdgcn_target "amdgcn-amd-amdhsa--gfx950"
.text
.globl gated_mix__ssm_conv_s4__dense_activation_silu__prompt_kernel
.p2align 8
.type gated_mix__ssm_conv_s4__dense_activation_silu__prompt_kernel,@function
gated_mix__ssm_conv_s4__dense_activation_silu__prompt_kernel:
    s_cmp_ge_u32 s2, 256
    s_cbranch_scc1 L_end
    s_load_dwordx16 s[16:31], s[0:1], 0
    s_load_dwordx16 s[32:47], s[0:1], 64
    s_memrealtime s[6:7]
    s_getpc_b64 s[4:5]
L_pc:
    s_lshr_b32 s14, s2, 3
    s_mul_i32 s9, s14, 9
    v_min_u32 v40, 12, v0
    v_add_u32 v41, s9, v40
    v_lshlrev_b32 v41, 7, v41
    v_min_u32 v41, L_stab-L_pc-4, v41
    s_lshl_b32 s9, s2, 9
    s_add_u32 s9, s9, L_stab-L_pc-1152
    v_lshl_add_u32 v42, v40, 7, s9
    v_cmp_gt_u32 vcc, 9, v40
    v_and_b32 v1, 63, v0
    v_lshrrev_b32 v43, 6, v0
    v_cndmask_b32 v41, v42, v41, vcc
    global_load_dword v253, v41, s[4:5]
    v_readfirstlane_b32 s8, v43
    v_lshlrev_b32 v2, 4, v1
    s_and_b32 s4, s2, 7
    s_lshr_b32 s5, s2, 4
    s_lshl_b32 s5, s5, 3
    s_add_u32 s5, s5, s4
    s_and_b32 s12, s14, 1
    s_mul_i32 s11, s12, 3
    s_add_u32 s11, s11, s8
    s_min_u32 s11, s11, 4
    s_and_b32 s9, s5, 15
    s_mul_i32 s9, s9, 5
    s_add_u32 s11, s11, s9
    s_lshr_b32 s9, s5, 6
    s_mul_i32 s9, s9, 320
    s_bfe_u32 s5, s5, 0x20004
    s_lshl_b32 s10, s5, 4
    s_add_u32 s10, s10, 192
    s_lshl_b32 s5, s5, 6
    s_cmp_lt_u32 s11, 64
    s_cselect_b32 s5, s5, s10
    s_add_u32 s5, s5, s9
    s_add_u32 s5, s5, s11
    s_mul_i32 s11, s5, 384
    v_lshlrev_b32 v63, 2, v1
    v_add_u32 v63, s11, v63
    v_lshlrev_b32 v65, 1, v1
    v_add_u32 v65, s11, v65
    s_lshl_b32 s11, s5, 1
    v_mov_b32 v64, s11
    v_mov_b32 v3, 0
    s_lshr_b32 s9, s4, 1
    s_lshl_b32 s9, s9, 2
    s_lshr_b32 s3, s14, 3
    s_add_u32 s9, s9, s3
    s_and_b32 s11, s4, 1
    s_and_b32 s15, s14, 7
    s_lshl_b32 s10, s11, 3
    s_add_u32 s10, s10, s15
    s_mul_i32 s13, s15, 5
    s_lshr_b32 s13, s13, 2
    s_mul_i32 s3, s3, 10
    s_lshr_b32 s3, s3, 2
    s_add_u32 s3, s3, s11
    s_lshr_b32 s4, s4, 1
    s_add_u32 s3, s3, s4
    s_add_u32 s13, s13, s3
    s_cmp_ge_u32 s13, 10
    s_cselect_b32 s4, 10, 0
    s_sub_u32 s13, s13, s4
    v_lshrrev_b32 v40, 3, v1
    s_lshl_b32 s4, s9, 7
    v_add_u32 v40, s4, v40
    v_mul_u32_u24 v40, 1280, v40
    v_and_b32 v41, 7, v1
    v_lshrrev_b32 v42, 4, v1
    v_xor_b32 v41, v41, v42
    v_lshlrev_b32 v41, 4, v41
    v_add_u32 v96, v40, v41
    v_xor_b32 v41, 64, v41
    v_add_u32 v97, v40, v41
    v_add_u32 v97, 9216, v97
    v_add_u32 v98, 18432, v96
    v_add_u32 v99, 18432, v97
    s_lshl_b32 s4, s2, 2
    s_add_u32 s4, s4, s8
    s_lshl_b32 s4, s4, 7
    s_add_u32 s4, s4, L_stab-L_pc2
    s_waitcnt lgkmcnt(0)
    s_getpc_b64 s[34:35]
L_pc2:
    s_load_dwordx16 s[68:83], s[34:35], s4
    s_load_dwordx16 s[84:99], s[34:35], s4 offset:64
    s_cmp_eq_u32 s8, 3
    s_cbranch_scc1 L_f3
    global_load_dword v48, v63, s[18:19] nt
    global_load_dword v49, v63, s[20:21] nt
    global_load_dword v50, v63, s[22:23] nt
    global_load_dword v51, v63, s[24:25] nt
    global_load_dword v52, v63, s[26:27] nt
    global_load_dword v53, v63, s[28:29] nt
    global_load_short_d16_hi v54, v64, s[30:31]
    s_barrier
    global_load_short_d16_hi v56, v65, s[18:19] offset:256 nt
    global_load_short_d16_hi v57, v65, s[20:21] offset:256 nt
    global_load_short_d16_hi v58, v65, s[22:23] offset:256 nt
    global_load_short_d16_hi v59, v65, s[24:25] offset:256 nt
    global_load_short_d16_hi v60, v65, s[26:27] offset:256 nt
    global_load_short_d16_hi v61, v65, s[28:29] offset:256 nt
    global_load_short_d16_hi v248, v64, s[32:33]
    s_mul_i32 s5, s10, 192
    v_add_u32 v40, 0, v1
    v_mul_u32_u24 v41, 5462, v40
    v_lshrrev_b32 v41, 16, v41
    v_mul_u32_u24 v42, 12, v41
    v_sub_u32 v42, v40, v42
    v_lshrrev_b32 v40, 2, v41
    v_and_b32 v40, 2, v40
    v_xor_b32 v42, v42, v40
    v_mul_u32_u24 v41, 3072, v41
    v_lshl_add_u32 v41, v42, 4, v41
    v_add_u32 v41, s5, v41
    v_subrev_u32 v100, 0, v41
    v_add_u32 v40, 64, v1
    v_mul_u32_u24 v41, 5462, v40
    v_lshrrev_b32 v41, 16, v41
    v_mul_u32_u24 v42, 12, v41
    v_sub_u32 v42, v40, v42
    v_lshrrev_b32 v40, 2, v41
    v_and_b32 v40, 2, v40
    v_xor_b32 v42, v42, v40
    v_mul_u32_u24 v41, 3072, v41
    v_lshl_add_u32 v41, v42, 4, v41
    v_add_u32 v41, s5, v41
    v_subrev_u32 v101, 1024, v41
    v_add_u32 v40, 128, v1
    v_mul_u32_u24 v41, 5462, v40
    v_lshrrev_b32 v41, 16, v41
    v_mul_u32_u24 v42, 12, v41
    v_sub_u32 v42, v40, v42
    v_lshrrev_b32 v40, 2, v41
    v_and_b32 v40, 2, v40
    v_xor_b32 v42, v42, v40
    v_mul_u32_u24 v41, 3072, v41
    v_lshl_add_u32 v41, v42, 4, v41
    v_add_u32 v41, s5, v41
    v_subrev_u32 v102, 2048, v41
    s_mov_b32 s48, s16
    s_and_b32 s49, s17, 0xffff
    s_mov_b32 s50, 0x280000
    s_mov_b32 s51, 0x00020000
    s_mov_b32 s52, s36
    s_and_b32 s53, s37, 0xffff
    s_mov_b32 s54, 0x1e0000
    s_mov_b32 s55, 0x00020000
    s_branch L_fj
L_f3:
    s_mov_b32 s48, s16
    s_and_b32 s49, s17, 0xffff
    s_mov_b32 s50, 0x280000
    s_mov_b32 s51, 0x00020000
    s_mov_b32 s52, s36
    s_and_b32 s53, s37, 0xffff
    s_mov_b32 s54, 0x1e0000
    s_mov_b32 s55, 0x00020000
    s_lshl_b32 s18, s13, 7
    s_mul_i32 s19, s18, 1536
    s_add_u32 s20, s18, 128
    s_cmp_ge_u32 s20, 1280
    s_cselect_b32 s20, 0, s20
    s_mul_i32 s21, s20, 1536
    s_add_u32 s22, s20, 128
    s_cmp_ge_u32 s22, 1280
    s_cselect_b32 s22, 0, s22
    s_mul_i32 s23, s22, 1536
    s_barrier
    v_lshrrev_b32 v40, 4, v1
    v_lshl_add_u32 v40, v40, 4, s18
    global_load_dwordx4 v[80:83], v40, s[40:41]
    global_load_dwordx4 v[84:87], v40, s[40:41] offset:64
    s_and_b32 s26, s15, 3
    s_lshl_b32 s27, s11, 2
    s_add_u32 s26, s26, s27
    s_lshl_b32 s27, s9, 1
    s_lshr_b32 s4, s15, 2
    s_add_u32 s27, s27, s4
    s_mov_b32 m0, 47360
    s_mov_b32 s4, s18
    buffer_load_dwordx4 v96, s[48:51], s4 offen offset:0  lds
    buffer_load_dwordx4 v97, s[48:51], s4 offen offset:1024  lds
    buffer_load_dwordx4 v98, s[48:51], s4 offen offset:2048  lds
    buffer_load_dwordx4 v99, s[48:51], s4 offen offset:3072  lds
    s_mov_b32 m0, 54528
    s_add_u32 s4, s18, 40960
    buffer_load_dwordx4 v96, s[48:51], s4 offen offset:0  lds
    buffer_load_dwordx4 v97, s[48:51], s4 offen offset:1024  lds
    buffer_load_dwordx4 v98, s[48:51], s4 offen offset:2048  lds
    buffer_load_dwordx4 v99, s[48:51], s4 offen offset:3072  lds
    s_mov_b32 m0, 61696
    s_add_u32 s4, s18, 81920
    buffer_load_dwordx4 v96, s[48:51], s4 offen offset:0  lds
    buffer_load_dwordx4 v97, s[48:51], s4 offen offset:1024  lds
    buffer_load_dwordx4 v98, s[48:51], s4 offen offset:2048  lds
    buffer_load_dwordx4 v99, s[48:51], s4 offen offset:3072  lds
    s_mov_b32 m0, 68864
    s_add_u32 s4, s18, 122880
    buffer_load_dwordx4 v96, s[48:51], s4 offen offset:0  lds
    buffer_load_dwordx4 v97, s[48:51], s4 offen offset:1024  lds
    buffer_load_dwordx4 v98, s[48:51], s4 offen offset:2048  lds
    buffer_load_dwordx4 v99, s[48:51], s4 offen offset:3072  lds
    s_mul_i32 s5, s10, 192
    v_add_u32 v40, 0, v1
    v_mul_u32_u24 v41, 5462, v40
    v_lshrrev_b32 v41, 16, v41
    v_mul_u32_u24 v42, 12, v41
    v_sub_u32 v42, v40, v42
    v_lshrrev_b32 v40, 2, v41
    v_and_b32 v40, 2, v40
    v_xor_b32 v42, v42, v40
    v_mul_u32_u24 v41, 3072, v41
    v_lshl_add_u32 v41, v42, 4, v41
    v_add_u32 v41, s5, v41
    v_subrev_u32 v100, 0, v41
    v_add_u32 v40, 64, v1
    v_mul_u32_u24 v41, 5462, v40
    v_lshrrev_b32 v41, 16, v41
    v_mul_u32_u24 v42, 12, v41
    v_sub_u32 v42, v40, v42
    v_lshrrev_b32 v40, 2, v41
    v_and_b32 v40, 2, v40
    v_xor_b32 v42, v42, v40
    v_mul_u32_u24 v41, 3072, v41
    v_lshl_add_u32 v41, v42, 4, v41
    v_add_u32 v41, s5, v41
    v_subrev_u32 v101, 1024, v41
    v_add_u32 v40, 128, v1
    v_mul_u32_u24 v41, 5462, v40
    v_lshrrev_b32 v41, 16, v41
    v_mul_u32_u24 v42, 12, v41
    v_sub_u32 v42, v40, v42
    v_lshrrev_b32 v40, 2, v41
    v_and_b32 v40, 2, v40
    v_xor_b32 v42, v42, v40
    v_mul_u32_u24 v41, 3072, v41
    v_lshl_add_u32 v41, v42, 4, v41
    v_add_u32 v41, s5, v41
    v_subrev_u32 v102, 2048, v41
L_fj:
    s_mov_b32 s56, s38
    s_and_b32 s57, s39, 0xffff
    s_mov_b32 s58, 0x1e0000
    s_mov_b32 s59, 0x00020000
    s_mov_b32 s60, s46
    s_and_b32 s61, s47, 0xffff
    s_mov_b32 s62, 0x4000000
    s_mov_b32 s63, 0x00020000
    s_mov_b32 s64, s42
    s_and_b32 s65, s43, 0xffff
    s_mov_b32 s66, 0x280000
    s_mov_b32 s67, 0x00020000
    s_or_b32 s6, s6, 1
    s_or_b32 s4, s2, s8
    s_cmp_lg_u32 s4, 0
    s_cbranch_scc1 L_nononce
    v_mov_b32 v40, s6
    global_store_dword v3, v40, s[44:45] sc1
L_nononce:
    s_mul_i32 s36, s8, 15776
    v_and_b32 v44, 31, v1
    v_lshrrev_b32 v45, 5, v1
    v_bfe_u32 v46, v1, 2, 2
    v_and_b32 v47, 3, v1
    v_bfe_u32 v43, v1, 4, 1
    v_and_b32 v29, 15, v1
    v_lshrrev_b32 v28, 4, v1
    s_cmp_eq_u32 s8, 3
    s_cbranch_scc1 L_loader
    s_mul_i32 s4, s8, 40960
    v_add_u32 v4, s4, v96
    v_add_u32 v5, s4, v97
    v_add_u32 v6, s4, v98
    v_add_u32 v7, s4, v99
    s_mul_i32 s4, s8, 49152
    v_add_u32 v8, s4, v100
    v_add_u32 v9, s4, v101
    v_add_u32 v10, s4, v102
    v_lshrrev_b32 v40, 1, v29
    v_xor_b32 v40, v40, v28
    v_lshlrev_b32 v40, 4, v40
    v_lshl_add_u32 v40, v29, 7, v40
    v_xor_b32 v41, 64, v40
    s_lshr_b32 s4, s8, 1
    s_mul_i32 s4, s4, 14336
    s_add_u32 s4, s4, 47360
    v_add_u32 v12, s4, v40
    v_add_u32 v13, s4, v41
    v_add_u32 v14, 57344, v12
    v_add_u32 v15, 57344, v13
    v_lshl_add_u32 v40, v43, 3, v46
    v_mul_u32_u24 v40, 192, v40
    v_mul_u32_u24 v41, 7168, v45
    v_add_u32 v40, v40, v41
    v_lshl_add_u32 v40, v47, 3, v40
    v_add_u32 v40, 51456, v40
    s_and_b32 s4, s8, 1
    s_mul_i32 s4, s4, 3
    v_xor_b32 v41, s4, v43
    v_lshl_add_u32 v16, v41, 5, v40
    v_add_u32 v19, 57344, v16
    s_add_u32 s4, s4, 1
    v_xor_b32 v41, s4, v43
    v_lshl_add_u32 v17, v41, 5, v40
    v_add_u32 v20, 57344, v17
    s_add_u32 s4, s4, 1
    v_xor_b32 v41, s4, v43
    v_lshl_add_u32 v18, v41, 5, v40
    v_add_u32 v21, 57344, v18
    v_mul_u32_u24 v40, 272, v44
    v_lshl_add_u32 v40, v45, 4, v40
    v_add_u32 v68, s36, v40
    v_lshrrev_b32 v40, 2, v44
    v_mul_u32_u24 v40, 3, v40
    v_min_u32 v41, 2, v47
    v_add3_u32 v40, v40, v41, 2
    v_min_u32 v40, v40, v44
    v_add_u32 v40, 32, v40
    v_mul_u32_u24 v40, 272, v40
    v_lshl_add_u32 v40, v45, 4, v40
    v_add_u32 v69, s36, v40
    v_lshlrev_b32 v40, 4, v44
    v_lshl_add_u32 v40, v45, 3, v40
    v_add_u32 v70, s36, v40
    v_add_u32 v71, s36, v2
    v_subrev_u32 v72, 8, v2
    v_max_i32 v72, 0, v72
    v_add_u32 v72, s36, v72
    v_and_b32 v40, 1, v1
    v_mul_u32_u24 v40, 254, v40
    v_sub_u32 v40, 2558, v40
    v_and_b32 v41, 30, v1
    v_add_u32 v40, v40, v41
    v_lshl_add_u32 v40, v45, 6, v40
    v_add_u32 v73, s36, v40
    s_mov_b32 m0, s36
    v_mov_b32 v42, 0x3f80
    ds_write_addtid_b32 v42 offset:0
    v_mul_u32_u24 v40, 3136, v46
    v_lshl_add_u32 v40, v47, 3, v40
    v_lshlrev_b32 v42, 3, v28
    v_sub_u32 v40, v40, v42
    s_cmp_eq_u32 s8, 3
    s_cselect_b32 s5, 0, s8
    s_mul_i32 s4, s5, 15776
    v_add_u32 v40, s4, v40
    v_add_u32 v225, 2272, v40
    v_sub_u32 v40, v40, v42
    v_add_u32 v32, 56, v40
    v_lshl_add_u32 v40, v29, 1, v28
    s_mul_i32 s4, s5, 4608
    s_add_u32 s4, s4, 108832
    v_lshl_add_u32 v33, v40, 4, s4
    v_lshlrev_b32 v40, 7, v46
    v_lshl_add_u32 v40, v47, 4, v40
    v_lshl_add_u32 v40, v45, 6, v40
    v_lshl_add_u32 v34, v43, 9, v40
    v_lshl_add_u32 v35, v43, 3, v40
    v_lshlrev_b32 v238, 4, v0
    v_add_u32 v238, 109312, v238
    v_mul_u32_u24 v40, 49152, v43
    v_lshl_add_u32 v40, v45, 8, v40
    v_lshl_add_u32 v239, v29, 4, v40
    v_and_b32 v42, 1, v1
    v_lshlrev_b32 v224, 16, v42
    v_lshlrev_b32 v226, 11, v42
    s_add_u32 s4, s8, 1
    s_and_b32 s4, s4, 3
    s_mul_i32 s4, s4, 15360
    s_add_u32 s4, s4, 47360
    v_add_u32 v36, s4, v2
    s_add_u32 s4, s8, 2
    s_and_b32 s4, s4, 3
    s_mul_i32 s4, s4, 15360
    s_add_u32 s4, s4, 52480
    v_add_u32 v37, s4, v2
    s_add_u32 s4, s8, 3
    s_and_b32 s4, s4, 3
    s_mul_i32 s4, s4, 15360
    s_add_u32 s4, s4, 57600
    v_add_u32 v38, s4, v2
    s_mul_i32 s4, s8, 15360
    s_add_u32 s4, s4, 47360
    v_add_u32 v39, s4, v2
    v_and_b32 v42, 1, v1
    v_lshlrev_b32 v42, 2, v42
    v_cmp_gt_u32 vcc, 8, v1
    s_waitcnt lgkmcnt(0)
    v_add_u32 v40, s72, v42
    v_lshlrev_b32 v40, 9, v40
    v_add_u32 v40, s73, v40
    v_lshlrev_b32 v41, 9, v42
    v_add_u32 v41, s74, v41
    v_cndmask_b32 v31, v40, v41, vcc
    v_mov_b32 v27, 0
    s_mov_b32 s72, 0x3fb8aa3b
    s_mov_b32 s73, 0x3e22f983
    s_mov_b32 s74, 0x4138aa3b
    s_mov_b32 s75, 0x3fa2f983
    s_mov_b64 exec, 0
    s_cmp_eq_u32 s8, 1
    s_cbranch_scc1 L_padL0
    s_cmp_eq_u32 s8, 2
    s_cbranch_scc1 L_padM0
    s_branch L_padK0
L_backK:
L_backL:
L_backM:
    s_mov_b64 exec, -1
    s_lshl_b32 s4, s12, 2
    s_add_u32 s4, s4, s8
    s_cmp_eq_u32 s4, 6
    s_cbranch_scc1 L_kzero
    s_waitcnt vmcnt(7)
    v_mul_f32 v54, s72, v54
    v_exp_f32 v54, v54
    v_lshlrev_b32 v190, 16, v48
    v_lshlrev_b32 v191, 16, v49
    v_cvt_pk_bf16_f32 v54, v54, v54
    v_lshlrev_b32 v192, 16, v50
    v_lshlrev_b32 v193, 16, v51
    v_and_b32 v54, s93, v54
    v_lshlrev_b32 v194, 16, v52
    v_lshlrev_b32_e64 v195, 16, v53
    v_pk_mul_f32 v[198:199], v[190:191], v[54:55] op_sel_hi:[1,0]
    v_pk_mul_f32 v[208:209], v[192:193], v[194:195] op_sel:[0,0] op_sel_hi:[1,0]
    v_pk_mul_f32 v[196:197], v[198:199], s[72:73]
    v_pk_mul_f32 v[198:199], v[198:199], s[74:75]
    v_pk_fma_f32 v[206:207], v[192:193], v[194:195], v[208:209] op_sel:[1,1,0] op_sel_hi:[0,1,1] neg_lo:[1,0,0]
    v_fract_f32 v197, v197
    v_fract_f32 v199, v199
    v_exp_f32 v205, v198
    v_exp_f32 v204, v196
    v_cos_f32 v202, v199
    v_sin_f32 v203, v199
    v_cos_f32 v200, v197
    v_sin_f32 v201, v197
    v_pk_mul_f32 v[96:97], v[202:203], v[204:205] op_sel:[0,1] op_sel_hi:[1,1]
    v_pk_mul_f32 v[100:101], v[206:207], v[54:55] op_sel_hi:[1,0]
    v_pk_mul_f32 v[98:99], v[200:201], v[204:205] op_sel_hi:[1,0]
    v_pk_mul_f32 v[108:109], v[96:97], v[96:97] op_sel:[0,0] op_sel_hi:[1,0]
    v_pk_mul_f32 v[110:111], v[100:101], v[98:99] op_sel:[0,0] op_sel_hi:[1,0]
    v_pk_fma_f32 v[128:129], v[96:97], v[96:97], v[108:109] op_sel:[1,1,0] op_sel_hi:[0,1,1] neg_lo:[1,0,0]
    v_pk_fma_f32 v[130:131], v[100:101], v[98:99], v[110:111] op_sel:[1,1,0] op_sel_hi:[0,1,1] neg_lo:[1,0,0]
    v_pk_mul_f32 v[108:109], v[128:129], v[128:129] op_sel:[0,0] op_sel_hi:[1,0]
    v_pk_mul_f32 v[110:111], v[128:129], v[96:97] op_sel:[0,0] op_sel_hi:[1,0]
    v_pk_mul_f32 v[112:113], v[130:131], v[98:99] op_sel:[0,0] op_sel_hi:[1,0]
    v_pk_fma_f32 v[132:133], v[128:129], v[128:129], v[108:109] op_sel:[1,1,0] op_sel_hi:[0,1,1] neg_lo:[1,0,0]
    v_pk_fma_f32 v[134:135], v[128:129], v[96:97], v[110:111] op_sel:[1,1,0] op_sel_hi:[0,1,1] neg_lo:[1,0,0]
    v_pk_fma_f32 v[136:137], v[130:131], v[98:99], v[112:113] op_sel:[1,1,0] op_sel_hi:[0,1,1] neg_lo:[1,0,0]
    v_cvt_pk_bf16_f32 v118, v100, -v101
    v_cvt_pk_bf16_f32 v119, v96, v97
    v_cvt_pk_bf16_f32 v120, v128, v129
    v_cvt_pk_bf16_f32 v121, v130, -v131
    v_cvt_pk_bf16_f32 v122, v132, v133
    v_cvt_pk_bf16_f32 v123, v134, v135
    v_cvt_pk_bf16_f32 v124, v136, -v137
    ds_write_addtid_b32 v118 offset:8704
    ds_write_addtid_b32 v119 offset:272
    ds_write_addtid_b32 v120 offset:544
    ds_write_addtid_b32 v121 offset:8976
    ds_write_addtid_b32 v122 offset:1088
    ds_write_addtid_b32 v123 offset:816
    ds_write_addtid_b32 v124 offset:9248
    v_pk_mul_f32 v[108:109], v[132:133], v[132:133] op_sel:[0,0] op_sel_hi:[1,0]
    v_pk_mul_f32 v[110:111], v[132:133], v[96:97] op_sel:[0,0] op_sel_hi:[1,0]
    v_pk_mul_f32 v[112:113], v[136:137], v[98:99] op_sel:[0,0] op_sel_hi:[1,0]
    v_pk_mul_f32 v[114:115], v[132:133], v[128:129] op_sel:[0,0] op_sel_hi:[1,0]
    v_pk_fma_f32 v[138:139], v[132:133], v[132:133], v[108:109] op_sel:[1,1,0] op_sel_hi:[0,1,1] neg_lo:[1,0,0]
    v_pk_fma_f32 v[140:141], v[132:133], v[96:97], v[110:111] op_sel:[1,1,0] op_sel_hi:[0,1,1] neg_lo:[1,0,0]
    v_pk_fma_f32 v[142:143], v[136:137], v[98:99], v[112:113] op_sel:[1,1,0] op_sel_hi:[0,1,1] neg_lo:[1,0,0]
    v_pk_fma_f32 v[144:145], v[132:133], v[128:129], v[114:115] op_sel:[1,1,0] op_sel_hi:[0,1,1] neg_lo:[1,0,0]
    v_pk_mul_f32 v[108:109], v[138:139], v[138:139] op_sel:[0,0] op_sel_hi:[1,0]
    v_pk_mul_f32 v[110:111], v[132:133], v[134:135] op_sel:[0,0] op_sel_hi:[1,0]
    v_pk_mul_f32 v[112:113], v[142:143], v[98:99] op_sel:[0,0] op_sel_hi:[1,0]
    v_pk_mul_f32 v[114:115], v[138:139], v[96:97] op_sel:[0,0] op_sel_hi:[1,0]
    v_pk_fma_f32 v[146:147], v[138:139], v[138:139], v[108:109] op_sel:[1,1,0] op_sel_hi:[0,1,1] neg_lo:[1,0,0]
    v_pk_fma_f32 v[148:149], v[132:133], v[134:135], v[110:111] op_sel:[1,1,0] op_sel_hi:[0,1,1] neg_lo:[1,0,0]
    v_pk_fma_f32 v[150:151], v[142:143], v[98:99], v[112:113] op_sel:[1,1,0] op_sel_hi:[0,1,1] neg_lo:[1,0,0]
    v_pk_fma_f32 v[152:153], v[138:139], v[96:97], v[114:115] op_sel:[1,1,0] op_sel_hi:[0,1,1] neg_lo:[1,0,0]
    v_cvt_pk_bf16_f32 v118, v138, v139
    v_cvt_pk_bf16_f32 v119, v140, v141
    v_cvt_pk_bf16_f32 v120, v142, -v143
    v_cvt_pk_bf16_f32 v121, v144, v145
    v_cvt_pk_bf16_f32 v122, v146, v147
    v_cvt_pk_bf16_f32 v123, v148, v149
    v_cvt_pk_bf16_f32 v124, v150, -v151
    v_cvt_pk_bf16_f32 v125, v152, v153
    ds_write_addtid_b32 v118 offset:2176
    ds_write_addtid_b32 v119 offset:1360
    ds_write_addtid_b32 v120 offset:9520
    ds_write_addtid_b32 v121 offset:1632
    ds_write_addtid_b32 v122 offset:4352
    ds_write_addtid_b32 v123 offset:1904
    ds_write_addtid_b32 v124 offset:9792
    ds_write_addtid_b32 v125 offset:2448
    v_pk_mul_f32 v[108:109], v[146:147], v[146:147] op_sel:[0,0] op_sel_hi:[1,0]
    v_pk_mul_f32 v[110:111], v[138:139], v[128:129] op_sel:[0,0] op_sel_hi:[1,0]
    v_pk_mul_f32 v[112:113], v[150:151], v[98:99] op_sel:[0,0] op_sel_hi:[1,0]
    v_pk_mul_f32 v[114:115], v[138:139], v[134:135] op_sel:[0,0] op_sel_hi:[1,0]
    v_pk_fma_f32 v[154:155], v[146:147], v[146:147], v[108:109] op_sel:[1,1,0] op_sel_hi:[0,1,1] neg_lo:[1,0,0]
    v_pk_fma_f32 v[156:157], v[138:139], v[128:129], v[110:111] op_sel:[1,1,0] op_sel_hi:[0,1,1] neg_lo:[1,0,0]
    v_pk_fma_f32 v[158:159], v[150:151], v[98:99], v[112:113] op_sel:[1,1,0] op_sel_hi:[0,1,1] neg_lo:[1,0,0]
    v_pk_fma_f32 v[160:161], v[138:139], v[134:135], v[114:115] op_sel:[1,1,0] op_sel_hi:[0,1,1] neg_lo:[1,0,0]
    v_pk_mul_f32 v[108:109], v[100:101], v[154:155] op_sel:[0,0] op_sel_hi:[1,0]
    v_pk_mul_f32 v[110:111], v[138:139], v[132:133] op_sel:[0,0] op_sel_hi:[1,0]
    v_pk_mul_f32 v[112:113], v[158:159], v[98:99] op_sel:[0,0] op_sel_hi:[1,0]
    v_pk_mul_f32 v[114:115], v[138:139], v[140:141] op_sel:[0,0] op_sel_hi:[1,0]
    v_pk_fma_f32 v[162:163], v[100:101], v[154:155], v[108:109] op_sel:[1,1,0] op_sel_hi:[0,1,1] neg_lo:[1,0,0]
    v_pk_fma_f32 v[164:165], v[138:139], v[132:133], v[110:111] op_sel:[1,1,0] op_sel_hi:[0,1,1] neg_lo:[1,0,0]
    v_pk_fma_f32 v[166:167], v[158:159], v[98:99], v[112:113] op_sel:[1,1,0] op_sel_hi:[0,1,1] neg_lo:[1,0,0]
    v_pk_fma_f32 v[168:169], v[138:139], v[140:141], v[114:115] op_sel:[1,1,0] op_sel_hi:[0,1,1] neg_lo:[1,0,0]
    v_cvt_pk_bf16_f32 v118, v156, v157
    v_cvt_pk_bf16_f32 v119, v158, -v159
    v_cvt_pk_bf16_f32 v120, v160, v161
    v_cvt_pk_bf16_f32 v121, v162, -v163
    v_cvt_pk_bf16_f32 v122, v164, v165
    v_cvt_pk_bf16_f32 v123, v166, -v167
    v_cvt_pk_bf16_f32 v124, v168, v169
    ds_write_addtid_b32 v118 offset:2720
    ds_write_addtid_b32 v119 offset:10064
    ds_write_addtid_b32 v120 offset:2992
    ds_write_addtid_b32 v121 offset:10880
    ds_write_addtid_b32 v122 offset:3264
    ds_write_addtid_b32 v123 offset:10336
    ds_write_addtid_b32 v124 offset:3536
    v_pk_mul_f32 v[108:109], v[162:163], v[154:155] op_sel:[0,0] op_sel_hi:[1,0]
    v_pk_mul_f32 v[110:111], v[150:151], v[154:155] op_sel:[0,0] op_sel_hi:[1,0]
    v_pk_mul_f32 v[112:113], v[166:167], v[98:99] op_sel:[0,0] op_sel_hi:[1,0]
    v_pk_mul_f32 v[114:115], v[138:139], v[144:145] op_sel:[0,0] op_sel_hi:[1,0]
    v_pk_fma_f32 v[170:171], v[162:163], v[154:155], v[108:109] op_sel:[1,1,0] op_sel_hi:[0,1,1] neg_lo:[1,0,0]
    v_pk_fma_f32 v[172:173], v[150:151], v[154:155], v[110:111] op_sel:[1,1,0] op_sel_hi:[0,1,1] neg_lo:[1,0,0]
    v_pk_fma_f32 v[174:175], v[166:167], v[98:99], v[112:113] op_sel:[1,1,0] op_sel_hi:[0,1,1] neg_lo:[1,0,0]
    v_pk_fma_f32 v[176:177], v[138:139], v[144:145], v[114:115] op_sel:[1,1,0] op_sel_hi:[0,1,1] neg_lo:[1,0,0]
    v_pk_mul_f32 v[108:109], v[170:171], v[154:155] op_sel:[0,0] op_sel_hi:[1,0]
    v_pk_mul_f32 v[110:111], v[172:173], v[154:155] op_sel:[0,0] op_sel_hi:[1,0]
    v_pk_mul_f32 v[112:113], v[136:137], v[154:155] op_sel:[0,0] op_sel_hi:[1,0]
    v_pk_mul_f32 v[114:115], v[138:139], v[148:149] op_sel:[0,0] op_sel_hi:[1,0]
    v_pk_fma_f32 v[178:179], v[170:171], v[154:155], v[108:109] op_sel:[1,1,0] op_sel_hi:[0,1,1] neg_lo:[1,0,0]
    v_pk_fma_f32 v[180:181], v[172:173], v[154:155], v[110:111] op_sel:[1,1,0] op_sel_hi:[0,1,1] neg_lo:[1,0,0]
    v_pk_fma_f32 v[182:183], v[136:137], v[154:155], v[112:113] op_sel:[1,1,0] op_sel_hi:[0,1,1] neg_lo:[1,0,0]
    v_pk_fma_f32 v[184:185], v[138:139], v[148:149], v[114:115] op_sel:[1,1,0] op_sel_hi:[0,1,1] neg_lo:[1,0,0]
    v_cvt_pk_bf16_f32 v118, v170, -v171
    v_cvt_pk_bf16_f32 v119, v172, -v173
L_padK0:
    s_cbranch_execz L_padK1
    s_nop 0
    v_cvt_pk_bf16_f32 v120, v174, -v175
    v_cvt_pk_bf16_f32 v121, v176, v177
    v_cvt_pk_bf16_f32 v122, v178, -v179
    v_cvt_pk_bf16_f32 v123, v180, -v181
    v_cvt_pk_bf16_f32 v124, v182, -v183
    v_cvt_pk_bf16_f32 v125, v184, v185
    ds_write_addtid_b32 v118 offset:12512
    ds_write_addtid_b32 v119 offset:11424
    ds_write_addtid_b32 v119 offset:11696
    ds_write_addtid_b32 v120 offset:10608
    ds_write_addtid_b32 v121 offset:3808
    ds_write_addtid_b32 v122 offset:13328
    ds_write_addtid_b32 v123 offset:12784
    ds_write_addtid_b32 v124 offset:11152
    ds_write_addtid_b32 v125 offset:4080
    v_pk_mul_f32 v[108:109], v[178:179], v[154:155] op_sel:[0,0] op_sel_hi:[1,0]
    v_pk_mul_f32 v[110:111], v[180:181], v[154:155] op_sel:[0,0] op_sel_hi:[1,0]
    v_pk_mul_f32 v[112:113], v[166:167], v[154:155] op_sel:[0,0] op_sel_hi:[1,0]
    v_pk_mul_f32 v[114:115], v[146:147], v[96:97] op_sel:[0,0] op_sel_hi:[1,0]
    v_pk_fma_f32 v[186:187], v[178:179], v[154:155], v[108:109] op_sel:[1,1,0] op_sel_hi:[0,1,1] neg_lo:[1,0,0]
    v_pk_fma_f32 v[188:189], v[180:181], v[154:155], v[110:111] op_sel:[1,1,0] op_sel_hi:[0,1,1] neg_lo:[1,0,0]
    v_pk_fma_f32 v[130:131], v[166:167], v[154:155], v[112:113] op_sel:[1,1,0] op_sel_hi:[0,1,1] neg_lo:[1,0,0]
    v_pk_fma_f32 v[142:143], v[146:147], v[96:97], v[114:115] op_sel:[1,1,0] op_sel_hi:[0,1,1] neg_lo:[1,0,0]
    v_pk_mul_f32 v[108:109], v[186:187], v[154:155] op_sel:[0,0] op_sel_hi:[1,0]
    v_pk_mul_f32 v[110:111], v[146:147], v[128:129] op_sel:[0,0] op_sel_hi:[1,0]
    v_pk_mul_f32 v[112:113], v[146:147], v[134:135] op_sel:[0,0] op_sel_hi:[1,0]
    v_pk_mul_f32 v[114:115], v[146:147], v[132:133] op_sel:[0,0] op_sel_hi:[1,0]
    v_pk_fma_f32 v[158:159], v[186:187], v[154:155], v[108:109] op_sel:[1,1,0] op_sel_hi:[0,1,1] neg_lo:[1,0,0]
    v_pk_fma_f32 v[136:137], v[146:147], v[128:129], v[110:111] op_sel:[1,1,0] op_sel_hi:[0,1,1] neg_lo:[1,0,0]
    v_pk_fma_f32 v[150:151], v[146:147], v[134:135], v[112:113] op_sel:[1,1,0] op_sel_hi:[0,1,1] neg_lo:[1,0,0]
    v_pk_fma_f32 v[172:173], v[146:147], v[132:133], v[114:115] op_sel:[1,1,0] op_sel_hi:[0,1,1] neg_lo:[1,0,0]
    v_cvt_pk_bf16_f32 v118, v186, -v187
    v_cvt_pk_bf16_f32 v119, v188, -v189
    v_cvt_pk_bf16_f32 v120, v130, -v131
    v_cvt_pk_bf16_f32 v121, v142, v143
    v_cvt_pk_bf16_f32 v122, v158, -v159
    v_cvt_pk_bf16_f32 v123, v136, v137
    v_cvt_pk_bf16_f32 v124, v150, v151
    v_cvt_pk_bf16_f32 v125, v172, v173
    ds_write_addtid_b32 v118 offset:14144
    ds_write_addtid_b32 v119 offset:13600
    ds_write_addtid_b32 v120 offset:11968
    ds_write_addtid_b32 v121 offset:4624
    ds_write_addtid_b32 v122 offset:14416
    ds_write_addtid_b32 v123 offset:4896
    ds_write_addtid_b32 v124 offset:5168
    ds_write_addtid_b32 v125 offset:5440
    v_pk_mul_f32 v[108:109], v[158:159], v[154:155] op_sel:[0,0] op_sel_hi:[1,0]
    v_pk_mul_f32 v[110:111], v[146:147], v[140:141] op_sel:[0,0] op_sel_hi:[1,0]
    v_pk_mul_f32 v[112:113], v[146:147], v[144:145] op_sel:[0,0] op_sel_hi:[1,0]
    v_pk_mul_f32 v[114:115], v[146:147], v[148:149] op_sel:[0,0] op_sel_hi:[1,0]
    v_pk_fma_f32 v[174:175], v[158:159], v[154:155], v[108:109] op_sel:[1,1,0] op_sel_hi:[0,1,1] neg_lo:[1,0,0]
    v_pk_fma_f32 v[182:183], v[146:147], v[140:141], v[110:111] op_sel:[1,1,0] op_sel_hi:[0,1,1] neg_lo:[1,0,0]
    v_pk_fma_f32 v[128:129], v[146:147], v[144:145], v[112:113] op_sel:[1,1,0] op_sel_hi:[0,1,1] neg_lo:[1,0,0]
    v_pk_fma_f32 v[132:133], v[146:147], v[148:149], v[114:115] op_sel:[1,1,0] op_sel_hi:[0,1,1] neg_lo:[1,0,0]
    v_pk_mul_f32 v[108:109], v[174:175], v[154:155] op_sel:[0,0] op_sel_hi:[1,0]
    v_pk_mul_f32 v[110:111], v[146:147], v[138:139] op_sel:[0,0] op_sel_hi:[1,0]
    v_pk_mul_f32 v[112:113], v[146:147], v[152:153] op_sel:[0,0] op_sel_hi:[1,0]
    v_pk_mul_f32 v[114:115], v[146:147], v[156:157] op_sel:[0,0] op_sel_hi:[1,0]
    v_pk_fma_f32 v[134:135], v[174:175], v[154:155], v[108:109] op_sel:[1,1,0] op_sel_hi:[0,1,1] neg_lo:[1,0,0]
    v_pk_fma_f32 v[166:167], v[146:147], v[138:139], v[110:111] op_sel:[1,1,0] op_sel_hi:[0,1,1] neg_lo:[1,0,0]
    v_pk_fma_f32 v[180:181], v[146:147], v[152:153], v[112:113] op_sel:[1,1,0] op_sel_hi:[0,1,1] neg_lo:[1,0,0]
    v_pk_fma_f32 v[186:187], v[146:147], v[156:157], v[114:115] op_sel:[1,1,0] op_sel_hi:[0,1,1] neg_lo:[1,0,0]
    v_cvt_pk_bf16_f32 v118, v174, -v175
    v_cvt_pk_bf16_f32 v119, v182, v183
    v_cvt_pk_bf16_f32 v120, v128, v129
    v_cvt_pk_bf16_f32 v121, v132, v133
    v_cvt_pk_bf16_f32 v122, v134, -v135
    v_cvt_pk_bf16_f32 v123, v166, v167
    v_cvt_pk_bf16_f32 v124, v180, v181
    v_cvt_pk_bf16_f32 v125, v186, v187
    ds_write_addtid_b32 v118 offset:14960
    ds_write_addtid_b32 v119 offset:5712
    ds_write_addtid_b32 v120 offset:5984
    ds_write_addtid_b32 v121 offset:6256
    ds_write_addtid_b32 v122 offset:15232
    ds_write_addtid_b32 v123 offset:6528
    ds_write_addtid_b32 v124 offset:6800
    ds_write_addtid_b32 v125 offset:7072
    v_pk_mul_f32 v[108:109], v[134:135], v[154:155] op_sel:[0,0] op_sel_hi:[1,0]
    v_pk_mul_f32 v[110:111], v[146:147], v[160:161] op_sel:[0,0] op_sel_hi:[1,0]
    v_pk_mul_f32 v[112:113], v[146:147], v[164:165] op_sel:[0,0] op_sel_hi:[1,0]
    v_pk_mul_f32 v[114:115], v[146:147], v[168:169] op_sel:[0,0] op_sel_hi:[1,0]
    v_pk_mul_f32 v[116:117], v[178:179], v[96:97] op_sel:[0,0] op_sel_hi:[1,0]
    v_pk_fma_f32 v[188:189], v[134:135], v[154:155], v[108:109] op_sel:[1,1,0] op_sel_hi:[0,1,1] neg_lo:[1,0,0]
    v_pk_fma_f32 v[130:131], v[146:147], v[160:161], v[110:111] op_sel:[1,1,0] op_sel_hi:[0,1,1] neg_lo:[1,0,0]
    v_pk_fma_f32 v[142:143], v[146:147], v[164:165], v[112:113] op_sel:[1,1,0] op_sel_hi:[0,1,1] neg_lo:[1,0,0]
    v_pk_fma_f32 v[136:137], v[146:147], v[168:169], v[114:115] op_sel:[1,1,0] op_sel_hi:[0,1,1] neg_lo:[1,0,0]
    v_pk_fma_f32 v[150:151], v[178:179], v[96:97], v[116:117] op_sel:[1,1,0] op_sel_hi:[0,1,1] neg_lo:[1,0,0]
    v_pk_mul_f32 v[108:109], v[146:147], v[176:177] op_sel:[0,0] op_sel_hi:[1,0]
    v_pk_mul_f32 v[110:111], v[146:147], v[184:185] op_sel:[0,0] op_sel_hi:[1,0]
    v_pk_mul_f32 v[112:113], v[162:163], v[96:97] op_sel:[0,0] op_sel_hi:[1,0]
    v_pk_mul_f32 v[114:115], v[170:171], v[96:97] op_sel:[0,0] op_sel_hi:[1,0]
    v_pk_fma_f32 v[172:173], v[146:147], v[176:177], v[108:109] op_sel:[1,1,0] op_sel_hi:[0,1,1] neg_lo:[1,0,0]
    v_pk_fma_f32 v[138:139], v[146:147], v[184:185], v[110:111] op_sel:[1,1,0] op_sel_hi:[0,1,1] neg_lo:[1,0,0]
    v_pk_fma_f32 v[140:141], v[162:163], v[96:97], v[112:113] op_sel:[1,1,0] op_sel_hi:[0,1,1] neg_lo:[1,0,0]
    v_pk_fma_f32 v[144:145], v[170:171], v[96:97], v[114:115] op_sel:[1,1,0] op_sel_hi:[0,1,1] neg_lo:[1,0,0]
    v_cvt_pk_bf16_f32 v118, v188, -v189
    v_cvt_pk_bf16_f32 v119, v130, v131
    v_cvt_pk_bf16_f32 v120, v142, v143
    v_cvt_pk_bf16_f32 v121, v136, v137
    v_cvt_pk_bf16_f32 v122, v150, -v151
    v_cvt_pk_bf16_f32 v123, v172, v173
    v_cvt_pk_bf16_f32 v124, v138, v139
    v_cvt_pk_bf16_f32 v125, v140, -v141
    v_cvt_pk_bf16_f32 v126, v144, -v145
    ds_write_addtid_b32 v118 offset:15504
    ds_write_addtid_b32 v119 offset:7344
    ds_write_addtid_b32 v120 offset:7616
    ds_write_addtid_b32 v121 offset:7888
    ds_write_addtid_b32 v122 offset:13872
    ds_write_addtid_b32 v123 offset:8160
    ds_write_addtid_b32 v124 offset:8432
    ds_write_addtid_b32 v125 offset:12240
    ds_write_addtid_b32 v126 offset:13056
    ds_read_b128 a[0:3], v68 offset:0
    ds_read_b128 a[4:7], v69 offset:0
    ds_read_b128 a[8:11], v68 offset:32
    ds_read_b128 a[12:15], v69 offset:32
    ds_read_b128 a[16:19], v68 offset:64
    ds_read_b128 a[20:23], v69 offset:64
    ds_read_b128 a[24:27], v68 offset:96
    ds_read_b128 a[28:31], v69 offset:96
    ds_read_b128 a[32:35], v68 offset:128
    ds_read_b128 a[36:39], v69 offset:128
    ds_read_b128 a[40:43], v68 offset:160
    ds_read_b128 a[44:47], v69 offset:160
    ds_read_b128 a[48:51], v68 offset:192
    ds_read_b128 a[52:55], v69 offset:192
    ds_read_b128 a[56:59], v68 offset:224
    ds_read_b128 a[60:63], v69 offset:224
    v_and_b32 v190, s93, v48
    v_and_b32 v191, s93, v49
    v_and_b32 v192, s93, v50
    v_and_b32 v193, s93, v51
    v_and_b32 v194, s93, v52
    v_and_b32 v195, s93, v53
    v_pk_mul_f32 v[198:199], v[190:191], v[54:55] op_sel_hi:[1,0]
    v_pk_mul_f32 v[208:209], v[192:193], v[194:195] op_sel:[0,0] op_sel_hi:[1,0]
    v_pk_mul_f32 v[196:197], v[198:199], s[72:73]
    v_pk_mul_f32 v[198:199], v[198:199], s[74:75]
    v_pk_fma_f32 v[206:207], v[192:193], v[194:195], v[208:209] op_sel:[1,1,0] op_sel_hi:[0,1,1] neg_lo:[1,0,0]
    v_fract_f32 v197, v197
    v_fract_f32 v199, v199
    v_exp_f32 v205, v198
    v_exp_f32 v204, v196
    v_cos_f32 v202, v199
    v_sin_f32 v203, v199
    v_cos_f32 v200, v197
    v_sin_f32 v201, v197
    v_pk_mul_f32 v[102:103], v[202:203], v[204:205] op_sel:[0,1] op_sel_hi:[1,1]
    v_pk_mul_f32 v[106:107], v[206:207], v[54:55] op_sel_hi:[1,0]
    v_pk_mul_f32 v[104:105], v[200:201], v[204:205] op_sel_hi:[1,0]
    s_waitcnt lgkmcnt(0)
    s_nop 0
    v_pk_mul_f32 v[108:109], v[102:103], v[102:103] op_sel:[0,0] op_sel_hi:[1,0]
    v_pk_mul_f32 v[110:111], v[106:107], v[104:105] op_sel:[0,0] op_sel_hi:[1,0]
    v_pk_fma_f32 v[128:129], v[102:103], v[102:103], v[108:109] op_sel:[1,1,0] op_sel_hi:[0,1,1] neg_lo:[1,0,0]
    v_pk_fma_f32 v[130:131], v[106:107], v[104:105], v[110:111] op_sel:[1,1,0] op_sel_hi:[0,1,1] neg_lo:[1,0,0]
    v_pk_mul_f32 v[108:109], v[128:129], v[128:129] op_sel:[0,0] op_sel_hi:[1,0]
    v_pk_mul_f32 v[110:111], v[128:129], v[102:103] op_sel:[0,0] op_sel_hi:[1,0]
    v_pk_mul_f32 v[112:113], v[130:131], v[104:105] op_sel:[0,0] op_sel_hi:[1,0]
    v_pk_fma_f32 v[132:133], v[128:129], v[128:129], v[108:109] op_sel:[1,1,0] op_sel_hi:[0,1,1] neg_lo:[1,0,0]
    v_pk_fma_f32 v[134:135], v[128:129], v[102:103], v[110:111] op_sel:[1,1,0] op_sel_hi:[0,1,1] neg_lo:[1,0,0]
    v_pk_fma_f32 v[136:137], v[130:131], v[104:105], v[112:113] op_sel:[1,1,0] op_sel_hi:[0,1,1] neg_lo:[1,0,0]
    v_mfma_f32_32x32x16_bf16 v[80:95], a[4:7], a[0:3], 0
    v_cvt_pk_bf16_f32 v118, v106, -v107
    v_cvt_pk_bf16_f32 v119, v102, v103
    v_cvt_pk_bf16_f32 v120, v128, v129
    v_cvt_pk_bf16_f32 v121, v130, -v131
    v_cvt_pk_bf16_f32 v122, v132, v133
    v_cvt_pk_bf16_f32 v123, v134, v135
    v_cvt_pk_bf16_f32 v124, v136, -v137
    v_mfma_f32_32x32x16_bf16 v[80:95], a[12:15], a[8:11], v[80:95]
    ds_write_addtid_b32 v118 offset:8704
    ds_write_addtid_b32 v119 offset:272
    ds_write_addtid_b32 v120 offset:544
    ds_write_addtid_b32 v121 offset:8976
    ds_write_addtid_b32 v122 offset:1088
    ds_write_addtid_b32 v123 offset:816
    ds_write_addtid_b32 v124 offset:9248
    v_pk_mul_f32 v[108:109], v[132:133], v[132:133] op_sel:[0,0] op_sel_hi:[1,0]
    v_pk_mul_f32 v[110:111], v[132:133], v[102:103] op_sel:[0,0] op_sel_hi:[1,0]
    v_pk_mul_f32 v[112:113], v[136:137], v[104:105] op_sel:[0,0] op_sel_hi:[1,0]
    v_pk_mul_f32 v[114:115], v[132:133], v[128:129] op_sel:[0,0] op_sel_hi:[1,0]
    v_pk_fma_f32 v[138:139], v[132:133], v[132:133], v[108:109] op_sel:[1,1,0] op_sel_hi:[0,1,1] neg_lo:[1,0,0]
    v_pk_fma_f32 v[140:141], v[132:133], v[102:103], v[110:111] op_sel:[1,1,0] op_sel_hi:[0,1,1] neg_lo:[1,0,0]
    v_pk_fma_f32 v[142:143], v[136:137], v[104:105], v[112:113] op_sel:[1,1,0] op_sel_hi:[0,1,1] neg_lo:[1,0,0]
    v_pk_fma_f32 v[144:145], v[132:133], v[128:129], v[114:115] op_sel:[1,1,0] op_sel_hi:[0,1,1] neg_lo:[1,0,0]
    v_pk_mul_f32 v[108:109], v[138:139], v[138:139] op_sel:[0,0] op_sel_hi:[1,0]
    v_pk_mul_f32 v[110:111], v[132:133], v[134:135] op_sel:[0,0] op_sel_hi:[1,0]
    v_pk_mul_f32 v[112:113], v[142:143], v[104:105] op_sel:[0,0] op_sel_hi:[1,0]
    v_pk_mul_f32 v[114:115], v[138:139], v[102:103] op_sel:[0,0] op_sel_hi:[1,0]
    v_pk_fma_f32 v[146:147], v[138:139], v[138:139], v[108:109] op_sel:[1,1,0] op_sel_hi:[0,1,1] neg_lo:[1,0,0]
    v_pk_fma_f32 v[148:149], v[132:133], v[134:135], v[110:111] op_sel:[1,1,0] op_sel_hi:[0,1,1] neg_lo:[1,0,0]
    v_pk_fma_f32 v[150:151], v[142:143], v[104:105], v[112:113] op_sel:[1,1,0] op_sel_hi:[0,1,1] neg_lo:[1,0,0]
    v_pk_fma_f32 v[152:153], v[138:139], v[102:103], v[114:115] op_sel:[1,1,0] op_sel_hi:[0,1,1] neg_lo:[1,0,0]
    v_mfma_f32_32x32x16_bf16 v[80:95], a[20:23], a[16:19], v[80:95]
    v_cvt_pk_bf16_f32 v118, v138, v139
    v_cvt_pk_bf16_f32 v119, v140, v141
    v_cvt_pk_bf16_f32 v120, v142, -v143
    v_cvt_pk_bf16_f32 v121, v144, v145
    v_cvt_pk_bf16_f32 v122, v146, v147
    v_cvt_pk_bf16_f32 v123, v148, v149
    v_cvt_pk_bf16_f32 v124, v150, -v151
    v_cvt_pk_bf16_f32 v125, v152, v153
    v_mfma_f32_32x32x16_bf16 v[80:95], a[28:31], a[24:27], v[80:95]
    ds_write_addtid_b32 v118 offset:2176
    ds_write_addtid_b32 v119 offset:1360
    ds_write_addtid_b32 v120 offset:9520
    ds_write_addtid_b32 v121 offset:1632
    ds_write_addtid_b32 v122 offset:4352
    ds_write_addtid_b32 v123 offset:1904
    ds_write_addtid_b32 v124 offset:9792
    ds_write_addtid_b32 v125 offset:2448
    v_pk_mul_f32 v[108:109], v[146:147], v[146:147] op_sel:[0,0] op_sel_hi:[1,0]
    v_pk_mul_f32 v[110:111], v[138:139], v[128:129] op_sel:[0,0] op_sel_hi:[1,0]
    v_pk_mul_f32 v[112:113], v[150:151], v[104:105] op_sel:[0,0] op_sel_hi:[1,0]
    v_pk_mul_f32 v[114:115], v[138:139], v[134:135] op_sel:[0,0] op_sel_hi:[1,0]
    v_pk_fma_f32 v[154:155], v[146:147], v[146:147], v[108:109] op_sel:[1,1,0] op_sel_hi:[0,1,1] neg_lo:[1,0,0]
    v_pk_fma_f32 v[156:157], v[138:139], v[128:129], v[110:111] op_sel:[1,1,0] op_sel_hi:[0,1,1] neg_lo:[1,0,0]
    v_pk_fma_f32 v[158:159], v[150:151], v[104:105], v[112:113] op_sel:[1,1,0] op_sel_hi:[0,1,1] neg_lo:[1,0,0]
    v_pk_fma_f32 v[160:161], v[138:139], v[134:135], v[114:115] op_sel:[1,1,0] op_sel_hi:[0,1,1] neg_lo:[1,0,0]
    v_pk_mul_f32 v[108:109], v[106:107], v[154:155] op_sel:[0,0] op_sel_hi:[1,0]
    v_pk_mul_f32 v[110:111], v[138:139], v[132:133] op_sel:[0,0] op_sel_hi:[1,0]
    v_pk_mul_f32 v[112:113], v[158:159], v[104:105] op_sel:[0,0] op_sel_hi:[1,0]
    v_pk_mul_f32 v[114:115], v[138:139], v[140:141] op_sel:[0,0] op_sel_hi:[1,0]
    v_pk_fma_f32 v[162:163], v[106:107], v[154:155], v[108:109] op_sel:[1,1,0] op_sel_hi:[0,1,1] neg_lo:[1,0,0]
    v_pk_fma_f32 v[164:165], v[138:139], v[132:133], v[110:111] op_sel:[1,1,0] op_sel_hi:[0,1,1] neg_lo:[1,0,0]
    v_pk_fma_f32 v[166:167], v[158:159], v[104:105], v[112:113] op_sel:[1,1,0] op_sel_hi:[0,1,1] neg_lo:[1,0,0]
    v_pk_fma_f32 v[168:169], v[138:139], v[140:141], v[114:115] op_sel:[1,1,0] op_sel_hi:[0,1,1] neg_lo:[1,0,0]
    v_mfma_f32_32x32x16_bf16 v[80:95], a[36:39], a[32:35], v[80:95]
    v_cvt_pk_bf16_f32 v118, v156, v157
    v_cvt_pk_bf16_f32 v119, v158, -v159
    v_cvt_pk_bf16_f32 v120, v160, v161
    v_cvt_pk_bf16_f32 v121, v162, -v163
    v_cvt_pk_bf16_f32 v122, v164, v165
    v_cvt_pk_bf16_f32 v123, v166, -v167
    v_cvt_pk_bf16_f32 v124, v168, v169
    v_mfma_f32_32x32x16_bf16 v[80:95], a[44:47], a[40:43], v[80:95]
    ds_write_addtid_b32 v118 offset:2720
    ds_write_addtid_b32 v119 offset:10064
    ds_write_addtid_b32 v120 offset:2992
    ds_write_addtid_b32 v121 offset:10880
    ds_write_addtid_b32 v122 offset:3264
    ds_write_addtid_b32 v123 offset:10336
    ds_write_addtid_b32 v124 offset:3536
    v_pk_mul_f32 v[108:109], v[162:163], v[154:155] op_sel:[0,0] op_sel_hi:[1,0]
    v_pk_mul_f32 v[110:111], v[150:151], v[154:155] op_sel:[0,0] op_sel_hi:[1,0]
    v_pk_mul_f32 v[112:113], v[166:167], v[104:105] op_sel:[0,0] op_sel_hi:[1,0]
    v_pk_mul_f32 v[114:115], v[138:139], v[144:145] op_sel:[0,0] op_sel_hi:[1,0]
    v_pk_fma_f32 v[170:171], v[162:163], v[154:155], v[108:109] op_sel:[1,1,0] op_sel_hi:[0,1,1] neg_lo:[1,0,0]
    v_pk_fma_f32 v[172:173], v[150:151], v[154:155], v[110:111] op_sel:[1,1,0] op_sel_hi:[0,1,1] neg_lo:[1,0,0]
    v_pk_fma_f32 v[174:175], v[166:167], v[104:105], v[112:113] op_sel:[1,1,0] op_sel_hi:[0,1,1] neg_lo:[1,0,0]
    v_pk_fma_f32 v[176:177], v[138:139], v[144:145], v[114:115] op_sel:[1,1,0] op_sel_hi:[0,1,1] neg_lo:[1,0,0]
    v_pk_mul_f32 v[108:109], v[170:171], v[154:155] op_sel:[0,0] op_sel_hi:[1,0]
    v_pk_mul_f32 v[110:111], v[172:173], v[154:155] op_sel:[0,0] op_sel_hi:[1,0]
    v_pk_mul_f32 v[112:113], v[136:137], v[154:155] op_sel:[0,0] op_sel_hi:[1,0]
    v_pk_mul_f32 v[114:115], v[138:139], v[148:149] op_sel:[0,0] op_sel_hi:[1,0]
    v_pk_fma_f32 v[178:179], v[170:171], v[154:155], v[108:109] op_sel:[1,1,0] op_sel_hi:[0,1,1] neg_lo:[1,0,0]
    v_pk_fma_f32 v[180:181], v[172:173], v[154:155], v[110:111] op_sel:[1,1,0] op_sel_hi:[0,1,1] neg_lo:[1,0,0]
    v_pk_fma_f32 v[182:183], v[136:137], v[154:155], v[112:113] op_sel:[1,1,0] op_sel_hi:[0,1,1] neg_lo:[1,0,0]
    v_pk_fma_f32 v[184:185], v[138:139], v[148:149], v[114:115] op_sel:[1,1,0] op_sel_hi:[0,1,1] neg_lo:[1,0,0]
    v_mfma_f32_32x32x16_bf16 v[80:95], a[52:55], a[48:51], v[80:95]
    v_cvt_pk_bf16_f32 v118, v170, -v171
    v_cvt_pk_bf16_f32 v119, v172, -v173
    v_cvt_pk_bf16_f32 v120, v174, -v175
    v_cvt_pk_bf16_f32 v121, v176, v177
    v_cvt_pk_bf16_f32 v122, v178, -v179
    v_cvt_pk_bf16_f32 v123, v180, -v181
    v_cvt_pk_bf16_f32 v124, v182, -v183
    v_cvt_pk_bf16_f32 v125, v184, v185
    v_mfma_f32_32x32x16_bf16 v[80:95], a[60:63], a[56:59], v[80:95]
    ds_write_addtid_b32 v118 offset:12512
    ds_write_addtid_b32 v119 offset:11424
    ds_write_addtid_b32 v119 offset:11696
    ds_write_addtid_b32 v120 offset:10608
    ds_write_addtid_b32 v121 offset:3808
    ds_write_addtid_b32 v122 offset:13328
    ds_write_addtid_b32 v123 offset:12784
    ds_write_addtid_b32 v124 offset:11152
    ds_write_addtid_b32 v125 offset:4080
    v_pk_mul_f32 v[108:109], v[178:179], v[154:155] op_sel:[0,0] op_sel_hi:[1,0]
    v_pk_mul_f32 v[110:111], v[180:181], v[154:155] op_sel:[0,0] op_sel_hi:[1,0]
    v_pk_mul_f32 v[112:113], v[166:167], v[154:155] op_sel:[0,0] op_sel_hi:[1,0]
    v_pk_mul_f32 v[114:115], v[146:147], v[102:103] op_sel:[0,0] op_sel_hi:[1,0]
    v_pk_fma_f32 v[186:187], v[178:179], v[154:155], v[108:109] op_sel:[1,1,0] op_sel_hi:[0,1,1] neg_lo:[1,0,0]
    v_pk_fma_f32 v[188:189], v[180:181], v[154:155], v[110:111] op_sel:[1,1,0] op_sel_hi:[0,1,1] neg_lo:[1,0,0]
    v_pk_fma_f32 v[130:131], v[166:167], v[154:155], v[112:113] op_sel:[1,1,0] op_sel_hi:[0,1,1] neg_lo:[1,0,0]
    v_pk_fma_f32 v[142:143], v[146:147], v[102:103], v[114:115] op_sel:[1,1,0] op_sel_hi:[0,1,1] neg_lo:[1,0,0]
    v_pk_mul_f32 v[108:109], v[186:187], v[154:155] op_sel:[0,0] op_sel_hi:[1,0]
    v_pk_mul_f32 v[110:111], v[146:147], v[128:129] op_sel:[0,0] op_sel_hi:[1,0]
    v_pk_mul_f32 v[112:113], v[146:147], v[134:135] op_sel:[0,0] op_sel_hi:[1,0]
    v_pk_mul_f32 v[114:115], v[146:147], v[132:133] op_sel:[0,0] op_sel_hi:[1,0]
    v_pk_fma_f32 v[158:159], v[186:187], v[154:155], v[108:109] op_sel:[1,1,0] op_sel_hi:[0,1,1] neg_lo:[1,0,0]
    v_pk_fma_f32 v[136:137], v[146:147], v[128:129], v[110:111] op_sel:[1,1,0] op_sel_hi:[0,1,1] neg_lo:[1,0,0]
    v_pk_fma_f32 v[150:151], v[146:147], v[134:135], v[112:113] op_sel:[1,1,0] op_sel_hi:[0,1,1] neg_lo:[1,0,0]
    v_pk_fma_f32 v[172:173], v[146:147], v[132:133], v[114:115] op_sel:[1,1,0] op_sel_hi:[0,1,1] neg_lo:[1,0,0]
    v_cvt_pk_bf16_f32 v118, v186, -v187
    v_cvt_pk_bf16_f32 v119, v188, -v189
    v_cvt_pk_bf16_f32 v120, v130, -v131
    v_cvt_pk_bf16_f32 v121, v142, v143
    v_cvt_pk_bf16_f32 v122, v158, -v159
    v_cvt_pk_bf16_f32 v123, v136, v137
    v_cvt_pk_bf16_f32 v124, v150, v151
    v_cvt_pk_bf16_f32 v125, v172, v173
    ds_write_addtid_b32 v118 offset:14144
    ds_write_addtid_b32 v119 offset:13600
    ds_write_addtid_b32 v120 offset:11968
    ds_write_addtid_b32 v121 offset:4624
    ds_write_addtid_b32 v122 offset:14416
    ds_write_addtid_b32 v123 offset:4896
    ds_write_addtid_b32 v124 offset:5168
    ds_write_addtid_b32 v125 offset:5440
    v_pk_mul_f32 v[108:109], v[158:159], v[154:155] op_sel:[0,0] op_sel_hi:[1,0]
    v_pk_mul_f32 v[110:111], v[146:147], v[140:141] op_sel:[0,0] op_sel_hi:[1,0]
    v_pk_mul_f32 v[112:113], v[146:147], v[144:145] op_sel:[0,0] op_sel_hi:[1,0]
    v_pk_mul_f32 v[114:115], v[146:147], v[148:149] op_sel:[0,0] op_sel_hi:[1,0]
    v_pk_fma_f32 v[174:175], v[158:159], v[154:155], v[108:109] op_sel:[1,1,0] op_sel_hi:[0,1,1] neg_lo:[1,0,0]
    v_pk_fma_f32 v[182:183], v[146:147], v[140:141], v[110:111] op_sel:[1,1,0] op_sel_hi:[0,1,1] neg_lo:[1,0,0]
    v_pk_fma_f32 v[128:129], v[146:147], v[144:145], v[112:113] op_sel:[1,1,0] op_sel_hi:[0,1,1] neg_lo:[1,0,0]
    v_pk_fma_f32 v[132:133], v[146:147], v[148:149], v[114:115] op_sel:[1,1,0] op_sel_hi:[0,1,1] neg_lo:[1,0,0]
    v_pk_mul_f32 v[108:109], v[174:175], v[154:155] op_sel:[0,0] op_sel_hi:[1,0]
    v_pk_mul_f32 v[110:111], v[146:147], v[138:139] op_sel:[0,0] op_sel_hi:[1,0]
    v_pk_mul_f32 v[112:113], v[146:147], v[152:153] op_sel:[0,0] op_sel_hi:[1,0]
    v_pk_mul_f32 v[114:115], v[146:147], v[156:157] op_sel:[0,0] op_sel_hi:[1,0]
    v_pk_fma_f32 v[134:135], v[174:175], v[154:155], v[108:109] op_sel:[1,1,0] op_sel_hi:[0,1,1] neg_lo:[1,0,0]
    v_pk_fma_f32 v[166:167], v[146:147], v[138:139], v[110:111] op_sel:[1,1,0] op_sel_hi:[0,1,1] neg_lo:[1,0,0]
    v_pk_fma_f32 v[180:181], v[146:147], v[152:153], v[112:113] op_sel:[1,1,0] op_sel_hi:[0,1,1] neg_lo:[1,0,0]
    v_pk_fma_f32 v[186:187], v[146:147], v[156:157], v[114:115] op_sel:[1,1,0] op_sel_hi:[0,1,1] neg_lo:[1,0,0]
    v_cvt_pk_bf16_f32 v118, v174, -v175
    v_cvt_pk_bf16_f32 v119, v182, v183
    v_cvt_pk_bf16_f32 v120, v128, v129
    v_cvt_pk_bf16_f32 v121, v132, v133
    v_cvt_pk_bf16_f32 v122, v134, -v135
    v_cvt_pk_bf16_f32 v123, v166, v167
    v_cvt_pk_bf16_f32 v124, v180, v181
    v_cvt_pk_bf16_f32 v125, v186, v187
    ds_write_addtid_b32 v118 offset:14960
    ds_write_addtid_b32 v119 offset:5712
    ds_write_addtid_b32 v120 offset:5984
    ds_write_addtid_b32 v121 offset:6256
    ds_write_addtid_b32 v122 offset:15232
    ds_write_addtid_b32 v123 offset:6528
    ds_write_addtid_b32 v124 offset:6800
    ds_write_addtid_b32 v125 offset:7072
    v_pk_mul_f32 v[108:109], v[134:135], v[154:155] op_sel:[0,0] op_sel_hi:[1,0]
    v_pk_mul_f32 v[110:111], v[146:147], v[160:161] op_sel:[0,0] op_sel_hi:[1,0]
    v_pk_mul_f32 v[112:113], v[146:147], v[164:165] op_sel:[0,0] op_sel_hi:[1,0]
    v_pk_mul_f32 v[114:115], v[146:147], v[168:169] op_sel:[0,0] op_sel_hi:[1,0]
    v_pk_mul_f32 v[116:117], v[178:179], v[102:103] op_sel:[0,0] op_sel_hi:[1,0]
    v_pk_fma_f32 v[188:189], v[134:135], v[154:155], v[108:109] op_sel:[1,1,0] op_sel_hi:[0,1,1] neg_lo:[1,0,0]
    v_pk_fma_f32 v[130:131], v[146:147], v[160:161], v[110:111] op_sel:[1,1,0] op_sel_hi:[0,1,1] neg_lo:[1,0,0]
    v_pk_fma_f32 v[142:143], v[146:147], v[164:165], v[112:113] op_sel:[1,1,0] op_sel_hi:[0,1,1] neg_lo:[1,0,0]
    v_pk_fma_f32 v[136:137], v[146:147], v[168:169], v[114:115] op_sel:[1,1,0] op_sel_hi:[0,1,1] neg_lo:[1,0,0]
    v_pk_fma_f32 v[150:151], v[178:179], v[102:103], v[116:117] op_sel:[1,1,0] op_sel_hi:[0,1,1] neg_lo:[1,0,0]
    v_pk_mul_f32 v[108:109], v[146:147], v[176:177] op_sel:[0,0] op_sel_hi:[1,0]
    v_pk_mul_f32 v[110:111], v[146:147], v[184:185] op_sel:[0,0] op_sel_hi:[1,0]
    v_pk_mul_f32 v[112:113], v[162:163], v[102:103] op_sel:[0,0] op_sel_hi:[1,0]
    v_pk_mul_f32 v[114:115], v[170:171], v[102:103] op_sel:[0,0] op_sel_hi:[1,0]
    v_pk_fma_f32 v[172:173], v[146:147], v[176:177], v[108:109] op_sel:[1,1,0] op_sel_hi:[0,1,1] neg_lo:[1,0,0]
    v_pk_fma_f32 v[138:139], v[146:147], v[184:185], v[110:111] op_sel:[1,1,0] op_sel_hi:[0,1,1] neg_lo:[1,0,0]
    v_pk_fma_f32 v[140:141], v[162:163], v[102:103], v[112:113] op_sel:[1,1,0] op_sel_hi:[0,1,1] neg_lo:[1,0,0]
    v_pk_fma_f32 v[144:145], v[170:171], v[102:103], v[114:115] op_sel:[1,1,0] op_sel_hi:[0,1,1] neg_lo:[1,0,0]
    v_cvt_pk_bf16_f32 v118, v188, -v189
    v_cvt_pk_bf16_f32 v119, v130, v131
    v_cvt_pk_bf16_f32 v120, v142, v143
    v_cvt_pk_bf16_f32 v121, v136, v137
    v_cvt_pk_bf16_f32 v122, v150, -v151
    v_cvt_pk_bf16_f32 v123, v172, v173
    v_cvt_pk_bf16_f32 v124, v138, v139
    v_cvt_pk_bf16_f32 v125, v140, -v141
    v_cvt_pk_bf16_f32 v126, v144, -v145
    ds_write_addtid_b32 v118 offset:15504
    ds_write_addtid_b32 v119 offset:7344
    ds_write_addtid_b32 v120 offset:7616
    ds_write_addtid_b32 v121 offset:7888
    ds_write_addtid_b32 v122 offset:13872
    ds_write_addtid_b32 v123 offset:8160
    ds_write_addtid_b32 v124 offset:8432
    ds_write_addtid_b32 v125 offset:12240
    ds_write_addtid_b32 v126 offset:13056
    ds_read_b128 a[0:3], v68 offset:0
    ds_read_b128 a[4:7], v69 offset:0
    ds_read_b128 a[8:11], v68 offset:32
    ds_read_b128 a[12:15], v69 offset:32
    ds_read_b128 a[16:19], v68 offset:64
    ds_read_b128 a[20:23], v69 offset:64
    ds_read_b128 a[24:27], v68 offset:96
    ds_read_b128 a[28:31], v69 offset:96
    ds_read_b128 a[32:35], v68 offset:128
    ds_read_b128 a[36:39], v69 offset:128
    ds_read_b128 a[40:43], v68 offset:160
    ds_read_b128 a[44:47], v69 offset:160
    ds_read_b128 a[48:51], v68 offset:192
    ds_read_b128 a[52:55], v69 offset:192
    ds_read_b128 a[56:59], v68 offset:224
    ds_read_b128 a[60:63], v69 offset:224
    s_waitcnt vmcnt(0)
    s_nop 0
    v_pk_mul_f32 v[198:199], v[56:57], v[54:55] op_sel_hi:[1,0]
    v_pk_mul_f32 v[208:209], v[58:59], v[60:61] op_sel:[0,0] op_sel_hi:[1,0]
    v_pk_mul_f32 v[196:197], v[198:199], s[72:73]
    v_pk_mul_f32 v[198:199], v[198:199], s[74:75]
    v_pk_fma_f32 v[206:207], v[58:59], v[60:61], v[208:209] op_sel:[1,1,0] op_sel_hi:[0,1,1] neg_lo:[1,0,0]
    v_fract_f32 v197, v197
    v_fract_f32 v199, v199
    v_exp_f32 v205, v198
    v_exp_f32 v204, v196
    v_cos_f32 v202, v199
    v_sin_f32 v203, v199
    v_cos_f32 v200, v197
    v_sin_f32 v201, v197
    v_pk_mul_f32 v[96:97], v[202:203], v[204:205] op_sel:[0,1] op_sel_hi:[1,1]
    v_pk_mul_f32 v[100:101], v[206:207], v[54:55] op_sel_hi:[1,0]
    v_pk_mul_f32 v[98:99], v[200:201], v[204:205] op_sel_hi:[1,0]
    s_waitcnt lgkmcnt(0)
    s_nop 0
    v_pk_mul_f32 v[108:109], v[96:97], v[96:97] op_sel:[0,0] op_sel_hi:[1,0]
    v_pk_mul_f32 v[110:111], v[100:101], v[98:99] op_sel:[0,0] op_sel_hi:[1,0]
    v_pk_fma_f32 v[128:129], v[96:97], v[96:97], v[108:109] op_sel:[1,1,0] op_sel_hi:[0,1,1] neg_lo:[1,0,0]
    v_pk_fma_f32 v[130:131], v[100:101], v[98:99], v[110:111] op_sel:[1,1,0] op_sel_hi:[0,1,1] neg_lo:[1,0,0]
    v_pk_mul_f32 v[108:109], v[128:129], v[128:129] op_sel:[0,0] op_sel_hi:[1,0]
    v_pk_mul_f32 v[110:111], v[128:129], v[96:97] op_sel:[0,0] op_sel_hi:[1,0]
    v_pk_mul_f32 v[112:113], v[130:131], v[98:99] op_sel:[0,0] op_sel_hi:[1,0]
    v_pk_fma_f32 v[132:133], v[128:129], v[128:129], v[108:109] op_sel:[1,1,0] op_sel_hi:[0,1,1] neg_lo:[1,0,0]
    v_pk_fma_f32 v[134:135], v[128:129], v[96:97], v[110:111] op_sel:[1,1,0] op_sel_hi:[0,1,1] neg_lo:[1,0,0]
    v_pk_fma_f32 v[136:137], v[130:131], v[98:99], v[112:113] op_sel:[1,1,0] op_sel_hi:[0,1,1] neg_lo:[1,0,0]
    v_mfma_f32_32x32x16_bf16 v[80:95], a[4:7], a[0:3], v[80:95]
    v_cvt_pk_bf16_f32 v118, v100, -v101
    v_cvt_pk_bf16_f32 v119, v96, v97
    v_cvt_pk_bf16_f32 v120, v128, v129
    v_cvt_pk_bf16_f32 v121, v130, -v131
    v_cvt_pk_bf16_f32 v122, v132, v133
    v_cvt_pk_bf16_f32 v123, v134, v135
    v_cvt_pk_bf16_f32 v124, v136, -v137
    v_mfma_f32_32x32x16_bf16 v[80:95], a[12:15], a[8:11], v[80:95]
    ds_write_addtid_b32 v118 offset:8704
    ds_write_addtid_b32 v119 offset:272
    ds_write_addtid_b32 v120 offset:544
    ds_write_addtid_b32 v121 offset:8976
    ds_write_addtid_b32 v122 offset:1088
    ds_write_addtid_b32 v123 offset:816
    ds_write_addtid_b32 v124 offset:9248
    v_pk_mul_f32 v[108:109], v[132:133], v[132:133] op_sel:[0,0] op_sel_hi:[1,0]
    v_pk_mul_f32 v[110:111], v[132:133], v[96:97] op_sel:[0,0] op_sel_hi:[1,0]
    v_pk_mul_f32 v[112:113], v[136:137], v[98:99] op_sel:[0,0] op_sel_hi:[1,0]
    v_pk_mul_f32 v[114:115], v[132:133], v[128:129] op_sel:[0,0] op_sel_hi:[1,0]
    v_pk_fma_f32 v[138:139], v[132:133], v[132:133], v[108:109] op_sel:[1,1,0] op_sel_hi:[0,1,1] neg_lo:[1,0,0]
    v_pk_fma_f32 v[140:141], v[132:133], v[96:97], v[110:111] op_sel:[1,1,0] op_sel_hi:[0,1,1] neg_lo:[1,0,0]
    v_pk_fma_f32 v[142:143], v[136:137], v[98:99], v[112:113] op_sel:[1,1,0] op_sel_hi:[0,1,1] neg_lo:[1,0,0]
    v_pk_fma_f32 v[144:145], v[132:133], v[128:129], v[114:115] op_sel:[1,1,0] op_sel_hi:[0,1,1] neg_lo:[1,0,0]
    v_pk_mul_f32 v[108:109], v[138:139], v[138:139] op_sel:[0,0] op_sel_hi:[1,0]
    v_pk_mul_f32 v[110:111], v[132:133], v[134:135] op_sel:[0,0] op_sel_hi:[1,0]
    v_pk_mul_f32 v[112:113], v[142:143], v[98:99] op_sel:[0,0] op_sel_hi:[1,0]
    v_pk_mul_f32 v[114:115], v[138:139], v[96:97] op_sel:[0,0] op_sel_hi:[1,0]
    v_pk_fma_f32 v[146:147], v[138:139], v[138:139], v[108:109] op_sel:[1,1,0] op_sel_hi:[0,1,1] neg_lo:[1,0,0]
    v_pk_fma_f32 v[148:149], v[132:133], v[134:135], v[110:111] op_sel:[1,1,0] op_sel_hi:[0,1,1] neg_lo:[1,0,0]
    v_pk_fma_f32 v[150:151], v[142:143], v[98:99], v[112:113] op_sel:[1,1,0] op_sel_hi:[0,1,1] neg_lo:[1,0,0]
    v_pk_fma_f32 v[152:153], v[138:139], v[96:97], v[114:115] op_sel:[1,1,0] op_sel_hi:[0,1,1] neg_lo:[1,0,0]
    v_mfma_f32_32x32x16_bf16 v[80:95], a[20:23], a[16:19], v[80:95]
    v_cvt_pk_bf16_f32 v118, v138, v139
    v_cvt_pk_bf16_f32 v119, v140, v141
    v_cvt_pk_bf16_f32 v120, v142, -v143
    v_cvt_pk_bf16_f32 v121, v144, v145
    v_cvt_pk_bf16_f32 v122, v146, v147
    v_cvt_pk_bf16_f32 v123, v148, v149
    v_cvt_pk_bf16_f32 v124, v150, -v151
    v_cvt_pk_bf16_f32 v125, v152, v153
    v_mfma_f32_32x32x16_bf16 v[80:95], a[28:31], a[24:27], v[80:95]
    ds_write_addtid_b32 v118 offset:2176
    ds_write_addtid_b32 v119 offset:1360
    ds_write_addtid_b32 v120 offset:9520
    ds_write_addtid_b32 v121 offset:1632
    ds_write_addtid_b32 v122 offset:4352
    ds_write_addtid_b32 v123 offset:1904
    ds_write_addtid_b32 v124 offset:9792
    ds_write_addtid_b32 v125 offset:2448
    v_pk_mul_f32 v[108:109], v[146:147], v[146:147] op_sel:[0,0] op_sel_hi:[1,0]
    v_pk_mul_f32 v[110:111], v[138:139], v[128:129] op_sel:[0,0] op_sel_hi:[1,0]
    v_pk_mul_f32 v[112:113], v[150:151], v[98:99] op_sel:[0,0] op_sel_hi:[1,0]
    v_pk_mul_f32 v[114:115], v[138:139], v[134:135] op_sel:[0,0] op_sel_hi:[1,0]
    v_pk_fma_f32 v[154:155], v[146:147], v[146:147], v[108:109] op_sel:[1,1,0] op_sel_hi:[0,1,1] neg_lo:[1,0,0]
    v_pk_fma_f32 v[156:157], v[138:139], v[128:129], v[110:111] op_sel:[1,1,0] op_sel_hi:[0,1,1] neg_lo:[1,0,0]
    v_pk_fma_f32 v[158:159], v[150:151], v[98:99], v[112:113] op_sel:[1,1,0] op_sel_hi:[0,1,1] neg_lo:[1,0,0]
    v_pk_fma_f32 v[160:161], v[138:139], v[134:135], v[114:115] op_sel:[1,1,0] op_sel_hi:[0,1,1] neg_lo:[1,0,0]
    v_pk_mul_f32 v[108:109], v[100:101], v[154:155] op_sel:[0,0] op_sel_hi:[1,0]
    v_pk_mul_f32 v[110:111], v[138:139], v[132:133] op_sel:[0,0] op_sel_hi:[1,0]
    v_pk_mul_f32 v[112:113], v[158:159], v[98:99] op_sel:[0,0] op_sel_hi:[1,0]
    v_pk_mul_f32 v[114:115], v[138:139], v[140:141] op_sel:[0,0] op_sel_hi:[1,0]
    v_pk_fma_f32 v[162:163], v[100:101], v[154:155], v[108:109] op_sel:[1,1,0] op_sel_hi:[0,1,1] neg_lo:[1,0,0]
    v_pk_fma_f32 v[164:165], v[138:139], v[132:133], v[110:111] op_sel:[1,1,0] op_sel_hi:[0,1,1] neg_lo:[1,0,0]
    v_pk_fma_f32 v[166:167], v[158:159], v[98:99], v[112:113] op_sel:[1,1,0] op_sel_hi:[0,1,1] neg_lo:[1,0,0]
    v_pk_fma_f32 v[168:169], v[138:139], v[140:141], v[114:115] op_sel:[1,1,0] op_sel_hi:[0,1,1] neg_lo:[1,0,0]
    v_mfma_f32_32x32x16_bf16 v[80:95], a[36:39], a[32:35], v[80:95]
    v_cvt_pk_bf16_f32 v118, v156, v157
    v_cvt_pk_bf16_f32 v119, v158, -v159
    v_cvt_pk_bf16_f32 v120, v160, v161
    v_cvt_pk_bf16_f32 v121, v162, -v163
    v_cvt_pk_bf16_f32 v122, v164, v165
    v_cvt_pk_bf16_f32 v123, v166, -v167
    v_cvt_pk_bf16_f32 v124, v168, v169
    v_mfma_f32_32x32x16_bf16 v[80:95], a[44:47], a[40:43], v[80:95]
    ds_write_addtid_b32 v118 offset:2720
    ds_write_addtid_b32 v119 offset:10064
    ds_write_addtid_b32 v120 offset:2992
    ds_write_addtid_b32 v121 offset:10880
    ds_write_addtid_b32 v122 offset:3264
    ds_write_addtid_b32 v123 offset:10336
    ds_write_addtid_b32 v124 offset:3536
    v_pk_mul_f32 v[108:109], v[162:163], v[154:155] op_sel:[0,0] op_sel_hi:[1,0]
    v_pk_mul_f32 v[110:111], v[150:151], v[154:155] op_sel:[0,0] op_sel_hi:[1,0]
    v_pk_mul_f32 v[112:113], v[166:167], v[98:99] op_sel:[0,0] op_sel_hi:[1,0]
    v_pk_mul_f32 v[114:115], v[138:139], v[144:145] op_sel:[0,0] op_sel_hi:[1,0]
    v_pk_fma_f32 v[170:171], v[162:163], v[154:155], v[108:109] op_sel:[1,1,0] op_sel_hi:[0,1,1] neg_lo:[1,0,0]
    v_pk_fma_f32 v[172:173], v[150:151], v[154:155], v[110:111] op_sel:[1,1,0] op_sel_hi:[0,1,1] neg_lo:[1,0,0]
    v_pk_fma_f32 v[174:175], v[166:167], v[98:99], v[112:113] op_sel:[1,1,0] op_sel_hi:[0,1,1] neg_lo:[1,0,0]
    v_pk_fma_f32 v[176:177], v[138:139], v[144:145], v[114:115] op_sel:[1,1,0] op_sel_hi:[0,1,1] neg_lo:[1,0,0]
    v_pk_mul_f32 v[108:109], v[170:171], v[154:155] op_sel:[0,0] op_sel_hi:[1,0]
    v_pk_mul_f32 v[110:111], v[172:173], v[154:155] op_sel:[0,0] op_sel_hi:[1,0]
    v_pk_mul_f32 v[112:113], v[136:137], v[154:155] op_sel:[0,0] op_sel_hi:[1,0]
    v_pk_mul_f32 v[114:115], v[138:139], v[148:149] op_sel:[0,0] op_sel_hi:[1,0]
    v_pk_fma_f32 v[178:179], v[170:171], v[154:155], v[108:109] op_sel:[1,1,0] op_sel_hi:[0,1,1] neg_lo:[1,0,0]
    v_pk_fma_f32 v[180:181], v[172:173], v[154:155], v[110:111] op_sel:[1,1,0] op_sel_hi:[0,1,1] neg_lo:[1,0,0]
    v_pk_fma_f32 v[182:183], v[136:137], v[154:155], v[112:113] op_sel:[1,1,0] op_sel_hi:[0,1,1] neg_lo:[1,0,0]
L_padK1:
    s_cbranch_execz L_backK
    s_nop 0
    v_pk_fma_f32 v[184:185], v[138:139], v[148:149], v[114:115] op_sel:[1,1,0] op_sel_hi:[0,1,1] neg_lo:[1,0,0]
    v_mfma_f32_32x32x16_bf16 v[80:95], a[52:55], a[48:51], v[80:95]
    v_cvt_pk_bf16_f32 v118, v170, -v171
    v_cvt_pk_bf16_f32 v119, v172, -v173
    v_cvt_pk_bf16_f32 v120, v174, -v175
    v_cvt_pk_bf16_f32 v121, v176, v177
    v_cvt_pk_bf16_f32 v122, v178, -v179
    v_cvt_pk_bf16_f32 v123, v180, -v181
    v_cvt_pk_bf16_f32 v124, v182, -v183
    v_cvt_pk_bf16_f32 v125, v184, v185
    v_mfma_f32_32x32x16_bf16 v[80:95], a[60:63], a[56:59], v[80:95]
    ds_write_addtid_b32 v118 offset:12512
    ds_write_addtid_b32 v119 offset:11424
    ds_write_addtid_b32 v119 offset:11696
    ds_write_addtid_b32 v120 offset:10608
    ds_write_addtid_b32 v121 offset:3808
    ds_write_addtid_b32 v122 offset:13328
    ds_write_addtid_b32 v123 offset:12784
    ds_write_addtid_b32 v124 offset:11152
    ds_write_addtid_b32 v125 offset:4080
    v_pk_mul_f32 v[108:109], v[178:179], v[154:155] op_sel:[0,0] op_sel_hi:[1,0]
    v_pk_mul_f32 v[110:111], v[180:181], v[154:155] op_sel:[0,0] op_sel_hi:[1,0]
    v_pk_mul_f32 v[112:113], v[166:167], v[154:155] op_sel:[0,0] op_sel_hi:[1,0]
    v_pk_mul_f32 v[114:115], v[146:147], v[96:97] op_sel:[0,0] op_sel_hi:[1,0]
    v_pk_fma_f32 v[186:187], v[178:179], v[154:155], v[108:109] op_sel:[1,1,0] op_sel_hi:[0,1,1] neg_lo:[1,0,0]
    v_pk_fma_f32 v[188:189], v[180:181], v[154:155], v[110:111] op_sel:[1,1,0] op_sel_hi:[0,1,1] neg_lo:[1,0,0]
    v_pk_fma_f32 v[130:131], v[166:167], v[154:155], v[112:113] op_sel:[1,1,0] op_sel_hi:[0,1,1] neg_lo:[1,0,0]
    v_pk_fma_f32 v[142:143], v[146:147], v[96:97], v[114:115] op_sel:[1,1,0] op_sel_hi:[0,1,1] neg_lo:[1,0,0]
    v_pk_mul_f32 v[108:109], v[186:187], v[154:155] op_sel:[0,0] op_sel_hi:[1,0]
    v_pk_mul_f32 v[110:111], v[146:147], v[128:129] op_sel:[0,0] op_sel_hi:[1,0]
    v_pk_mul_f32 v[112:113], v[146:147], v[134:135] op_sel:[0,0] op_sel_hi:[1,0]
    v_pk_mul_f32 v[114:115], v[146:147], v[132:133] op_sel:[0,0] op_sel_hi:[1,0]
    v_pk_fma_f32 v[158:159], v[186:187], v[154:155], v[108:109] op_sel:[1,1,0] op_sel_hi:[0,1,1] neg_lo:[1,0,0]
    v_pk_fma_f32 v[136:137], v[146:147], v[128:129], v[110:111] op_sel:[1,1,0] op_sel_hi:[0,1,1] neg_lo:[1,0,0]
    v_pk_fma_f32 v[150:151], v[146:147], v[134:135], v[112:113] op_sel:[1,1,0] op_sel_hi:[0,1,1] neg_lo:[1,0,0]
    v_pk_fma_f32 v[172:173], v[146:147], v[132:133], v[114:115] op_sel:[1,1,0] op_sel_hi:[0,1,1] neg_lo:[1,0,0]
    v_cvt_pk_bf16_f32 v118, v186, -v187
    v_cvt_pk_bf16_f32 v119, v188, -v189
    v_cvt_pk_bf16_f32 v120, v130, -v131
    v_cvt_pk_bf16_f32 v121, v142, v143
    v_cvt_pk_bf16_f32 v122, v158, -v159
    v_cvt_pk_bf16_f32 v123, v136, v137
    v_cvt_pk_bf16_f32 v124, v150, v151
    v_cvt_pk_bf16_f32 v125, v172, v173
    ds_write_addtid_b32 v118 offset:14144
    ds_write_addtid_b32 v119 offset:13600
    ds_write_addtid_b32 v120 offset:11968
    ds_write_addtid_b32 v121 offset:4624
    ds_write_addtid_b32 v122 offset:14416
    ds_write_addtid_b32 v123 offset:4896
    ds_write_addtid_b32 v124 offset:5168
    ds_write_addtid_b32 v125 offset:5440
    v_pk_mul_f32 v[108:109], v[158:159], v[154:155] op_sel:[0,0] op_sel_hi:[1,0]
    v_pk_mul_f32 v[110:111], v[146:147], v[140:141] op_sel:[0,0] op_sel_hi:[1,0]
    v_pk_mul_f32 v[112:113], v[146:147], v[144:145] op_sel:[0,0] op_sel_hi:[1,0]
    v_pk_mul_f32 v[114:115], v[146:147], v[148:149] op_sel:[0,0] op_sel_hi:[1,0]
    v_pk_fma_f32 v[174:175], v[158:159], v[154:155], v[108:109] op_sel:[1,1,0] op_sel_hi:[0,1,1] neg_lo:[1,0,0]
    v_pk_fma_f32 v[182:183], v[146:147], v[140:141], v[110:111] op_sel:[1,1,0] op_sel_hi:[0,1,1] neg_lo:[1,0,0]
    v_pk_fma_f32 v[128:129], v[146:147], v[144:145], v[112:113] op_sel:[1,1,0] op_sel_hi:[0,1,1] neg_lo:[1,0,0]
    v_pk_fma_f32 v[132:133], v[146:147], v[148:149], v[114:115] op_sel:[1,1,0] op_sel_hi:[0,1,1] neg_lo:[1,0,0]
    v_pk_mul_f32 v[108:109], v[174:175], v[154:155] op_sel:[0,0] op_sel_hi:[1,0]
    v_pk_mul_f32 v[110:111], v[146:147], v[138:139] op_sel:[0,0] op_sel_hi:[1,0]
    v_pk_mul_f32 v[112:113], v[146:147], v[152:153] op_sel:[0,0] op_sel_hi:[1,0]
    v_pk_mul_f32 v[114:115], v[146:147], v[156:157] op_sel:[0,0] op_sel_hi:[1,0]
    v_pk_fma_f32 v[134:135], v[174:175], v[154:155], v[108:109] op_sel:[1,1,0] op_sel_hi:[0,1,1] neg_lo:[1,0,0]
    v_pk_fma_f32 v[166:167], v[146:147], v[138:139], v[110:111] op_sel:[1,1,0] op_sel_hi:[0,1,1] neg_lo:[1,0,0]
    v_pk_fma_f32 v[180:181], v[146:147], v[152:153], v[112:113] op_sel:[1,1,0] op_sel_hi:[0,1,1] neg_lo:[1,0,0]
    v_pk_fma_f32 v[186:187], v[146:147], v[156:157], v[114:115] op_sel:[1,1,0] op_sel_hi:[0,1,1] neg_lo:[1,0,0]
    v_cvt_pk_bf16_f32 v118, v174, -v175
    v_cvt_pk_bf16_f32 v119, v182, v183
    v_cvt_pk_bf16_f32 v120, v128, v129
    v_cvt_pk_bf16_f32 v121, v132, v133
    v_cvt_pk_bf16_f32 v122, v134, -v135
    v_cvt_pk_bf16_f32 v123, v166, v167
    v_cvt_pk_bf16_f32 v124, v180, v181
    v_cvt_pk_bf16_f32 v125, v186, v187
    ds_write_addtid_b32 v118 offset:14960
    ds_write_addtid_b32 v119 offset:5712
    ds_write_addtid_b32 v120 offset:5984
    ds_write_addtid_b32 v121 offset:6256
    ds_write_addtid_b32 v122 offset:15232
    ds_write_addtid_b32 v123 offset:6528
    ds_write_addtid_b32 v124 offset:6800
    ds_write_addtid_b32 v125 offset:7072
    v_pk_mul_f32 v[108:109], v[134:135], v[154:155] op_sel:[0,0] op_sel_hi:[1,0]
    v_pk_mul_f32 v[110:111], v[146:147], v[160:161] op_sel:[0,0] op_sel_hi:[1,0]
    v_pk_mul_f32 v[112:113], v[146:147], v[164:165] op_sel:[0,0] op_sel_hi:[1,0]
    v_pk_mul_f32 v[114:115], v[146:147], v[168:169] op_sel:[0,0] op_sel_hi:[1,0]
    v_pk_mul_f32 v[116:117], v[178:179], v[96:97] op_sel:[0,0] op_sel_hi:[1,0]
    v_pk_fma_f32 v[188:189], v[134:135], v[154:155], v[108:109] op_sel:[1,1,0] op_sel_hi:[0,1,1] neg_lo:[1,0,0]
    v_pk_fma_f32 v[130:131], v[146:147], v[160:161], v[110:111] op_sel:[1,1,0] op_sel_hi:[0,1,1] neg_lo:[1,0,0]
    v_pk_fma_f32 v[142:143], v[146:147], v[164:165], v[112:113] op_sel:[1,1,0] op_sel_hi:[0,1,1] neg_lo:[1,0,0]
    v_pk_fma_f32 v[136:137], v[146:147], v[168:169], v[114:115] op_sel:[1,1,0] op_sel_hi:[0,1,1] neg_lo:[1,0,0]
    v_pk_fma_f32 v[150:151], v[178:179], v[96:97], v[116:117] op_sel:[1,1,0] op_sel_hi:[0,1,1] neg_lo:[1,0,0]
    v_pk_mul_f32 v[108:109], v[146:147], v[176:177] op_sel:[0,0] op_sel_hi:[1,0]
    v_pk_mul_f32 v[110:111], v[146:147], v[184:185] op_sel:[0,0] op_sel_hi:[1,0]
    v_pk_mul_f32 v[112:113], v[162:163], v[96:97] op_sel:[0,0] op_sel_hi:[1,0]
    v_pk_mul_f32 v[114:115], v[170:171], v[96:97] op_sel:[0,0] op_sel_hi:[1,0]
    v_pk_fma_f32 v[172:173], v[146:147], v[176:177], v[108:109] op_sel:[1,1,0] op_sel_hi:[0,1,1] neg_lo:[1,0,0]
    v_pk_fma_f32 v[138:139], v[146:147], v[184:185], v[110:111] op_sel:[1,1,0] op_sel_hi:[0,1,1] neg_lo:[1,0,0]
    v_pk_fma_f32 v[140:141], v[162:163], v[96:97], v[112:113] op_sel:[1,1,0] op_sel_hi:[0,1,1] neg_lo:[1,0,0]
    v_pk_fma_f32 v[144:145], v[170:171], v[96:97], v[114:115] op_sel:[1,1,0] op_sel_hi:[0,1,1] neg_lo:[1,0,0]
    v_cvt_pk_bf16_f32 v118, v188, -v189
    v_cvt_pk_bf16_f32 v119, v130, v131
    v_cvt_pk_bf16_f32 v120, v142, v143
    v_cvt_pk_bf16_f32 v121, v136, v137
    v_cvt_pk_bf16_f32 v122, v150, -v151
    v_cvt_pk_bf16_f32 v123, v172, v173
    v_cvt_pk_bf16_f32 v124, v138, v139
    v_cvt_pk_bf16_f32 v125, v140, -v141
    v_cvt_pk_bf16_f32 v126, v144, -v145
    ds_write_addtid_b32 v118 offset:15504
    ds_write_addtid_b32 v119 offset:7344
    ds_write_addtid_b32 v120 offset:7616
    ds_write_addtid_b32 v121 offset:7888
    ds_write_addtid_b32 v122 offset:13872
    ds_write_addtid_b32 v123 offset:8160
    ds_write_addtid_b32 v124 offset:8432
    ds_write_addtid_b32 v125 offset:12240
    ds_write_addtid_b32 v126 offset:13056
    ds_read_b128 a[0:3], v68 offset:0
    ds_read_b128 a[4:7], v69 offset:0
    ds_read_b128 a[8:11], v68 offset:32
    ds_read_b128 a[12:15], v69 offset:32
    ds_read_b128 a[16:19], v68 offset:64
    ds_read_b128 a[20:23], v69 offset:64
    ds_read_b128 a[24:27], v68 offset:96
    ds_read_b128 a[28:31], v69 offset:96
    ds_read_b128 a[32:35], v68 offset:128
    ds_read_b128 a[36:39], v69 offset:128
    ds_read_b128 a[40:43], v68 offset:160
    ds_read_b128 a[44:47], v69 offset:160
    ds_read_b128 a[48:51], v68 offset:192
    ds_read_b128 a[52:55], v69 offset:192
    ds_read_b128 a[56:59], v68 offset:224
    ds_read_b128 a[60:63], v69 offset:224
    s_waitcnt lgkmcnt(14)
    s_nop 0
    v_mfma_f32_32x32x16_bf16 v[80:95], a[4:7], a[0:3], v[80:95]
    s_mov_b32 s4, 0x10001
    v_mov_b32 v41, 0xfe0
    v_lshlrev_b32 v41, v29, v41
    v_lshlrev_b32 v40, 3, v28
    v_bfe_u32 v41, v41, v40, 8
    v_lshl_or_b32 v41, v41, 15, v41
    s_waitcnt lgkmcnt(12)
    v_mfma_f32_32x32x16_bf16 v[80:95], a[12:15], a[8:11], v[80:95]
    v_mov_b32 v40, v41
    v_and_b32_e64 v40, s4, v40
    v_mul_u32_u24 v40, 0x3f80, v40
    v_accvgpr_write_b32 a240, v40
    v_lshrrev_b32 v40, 2, v41
    v_and_b32 v40, s4, v40
    s_waitcnt lgkmcnt(10)
    s_nop 0
    v_mfma_f32_32x32x16_bf16 v[80:95], a[20:23], a[16:19], v[80:95]
    v_mul_u32_u24 v40, 0x3f80, v40
    v_accvgpr_write_b32 a241, v40
    v_lshrrev_b32 v40, 4, v41
    v_and_b32 v40, s4, v40
    v_mul_u32_u24 v40, 0x3f80, v40
    v_accvgpr_write_b32 a242, v40
    s_waitcnt lgkmcnt(8)
    v_mfma_f32_32x32x16_bf16 v[80:95], a[28:31], a[24:27], v[80:95]
    v_lshrrev_b32 v40, 6, v41
    v_and_b32_e64 v40, s4, v40
    v_mul_u32_u24 v40, 0x3f80, v40
    v_accvgpr_write_b32 a243, v40
    v_mov_b32 v41, 0x1ff0
    v_lshlrev_b32 v41, v29, v41
    s_waitcnt lgkmcnt(6)
    v_mfma_f32_32x32x16_bf16 v[80:95], a[36:39], a[32:35], v[80:95]
    v_lshlrev_b32_e64 v40, 3, v28
    v_bfe_u32 v41, v41, v40, 8
    v_lshl_or_b32 v41, v41, 15, v41
    v_mov_b32 v40, v41
    v_and_b32 v40, s4, v40
    v_mul_u32_u24 v40, 0x3f80, v40
    s_waitcnt lgkmcnt(4)
    v_mfma_f32_32x32x16_bf16 v[80:95], a[44:47], a[40:43], v[80:95]
    v_accvgpr_write_b32 a244, v40
    v_lshrrev_b32 v40, 2, v41
    v_and_b32_e64 v40, s4, v40
    v_mul_u32_u24 v40, 0x3f80, v40
    v_accvgpr_write_b32 a245, v40
    v_lshrrev_b32 v40, 4, v41
    s_waitcnt lgkmcnt(2)
    v_mfma_f32_32x32x16_bf16 v[80:95], a[52:55], a[48:51], v[80:95]
    v_and_b32_e64 v40, s4, v40
    v_mul_u32_u24 v40, 0x3f80, v40
    v_accvgpr_write_b32 a246, v40
    v_lshrrev_b32 v40, 6, v41
    v_and_b32 v40, s4, v40
    v_mul_u32_u24 v40, 0x3f80, v40
    s_waitcnt lgkmcnt(0)
    v_mfma_f32_32x32x16_bf16 v[80:95], a[60:63], a[56:59], v[80:95]
    v_accvgpr_write_b32 a247, v40
    v_cmp_eq_u32 vcc, 0, v1
    v_mov_b32 v156, 0
    v_mov_b32 v157, 0
    v_mov_b32 v158, 0
    v_mov_b32 v159, 0
    v_mov_b32 v155, 0
    v_cndmask_b32 v248, 0, v248, vcc
    ds_write_b128 v71, v[156:159]
    s_nop 7
    v_cndmask_b32 v112, 0, v92, vcc
    v_add_f32_e64 v80, v80, v248
    v_cvt_pk_bf16_f32 v148, v88, v88
    v_cvt_pk_bf16_f32 v149, v88, v89
    v_cvt_pk_bf16_f32 v150, v89, v89
    v_cvt_pk_bf16_f32 v151, v90, v90
    v_cvt_pk_bf16_f32 v152, v112, v112
    v_cvt_pk_bf16_f32 v153, v112, v112
    v_cvt_pk_bf16_f32 v154, v112, v155
    v_sub_f32_e64 v113, v92, v112
    v_cvt_pk_bf16_f32 v144, v80, v81
    v_cvt_pk_bf16_f32 v145, v82, v83
    v_cvt_pk_bf16_f32 v146, v84, v84
    v_cvt_pk_bf16_f32 v147, v85, v86
    v_cvt_pk_bf16_f32 v160, v113, v93
    v_cvt_pk_bf16_f32 v161, v94, v94
    ds_write_b64 v70, v[144:145] offset:32
    ds_write_b64 v70, v[146:147] offset:544
    ds_write_b128 v71, v[148:151] offset:1056
    ds_write_b128 v71, v[152:155] offset:2080
    ds_write_b16 v73, v160
    ds_write_b16_d16_hi v73, v160 offset:32
    s_mov_b32 exec_lo, 0
    s_mov_b32 exec_hi, 1
    ds_write_b16 v73, v161 offset:64
    s_mov_b64 exec, -1
    s_branch L_p1done
L_kzero:
    s_mov_b32 s4, 0x10001
    v_mov_b32 v41, 0xfe0
    v_lshlrev_b32 v41, v29, v41
    v_lshlrev_b32 v40, 3, v28
    v_bfe_u32 v41, v41, v40, 8
    v_lshl_or_b32 v41, v41, 15, v41
    v_mov_b32 v40, v41
    v_and_b32 v40, s4, v40
    v_mul_u32_u24 v40, 0x3f80, v40
    v_accvgpr_write_b32 a240, v40
    v_lshrrev_b32 v40, 2, v41
    v_and_b32 v40, s4, v40
    v_mul_u32_u24 v40, 0x3f80, v40
    v_accvgpr_write_b32 a241, v40
    v_lshrrev_b32 v40, 4, v41
    v_and_b32 v40, s4, v40
    v_mul_u32_u24 v40, 0x3f80, v40
    v_accvgpr_write_b32 a242, v40
    v_lshrrev_b32 v40, 6, v41
    v_and_b32 v40, s4, v40
    v_mul_u32_u24 v40, 0x3f80, v40
    v_accvgpr_write_b32 a243, v40
    v_mov_b32 v41, 0x1ff0
    v_lshlrev_b32 v41, v29, v41
    v_lshlrev_b32 v40, 3, v28
    v_bfe_u32 v41, v41, v40, 8
    v_lshl_or_b32 v41, v41, 15, v41
    v_mov_b32 v40, v41
    v_and_b32 v40, s4, v40
    v_mul_u32_u24 v40, 0x3f80, v40
    v_accvgpr_write_b32 a244, v40
    v_lshrrev_b32 v40, 2, v41
    v_and_b32 v40, s4, v40
    v_mul_u32_u24 v40, 0x3f80, v40
    v_accvgpr_write_b32 a245, v40
    v_lshrrev_b32 v40, 4, v41
    v_and_b32 v40, s4, v40
    v_mul_u32_u24 v40, 0x3f80, v40
    v_accvgpr_write_b32 a246, v40
    v_lshrrev_b32 v40, 6, v41
    v_and_b32 v40, s4, v40
    v_mul_u32_u24 v40, 0x3f80, v40
    v_accvgpr_write_b32 a247, v40
    v_mov_b32 v112, 0
    v_mov_b32 v113, 0
    v_mov_b32 v114, 0
    v_mov_b32 v115, 0
    ds_write_b128 v71, v[112:115] offset:0
    ds_write_b128 v71, v[112:115] offset:1024
    ds_write_b128 v71, v[112:115] offset:2048
    s_waitcnt vmcnt(0) lgkmcnt(0)
    s_branch L_p1done
L_loader:
    s_mul_i32 s4, s8, 40960
    v_add_u32 v4, s4, v96
    v_add_u32 v5, s4, v97
    v_add_u32 v6, s4, v98
    v_add_u32 v7, s4, v99
    s_mul_i32 s4, s8, 49152
    v_add_u32 v8, s4, v100
    v_add_u32 v9, s4, v101
    v_add_u32 v10, s4, v102
    v_lshrrev_b32 v40, 1, v29
    v_xor_b32 v40, v40, v28
    v_lshlrev_b32 v40, 4, v40
    v_lshl_add_u32 v40, v29, 7, v40
    v_xor_b32 v41, 64, v40
    s_lshr_b32 s4, s8, 1
    s_mul_i32 s4, s4, 14336
    s_add_u32 s4, s4, 47360
    v_add_u32 v12, s4, v40
    v_add_u32 v13, s4, v41
    v_add_u32 v14, 57344, v12
    v_add_u32 v15, 57344, v13
    v_lshl_add_u32 v40, v43, 3, v46
    v_mul_u32_u24 v40, 192, v40
    v_mul_u32_u24 v41, 7168, v45
    v_add_u32 v40, v40, v41
    v_lshl_add_u32 v40, v47, 3, v40
    v_add_u32 v40, 51456, v40
    s_and_b32 s4, s8, 1
    s_mul_i32 s4, s4, 3
    v_xor_b32 v41, s4, v43
    v_lshl_add_u32 v16, v41, 5, v40
    v_add_u32 v19, 57344, v16
    s_add_u32 s4, s4, 1
    v_xor_b32 v41, s4, v43
    v_lshl_add_u32 v17, v41, 5, v40
    v_add_u32 v20, 57344, v17
    s_add_u32 s4, s4, 1
    v_xor_b32 v41, s4, v43
    v_lshl_add_u32 v18, v41, 5, v40
    v_add_u32 v21, 57344, v18
    v_mul_u32_u24 v40, 3136, v46
    v_lshl_add_u32 v40, v47, 3, v40
    v_lshlrev_b32 v42, 3, v28
    v_sub_u32 v40, v40, v42
    s_cmp_eq_u32 s8, 3
    s_cselect_b32 s5, 0, s8
    s_mul_i32 s4, s5, 15776
    v_add_u32 v40, s4, v40
    v_add_u32 v225, 2272, v40
    v_sub_u32 v40, v40, v42
    v_add_u32 v32, 56, v40
    v_lshl_add_u32 v40, v29, 1, v28
    s_mul_i32 s4, s5, 4608
    s_add_u32 s4, s4, 108832
    v_lshl_add_u32 v33, v40, 4, s4
    v_lshlrev_b32 v40, 7, v46
    v_lshl_add_u32 v40, v47, 4, v40
    v_lshl_add_u32 v40, v45, 6, v40
    v_lshl_add_u32 v34, v43, 9, v40
    v_lshl_add_u32 v35, v43, 3, v40
    v_lshlrev_b32 v238, 4, v0
    v_add_u32 v238, 109312, v238
    v_mul_u32_u24 v40, 49152, v43
    v_lshl_add_u32 v40, v45, 8, v40
    v_lshl_add_u32 v239, v29, 4, v40
    v_and_b32 v42, 1, v1
    v_lshlrev_b32 v224, 16, v42
    v_lshlrev_b32 v226, 11, v42
    s_add_u32 s4, s8, 1
    s_and_b32 s4, s4, 3
    s_mul_i32 s4, s4, 15360
    s_add_u32 s4, s4, 47360
    v_add_u32 v36, s4, v2
    s_add_u32 s4, s8, 2
    s_and_b32 s4, s4, 3
    s_mul_i32 s4, s4, 15360
    s_add_u32 s4, s4, 52480
    v_add_u32 v37, s4, v2
    s_add_u32 s4, s8, 3
    s_and_b32 s4, s4, 3
    s_mul_i32 s4, s4, 15360
    s_add_u32 s4, s4, 57600
    v_add_u32 v38, s4, v2
    s_mul_i32 s4, s8, 15360
    s_add_u32 s4, s4, 47360
    v_add_u32 v39, s4, v2
    s_mov_b32 m0, 51456
    s_mov_b32 s4, s19
    buffer_load_dwordx4 v100, s[52:55], s4 offen offset:0  lds
    buffer_load_dwordx4 v101, s[52:55], s4 offen offset:1024  lds
    buffer_load_dwordx4 v102, s[52:55], s4 offen offset:2048  lds
    s_mov_b32 m0, 58624
    s_add_u32 s4, s19, 49152
    buffer_load_dwordx4 v100, s[52:55], s4 offen offset:0  lds
    buffer_load_dwordx4 v101, s[52:55], s4 offen offset:1024  lds
    buffer_load_dwordx4 v102, s[52:55], s4 offen offset:2048  lds
    s_mov_b32 m0, 65792
    s_add_u32 s4, s19, 98304
    buffer_load_dwordx4 v100, s[52:55], s4 offen offset:0  lds
    buffer_load_dwordx4 v101, s[52:55], s4 offen offset:1024  lds
    buffer_load_dwordx4 v102, s[52:55], s4 offen offset:2048  lds
    s_mov_b32 m0, 72960
    s_add_u32 s4, s19, 147456
    buffer_load_dwordx4 v100, s[52:55], s4 offen offset:0  lds
    buffer_load_dwordx4 v101, s[52:55], s4 offen offset:1024  lds
    buffer_load_dwordx4 v102, s[52:55], s4 offen offset:2048  lds
    v_and_b32 v42, 1, v1
    v_lshlrev_b32 v42, 2, v42
    v_cmp_gt_u32 vcc, 8, v1
    s_waitcnt lgkmcnt(0)
    v_add_u32 v40, s72, v42
    v_lshlrev_b32 v40, 9, v40
    v_add_u32 v40, s73, v40
    v_lshlrev_b32 v41, 9, v42
    v_add_u32 v41, s74, v41
    v_cndmask_b32 v31, v40, v41, vcc
    v_mov_b32 v27, 0
    s_andn2_b32 s4, s86, 0x180
    s_andn2_b32 s5, s85, 0x180
    s_add_u32 s5, s5, 393216
    s_sub_u32 s5, s5, s4
    v_bfe_u32 v40, v1, 2, 1
    v_mul_lo_u32 v40, v40, s5
    v_lshl_add_u32 v40, v47, 7, v40
    buffer_load_dword v55, v40, s[60:63], s4 offen sc1
    s_andn2_b32 s4, s92, 0x180
    s_andn2_b32 s5, s86, 0x180
    s_add_u32 s5, s5, 131072
    s_sub_u32 s5, s5, s4
    s_add_u32 s4, s4, 131072
    v_bfe_u32 v40, v1, 2, 1
    v_mul_lo_u32 v40, v40, s5
    v_lshl_add_u32 v40, v47, 7, v40
    buffer_load_dword v53, v40, s[60:63], s4 offen sc1
    s_and_b32 s4, s15, 3
    s_sub_u32 s4, 3, s4
    s_mul_i32 s4, s4, 20480
    s_sub_u32 s4, s80, s4
    v_mul_u32_u24 v40, 1280, v29
    buffer_load_dword v54, v40, s[64:67], s4 offen sc1
    s_mov_b32 m0, 80128
    s_mov_b32 s4, s21
    buffer_load_dwordx4 v100, s[52:55], s4 offen offset:0  lds
    buffer_load_dwordx4 v101, s[52:55], s4 offen offset:1024  lds
    buffer_load_dwordx4 v102, s[52:55], s4 offen offset:2048  lds
    s_mov_b32 m0, 87296
    s_add_u32 s4, s21, 49152
    buffer_load_dwordx4 v100, s[52:55], s4 offen offset:0  lds
    buffer_load_dwordx4 v101, s[52:55], s4 offen offset:1024  lds
    buffer_load_dwordx4 v102, s[52:55], s4 offen offset:2048  lds
    s_mov_b32 m0, 94464
    s_add_u32 s4, s21, 98304
    buffer_load_dwordx4 v100, s[52:55], s4 offen offset:0  lds
    buffer_load_dwordx4 v101, s[52:55], s4 offen offset:1024  lds
    buffer_load_dwordx4 v102, s[52:55], s4 offen offset:2048  lds
    s_mov_b32 m0, 101632
    s_add_u32 s4, s21, 147456
    buffer_load_dwordx4 v100, s[52:55], s4 offen offset:0  lds
    buffer_load_dwordx4 v101, s[52:55], s4 offen offset:1024  lds
    buffer_load_dwordx4 v102, s[52:55], s4 offen offset:2048  lds
    s_cmp_eq_u32 s75, 0
    s_cbranch_scc1 L_notr
    v_lshl_add_u32 v40, v47, 3, v46
    v_bfe_u32 v41, v40, 1, 3
    v_xor_b32 v41, v41, v45
    v_lshlrev_b32 v41, 4, v41
    v_lshl_add_u32 v41, v40, 7, v41
    v_lshl_add_u32 v104, v43, 3, v41
    v_add_u32 v104, 47360, v104
    v_xor_b32 v105, 32, v104
    v_xor_b32 v106, 64, v104
    v_xor_b32 v107, 96, v104
    v_lshl_add_u32 v40, v28, 2, v47
    v_mul_u32_u24 v40, 288, v40
    v_lshl_add_u32 v108, v46, 4, v40
    v_add_u32 v108, 141568, v108
    v_mul_u32_u24 v40, 288, v28
    v_lshl_add_u32 v109, v29, 4, v40
    v_add_u32 v109, 141568, v109
    v_mul_u32_u24 v40, 4224, v28
    v_lshl_add_u32 v110, v29, 4, v40
    s_mul_i32 s30, s13, 270336
    s_lshl_b32 s5, s9, 8
    s_add_u32 s30, s30, s5
    s_add_u32 s30, s30, 1048704
    v_lshrrev_b32 v40, 1, v29
    v_xor_b32 v40, v40, v28
    v_lshlrev_b32 v40, 4, v40
    v_lshl_add_u32 v40, v29, 7, v40
    v_add_u32 v88, 47360, v40
    v_xor_b32 v40, 64, v40
    v_add_u32 v89, 47360, v40
    s_waitcnt vmcnt(27)
    ds_read_b64_tr_b16 v[112:113], v104 offset:0
    ds_read_b64_tr_b16 v[114:115], v105 offset:512
    ds_read_b64_tr_b16 v[116:117], v104 offset:7168
    ds_read_b64_tr_b16 v[118:119], v105 offset:7680
    ds_read_b64_tr_b16 v[120:121], v104 offset:14336
    ds_read_b64_tr_b16 v[122:123], v105 offset:14848
    ds_read_b64_tr_b16 v[124:125], v104 offset:21504
    ds_read_b64_tr_b16 v[126:127], v105 offset:22016
    ds_read_b64_tr_b16 v[128:129], v105 offset:0
    ds_read_b64_tr_b16 v[130:131], v104 offset:512
    ds_read_b64_tr_b16 v[132:133], v105 offset:7168
    ds_read_b64_tr_b16 v[134:135], v104 offset:7680
    ds_read_b64_tr_b16 v[136:137], v105 offset:14336
    ds_read_b64_tr_b16 v[138:139], v104 offset:14848
    ds_read_b64_tr_b16 v[140:141], v105 offset:21504
    ds_read_b64_tr_b16 v[142:143], v104 offset:22016
    ds_read_b64_tr_b16 v[144:145], v106 offset:0
    ds_read_b64_tr_b16 v[146:147], v107 offset:512
    ds_read_b64_tr_b16 v[148:149], v106 offset:7168
    ds_read_b64_tr_b16 v[150:151], v107 offset:7680
    ds_read_b64_tr_b16 v[152:153], v106 offset:14336
    ds_read_b64_tr_b16 v[154:155], v107 offset:14848
    ds_read_b64_tr_b16 v[156:157], v106 offset:21504
    ds_read_b64_tr_b16 v[158:159], v107 offset:22016
    ds_read_b64_tr_b16 v[160:161], v107 offset:0
    ds_read_b64_tr_b16 v[162:163], v106 offset:512
    ds_read_b64_tr_b16 v[164:165], v107 offset:7168
    ds_read_b64_tr_b16 v[166:167], v106 offset:7680
    ds_read_b64_tr_b16 v[168:169], v107 offset:14336
    ds_read_b64_tr_b16 v[170:171], v106 offset:14848
    ds_read_b64_tr_b16 v[172:173], v107 offset:21504
    ds_read_b64_tr_b16 v[174:175], v106 offset:22016
    s_waitcnt lgkmcnt(15)
    ds_write_b128 v108, v[112:115] offset:0
    ds_write_b128 v108, v[116:119] offset:64
    ds_write_b128 v108, v[120:123] offset:128
    ds_write_b128 v108, v[124:127] offset:192
    ds_write_b128 v108, v[128:131] offset:4608
    ds_write_b128 v108, v[132:135] offset:4672
    ds_write_b128 v108, v[136:139] offset:4736
    ds_write_b128 v108, v[140:143] offset:4800
    s_waitcnt lgkmcnt(15)
    ds_write_b128 v108, v[144:147] offset:9216
    ds_write_b128 v108, v[148:151] offset:9280
    ds_write_b128 v108, v[152:155] offset:9344
    ds_write_b128 v108, v[156:159] offset:9408
    s_waitcnt lgkmcnt(15)
    ds_write_b128 v108, v[160:163] offset:13824
    ds_write_b128 v108, v[164:167] offset:13888
    s_waitcnt lgkmcnt(15)
    ds_write_b128 v108, v[168:171] offset:13952
    s_waitcnt lgkmcnt(15)
    ds_write_b128 v108, v[172:175] offset:14016
    ds_read_b128 v[112:115], v109 offset:0
    ds_read_b128 v[116:119], v109 offset:1152
    ds_read_b128 v[120:123], v109 offset:2304
    ds_read_b128 v[124:127], v109 offset:3456
    ds_read_b128 v[128:131], v109 offset:4608
    ds_read_b128 v[132:135], v109 offset:5760
    ds_read_b128 v[136:139], v109 offset:6912
    ds_read_b128 v[140:143], v109 offset:8064
    ds_read_b128 v[144:147], v109 offset:9216
    ds_read_b128 v[148:151], v109 offset:10368
    ds_read_b128 v[152:155], v109 offset:11520
    ds_read_b128 v[156:159], v109 offset:12672
    ds_read_b128 v[160:163], v109 offset:13824
    ds_read_b128 v[164:167], v109 offset:14976
    ds_read_b128 v[168:171], v109 offset:16128
    ds_read_b128 v[172:175], v109 offset:17280
    s_waitcnt lgkmcnt(15)
    buffer_store_dwordx4 v[112:115], v110, s[60:63], s30 offen sc1
    s_add_u32 s30, s30, 16896
    s_waitcnt lgkmcnt(14)
    buffer_store_dwordx4 v[116:119], v110, s[60:63], s30 offen sc1
    s_add_u32 s30, s30, 16896
    s_waitcnt lgkmcnt(13)
    buffer_store_dwordx4 v[120:123], v110, s[60:63], s30 offen sc1
    s_add_u32 s30, s30, 16896
    s_waitcnt lgkmcnt(12)
    buffer_store_dwordx4 v[124:127], v110, s[60:63], s30 offen sc1
    s_add_u32 s30, s30, 16896
    s_waitcnt lgkmcnt(11)
    buffer_store_dwordx4 v[128:131], v110, s[60:63], s30 offen sc1
    s_add_u32 s30, s30, 16896
    s_waitcnt lgkmcnt(10)
    buffer_store_dwordx4 v[132:135], v110, s[60:63], s30 offen sc1
    s_add_u32 s30, s30, 16896
    s_waitcnt lgkmcnt(9)
    buffer_store_dwordx4 v[136:139], v110, s[60:63], s30 offen sc1
    s_add_u32 s30, s30, 16896
    s_waitcnt lgkmcnt(8)
    buffer_store_dwordx4 v[140:143], v110, s[60:63], s30 offen sc1
    s_add_u32 s30, s30, 16896
    s_waitcnt lgkmcnt(7)
    buffer_store_dwordx4 v[144:147], v110, s[60:63], s30 offen sc1
    s_add_u32 s30, s30, 16896
    s_waitcnt lgkmcnt(6)
    buffer_store_dwordx4 v[148:151], v110, s[60:63], s30 offen sc1
    s_add_u32 s30, s30, 16896
    s_waitcnt lgkmcnt(5)
    buffer_store_dwordx4 v[152:155], v110, s[60:63], s30 offen sc1
    s_add_u32 s30, s30, 16896
    s_waitcnt lgkmcnt(4)
    buffer_store_dwordx4 v[156:159], v110, s[60:63], s30 offen sc1
    s_add_u32 s30, s30, 16896
    s_waitcnt lgkmcnt(3)
    buffer_store_dwordx4 v[160:163], v110, s[60:63], s30 offen sc1
    s_add_u32 s30, s30, 16896
    s_waitcnt lgkmcnt(2)
    buffer_store_dwordx4 v[164:167], v110, s[60:63], s30 offen sc1
    s_add_u32 s30, s30, 16896
    s_waitcnt lgkmcnt(1)
    buffer_store_dwordx4 v[168:171], v110, s[60:63], s30 offen sc1
    s_add_u32 s30, s30, 16896
    s_waitcnt lgkmcnt(0)
    buffer_store_dwordx4 v[172:175], v110, s[60:63], s30 offen sc1
    ds_read_b128 a[0:3], v88 offset:0
    ds_read_b128 a[4:7], v89 offset:0
    ds_read_b128 a[8:11], v88 offset:2048
    ds_read_b128 a[12:15], v89 offset:2048
    ds_read_b128 a[16:19], v88 offset:7168
    ds_read_b128 a[20:23], v89 offset:7168
    ds_read_b128 a[24:27], v88 offset:9216
    ds_read_b128 a[28:31], v89 offset:9216
    ds_read_b128 a[32:35], v88 offset:14336
    ds_read_b128 a[36:39], v89 offset:14336
    ds_read_b128 a[40:43], v88 offset:16384
    ds_read_b128 a[44:47], v89 offset:16384
    ds_read_b128 a[48:51], v88 offset:21504
    ds_read_b128 a[52:55], v89 offset:21504
    ds_read_b128 a[56:59], v88 offset:23552
    ds_read_b128 a[60:63], v89 offset:23552
    s_waitcnt lgkmcnt(14)
    v_mfma_f32_16x16x32_bf16 v[176:179], v[80:83], a[0:3], 0
    v_mfma_f32_16x16x32_bf16 v[176:179], v[84:87], a[4:7], v[176:179]
    s_waitcnt lgkmcnt(12)
    v_mfma_f32_16x16x32_bf16 v[180:183], v[80:83], a[8:11], 0
    v_mfma_f32_16x16x32_bf16 v[180:183], v[84:87], a[12:15], v[180:183]
    s_waitcnt lgkmcnt(10)
    v_mfma_f32_16x16x32_bf16 v[184:187], v[80:83], a[16:19], 0
    v_mfma_f32_16x16x32_bf16 v[184:187], v[84:87], a[20:23], v[184:187]
    s_waitcnt lgkmcnt(8)
    v_mfma_f32_16x16x32_bf16 v[188:191], v[80:83], a[24:27], 0
    v_mfma_f32_16x16x32_bf16 v[188:191], v[84:87], a[28:31], v[188:191]
    s_waitcnt lgkmcnt(6)
    v_mfma_f32_16x16x32_bf16 v[192:195], v[80:83], a[32:35], 0
    v_mfma_f32_16x16x32_bf16 v[192:195], v[84:87], a[36:39], v[192:195]
    s_waitcnt lgkmcnt(4)
    v_mfma_f32_16x16x32_bf16 v[196:199], v[80:83], a[40:43], 0
    v_mfma_f32_16x16x32_bf16 v[196:199], v[84:87], a[44:47], v[196:199]
    s_waitcnt lgkmcnt(2)
    v_mfma_f32_16x16x32_bf16 v[200:203], v[80:83], a[48:51], 0
    v_mfma_f32_16x16x32_bf16 v[200:203], v[84:87], a[52:55], v[200:203]
    s_waitcnt lgkmcnt(0)
    v_mfma_f32_16x16x32_bf16 v[204:207], v[80:83], a[56:59], 0
    v_mfma_f32_16x16x32_bf16 v[204:207], v[84:87], a[60:63], v[204:207]
    s_mul_i32 s4, s9, 10
    s_add_u32 s4, s4, s13
    s_lshl_b32 s4, s4, 9
    s_add_u32 s4, s4, 524288
    v_lshlrev_b32 v40, 2, v1
    s_nop 3
    s_mov_b32 exec_lo, 0xffff0000
    v_mov_b32 v176, v180
    v_mov_b32 v192, v196
    s_mov_b32 exec_lo, 0
    v_mov_b32 v176, v184
    v_mov_b32 v192, v200
    s_mov_b32 exec_hi, 0xffff0000
    v_mov_b32 v176, v188
    v_mov_b32 v192, v204
    s_mov_b64 exec, -1
    buffer_store_dword v176, v40, s[60:63], s4 offen sc1
    buffer_store_dword v192, v40, s[60:63], s4 offen offset:256 sc1
L_notr:
    v_mul_u32_u24 v41, 6554, v1
    v_lshrrev_b32 v41, 16, v41
    v_mul_u32_u24 v42, 10, v41
    v_sub_u32 v42, v1, v42
    v_mul_u32_u24 v41, 1280, v41
    v_lshl_add_u32 v72, v42, 4, v41
    s_and_b32 s5, s26, 3
    s_mul_i32 s4, s5, 96
    s_sub_u32 s4, 384, s4
    v_lshrrev_b32 v42, 3, v42
    v_mad_u32_u24 v72, v42, s4, v72
    s_mul_i32 s4, s27, 61440
    s_lshl_b32 s5, s5, 7
    s_add_u32 s4, s4, s5
    s_lshr_b32 s5, s26, 2
    s_mul_i32 s5, s5, 640
    s_add_u32 s4, s4, s5
    s_mov_b32 exec_hi, 0x0fffffff
    s_mov_b32 m0, 133376
    s_nop 0
    buffer_load_dwordx4 v72, s[56:59], s4 offen nt lds
    s_mov_b32 m0, 134336
    s_add_u32 s4, s4, 7680
    buffer_load_dwordx4 v72, s[56:59], s4 offen nt lds
    s_mov_b32 m0, 135296
    s_add_u32 s4, s4, 7680
    buffer_load_dwordx4 v72, s[56:59], s4 offen nt lds
    s_mov_b32 m0, 136256
    s_add_u32 s4, s4, 7680
    buffer_load_dwordx4 v72, s[56:59], s4 offen nt lds
    s_mov_b32 m0, 137216
    s_add_u32 s4, s4, 7680
    buffer_load_dwordx4 v72, s[56:59], s4 offen nt lds
    s_mov_b32 m0, 138176
    s_add_u32 s4, s4, 7680
    buffer_load_dwordx4 v72, s[56:59], s4 offen nt lds
    s_mov_b32 m0, 139136
    s_add_u32 s4, s4, 7680
    buffer_load_dwordx4 v72, s[56:59], s4 offen nt lds
    s_mov_b32 m0, 140096
    s_add_u32 s4, s4, 7680
    buffer_load_dwordx4 v72, s[56:59], s4 offen nt lds
    s_mov_b32 exec_hi, -1
    global_load_dword v30, v3, s[44:45] sc1
    s_mov_b32 m0, 76032
    s_mov_b32 s4, s20
    buffer_load_dwordx4 v96, s[48:51], s4 offen offset:0  lds
    buffer_load_dwordx4 v97, s[48:51], s4 offen offset:1024  lds
    buffer_load_dwordx4 v98, s[48:51], s4 offen offset:2048  lds
    buffer_load_dwordx4 v99, s[48:51], s4 offen offset:3072  lds
    s_mov_b32 m0, 83200
    s_add_u32 s4, s20, 40960
    buffer_load_dwordx4 v96, s[48:51], s4 offen offset:0  lds
    buffer_load_dwordx4 v97, s[48:51], s4 offen offset:1024  lds
    buffer_load_dwordx4 v98, s[48:51], s4 offen offset:2048  lds
    buffer_load_dwordx4 v99, s[48:51], s4 offen offset:3072  lds
    s_mov_b32 m0, 90368
    s_add_u32 s4, s20, 81920
    buffer_load_dwordx4 v96, s[48:51], s4 offen offset:0  lds
    buffer_load_dwordx4 v97, s[48:51], s4 offen offset:1024  lds
    buffer_load_dwordx4 v98, s[48:51], s4 offen offset:2048  lds
    buffer_load_dwordx4 v99, s[48:51], s4 offen offset:3072  lds
    s_mov_b32 m0, 97536
    s_add_u32 s4, s20, 122880
    buffer_load_dwordx4 v96, s[48:51], s4 offen offset:0  lds
    buffer_load_dwordx4 v97, s[48:51], s4 offen offset:1024  lds
    buffer_load_dwordx4 v98, s[48:51], s4 offen offset:2048  lds
    buffer_load_dwordx4 v99, s[48:51], s4 offen offset:3072  lds
    s_mov_b32 m0, 108800
    s_mov_b32 s4, s23
    buffer_load_dwordx4 v100, s[52:55], s4 offen offset:0  lds
    buffer_load_dwordx4 v101, s[52:55], s4 offen offset:1024  lds
    buffer_load_dwordx4 v102, s[52:55], s4 offen offset:2048  lds
    s_mov_b32 m0, 115968
    s_add_u32 s4, s23, 49152
    buffer_load_dwordx4 v100, s[52:55], s4 offen offset:0  lds
    buffer_load_dwordx4 v101, s[52:55], s4 offen offset:1024  lds
    buffer_load_dwordx4 v102, s[52:55], s4 offen offset:2048  lds
    s_mov_b32 m0, 123136
    s_add_u32 s4, s23, 98304
    buffer_load_dwordx4 v100, s[52:55], s4 offen offset:0  lds
    buffer_load_dwordx4 v101, s[52:55], s4 offen offset:1024  lds
    buffer_load_dwordx4 v102, s[52:55], s4 offen offset:2048  lds
    s_mov_b32 m0, 130304
    s_add_u32 s4, s23, 147456
    buffer_load_dwordx4 v100, s[52:55], s4 offen offset:0  lds
    buffer_load_dwordx4 v101, s[52:55], s4 offen offset:1024  lds
    buffer_load_dwordx4 v102, s[52:55], s4 offen offset:2048  lds
    v_lshl_add_u32 v40, v43, 3, v46
    v_mul_u32_u24 v40, 160, v40
    v_mul_u32_u24 v41, 40, v47
    v_add_u32 v40, v40, v41
    v_add_u32 v40, 133376, v40
    v_mul_u32_u24 v41, 2560, v45
    v_add_u32 v56, v40, v41
    v_lshl_add_u32 v57, v45, 3, v40
    s_mul_i32 s4, s26, 245760
    s_add_u32 s4, s4, 8388608
    v_lshlrev_b32 v40, 4, v44
    v_add_u32 v40, s4, v40
    s_mul_i32 s5, s27, 3
    v_add_u32 v41, s5, v45
    v_lshrrev_b32 v42, 1, v41
    v_mul_u32_u24 v42, 5120, v42
    v_and_b32 v41, 1, v41
    v_lshl_add_u32 v42, v41, 9, v42
    v_add_u32 v58, v42, v40
    s_add_u32 s5, s5, 2
    s_lshr_b32 s4, s5, 1
    s_mul_i32 s4, s4, 5120
    s_and_b32 s5, s5, 1
    s_lshl_b32 s5, s5, 9
    s_add_u32 s4, s4, s5
    v_lshl_add_u32 v40, v45, 10, v40
    v_add_u32 v59, s4, v40
    s_movk_i32 s31, 0x1000
    s_waitcnt vmcnt(29)
    ds_read_b64_tr_b16 v[176:177], v56 offset:0
    ds_read_b64_tr_b16 v[178:179], v56 offset:640
    ds_read_b64_tr_b16 v[180:181], v56 offset:8
    ds_read_b64_tr_b16 v[182:183], v56 offset:648
    ds_read_b64_tr_b16 v[184:185], v56 offset:16
    ds_read_b64_tr_b16 v[186:187], v56 offset:656
    ds_read_b64_tr_b16 v[188:189], v56 offset:24
    ds_read_b64_tr_b16 v[190:191], v56 offset:664
    ds_read_b64_tr_b16 v[192:193], v56 offset:32
    ds_read_b64_tr_b16 v[194:195], v56 offset:672
    ds_read_b64_tr_b16 v[196:197], v57 offset:5120
    ds_read_b64_tr_b16 v[198:199], v57 offset:5760
    ds_read_b64_tr_b16 v[200:201], v57 offset:5136
    ds_read_b64_tr_b16 v[202:203], v57 offset:5776
    ds_read_b64_tr_b16 v[204:205], v57 offset:5152
    ds_read_b64_tr_b16 v[206:207], v57 offset:5792
    s_waitcnt lgkmcnt(14)
    buffer_store_dwordx4 v[176:179], v58, s[60:63], 0 offen offset:0 sc1
    s_waitcnt lgkmcnt(12)
    buffer_store_dwordx4 v[180:183], v58, s[60:63], 0 offen offset:1024 sc1
    s_waitcnt lgkmcnt(10)
    buffer_store_dwordx4 v[184:187], v58, s[60:63], 0 offen offset:2048 sc1
    s_waitcnt lgkmcnt(8)
    buffer_store_dwordx4 v[188:191], v58, s[60:63], 0 offen offset:3072 sc1
    s_waitcnt lgkmcnt(6)
    buffer_store_dwordx4 v[192:195], v58, s[60:63], s31 offen offset:0 sc1
    s_waitcnt lgkmcnt(4)
    buffer_store_dwordx4 v[196:199], v59, s[60:63], 0 offen offset:0 sc1
    s_waitcnt lgkmcnt(2)
    buffer_store_dwordx4 v[200:203], v59, s[60:63], 0 offen offset:2048 sc1
    s_waitcnt lgkmcnt(0)
    s_mov_b32 exec_hi, 0
    buffer_store_dwordx4 v[204:207], v59, s[60:63], s31 offen offset:0 sc1
    s_mov_b32 exec_hi, -1
    s_mov_b32 m0, 104704
    s_mov_b32 s4, s22
    buffer_load_dwordx4 v96, s[48:51], s4 offen offset:0  lds
    buffer_load_dwordx4 v97, s[48:51], s4 offen offset:1024  lds
    buffer_load_dwordx4 v98, s[48:51], s4 offen offset:2048  lds
    buffer_load_dwordx4 v99, s[48:51], s4 offen offset:3072  lds
    s_mov_b32 m0, 111872
    s_add_u32 s4, s22, 40960
    buffer_load_dwordx4 v96, s[48:51], s4 offen offset:0  lds
    buffer_load_dwordx4 v97, s[48:51], s4 offen offset:1024  lds
    buffer_load_dwordx4 v98, s[48:51], s4 offen offset:2048  lds
    buffer_load_dwordx4 v99, s[48:51], s4 offen offset:3072  lds
    s_mov_b32 m0, 119040
    s_add_u32 s4, s22, 81920
    buffer_load_dwordx4 v96, s[48:51], s4 offen offset:0  lds
    buffer_load_dwordx4 v97, s[48:51], s4 offen offset:1024  lds
    buffer_load_dwordx4 v98, s[48:51], s4 offen offset:2048  lds
    buffer_load_dwordx4 v99, s[48:51], s4 offen offset:3072  lds
    s_mov_b32 m0, 126208
    s_add_u32 s4, s22, 122880
    buffer_load_dwordx4 v96, s[48:51], s4 offen offset:0  lds
    buffer_load_dwordx4 v97, s[48:51], s4 offen offset:1024  lds
    buffer_load_dwordx4 v98, s[48:51], s4 offen offset:2048  lds
    buffer_load_dwordx4 v99, s[48:51], s4 offen offset:3072  lds
    s_waitcnt vmcnt(52)
    v_cmp_eq_u32 vcc, 0, v30
    s_cbranch_vccz L_sn_ok
    s_mov_b32 s82, 0x40000
L_sn_lp:
    s_sleep 1
    global_load_dword v30, v3, s[44:45] sc1
    s_waitcnt vmcnt(0)
    v_cmp_eq_u32 vcc, 0, v30
    s_sub_u32 s82, s82, 1
    s_cmp_eq_u32 s82, 0
    s_cbranch_scc1 L_sn_ok
    s_cbranch_vccnz L_sn_lp
L_sn_ok:
    v_mov_b32 v40, 162048
    ds_write_b32 v40, v30
    s_waitcnt lgkmcnt(0)
L_p1done:
    s_barrier
    ds_read_b128 v[96:99], v12 offset:0
    ds_read_b64_tr_b16 v[112:113], v16 offset:0
    ds_read_b64_tr_b16 v[114:115], v16 offset:768
    ds_read_b128 v[100:103], v12 offset:2048
    ds_read_b64_tr_b16 v[116:117], v17 offset:0
    ds_read_b64_tr_b16 v[118:119], v17 offset:768
    ds_read_b128 v[104:107], v12 offset:7168
    ds_read_b128 v[108:111], v12 offset:9216
    ds_read_b64_tr_b16 v[120:121], v18 offset:0
    ds_read_b64_tr_b16 v[122:123], v18 offset:768
    v_mov_b32 v40, 162048
    ds_read_b32 v30, v40
    s_waitcnt lgkmcnt(5)
    v_mfma_f32_16x16x32_bf16 v[48:51], v[112:115], v[96:99], 0
    ds_read_b128 v[124:127], v13 offset:0
    v_mfma_f32_16x16x32_bf16 v[52:55], v[112:115], v[100:103], 0
    ds_read_b64_tr_b16 v[140:141], v16 offset:14336
    v_mfma_f32_16x16x32_bf16 v[64:67], v[116:119], v[96:99], 0
    ds_read_b64_tr_b16 v[142:143], v16 offset:15104
    v_mfma_f32_16x16x32_bf16 v[68:71], v[116:119], v[100:103], 0
    s_add_u32 m0, s78, 133376
    s_mul_i32 s37, s79, 1536
    buffer_load_dwordx4 v4, s[48:51], s79 offen offset:0 lds
    s_waitcnt lgkmcnt(5)
    v_mfma_f32_16x16x32_bf16 v[56:59], v[112:115], v[104:107], 0
    ds_read_b128 v[128:131], v13 offset:2048
    v_mfma_f32_16x16x32_bf16 v[72:75], v[116:119], v[104:107], 0
    ds_read_b64_tr_b16 v[144:145], v17 offset:14336
    v_mfma_f32_16x16x32_bf16 v[60:63], v[112:115], v[108:111], 0
    ds_read_b64_tr_b16 v[146:147], v17 offset:15104
    v_mfma_f32_16x16x32_bf16 v[76:79], v[116:119], v[108:111], 0
    buffer_load_dwordx4 v5, s[48:51], s79 offen offset:1024 lds
    s_waitcnt lgkmcnt(5)
    v_mfma_f32_16x16x32_bf16 v[80:83], v[120:123], v[96:99], 0
    ds_read_b128 v[132:135], v13 offset:7168
    v_mfma_f32_16x16x32_bf16 v[84:87], v[120:123], v[100:103], 0
    ds_read_b128 v[136:139], v13 offset:9216
    v_mfma_f32_16x16x32_bf16 v[88:91], v[120:123], v[104:107], 0
    ds_read_b64_tr_b16 v[148:149], v18 offset:14336
    ds_read_b64_tr_b16 v[150:151], v18 offset:15104
    v_mfma_f32_16x16x32_bf16 v[92:95], v[120:123], v[108:111], 0
    buffer_load_dwordx4 v6, s[48:51], s79 offen offset:2048 lds
    s_waitcnt vmcnt(39)
    s_waitcnt lgkmcnt(0)
    s_waitcnt vmcnt(19)
    s_barrier
    v_mfma_f32_16x16x32_bf16 v[48:51], v[140:143], v[124:127], v[48:51]
    ds_read_b128 v[96:99], v12 offset:28672
    v_mfma_f32_16x16x32_bf16 v[52:55], v[140:143], v[128:131], v[52:55]
    ds_read_b64_tr_b16 v[112:113], v16 offset:28672
    v_readfirstlane_b32 s6, v30
    v_mfma_f32_16x16x32_bf16 v[64:67], v[144:147], v[124:127], v[64:67]
    ds_read_b64_tr_b16 v[114:115], v16 offset:29440
    buffer_load_dwordx4 v7, s[48:51], s79 offen offset:3072 lds
    s_add_u32 m0, m0, 4096
    v_mfma_f32_16x16x32_bf16 v[68:71], v[144:147], v[128:131], v[68:71]
    v_readfirstlane_b32 s7, v30
    v_mfma_f32_16x16x32_bf16 v[56:59], v[140:143], v[132:135], v[56:59]
    ds_read_b128 v[100:103], v12 offset:30720
    v_mfma_f32_16x16x32_bf16 v[72:75], v[144:147], v[132:135], v[72:75]
    ds_read_b64_tr_b16 v[116:117], v17 offset:28672
    buffer_load_dwordx4 v8, s[52:55], s37 offen offset:0 lds
    s_add_u32 s79, s79, 128
    v_mfma_f32_16x16x32_bf16 v[60:63], v[140:143], v[136:139], v[60:63]
    ds_read_b64_tr_b16 v[118:119], v17 offset:29440
    v_mfma_f32_16x16x32_bf16 v[76:79], v[144:147], v[136:139], v[76:79]
    v_mfma_f32_16x16x32_bf16 v[80:83], v[148:151], v[124:127], v[80:83]
    ds_read_b128 v[104:107], v12 offset:35840
    buffer_load_dwordx4 v9, s[52:55], s37 offen offset:1024 lds
    s_cmp_ge_u32 s79, 1280
    s_cselect_b32 s79, 0, s79
    v_mfma_f32_16x16x32_bf16 v[84:87], v[148:151], v[128:131], v[84:87]
    ds_read_b128 v[108:111], v12 offset:37888
    v_mfma_f32_16x16x32_bf16 v[88:91], v[148:151], v[132:135], v[88:91]
    ds_read_b64_tr_b16 v[120:121], v18 offset:28672
    ds_read_b64_tr_b16 v[122:123], v18 offset:29440
    v_mfma_f32_16x16x32_bf16 v[92:95], v[148:151], v[136:139], v[92:95]
    buffer_load_dwordx4 v10, s[52:55], s37 offen offset:2048 lds
    s_waitcnt lgkmcnt(5)
    v_mfma_f32_16x16x32_bf16 v[48:51], v[112:115], v[96:99], v[48:51]
    ds_read_b128 v[124:127], v13 offset:28672
    v_mfma_f32_16x16x32_bf16 v[52:55], v[112:115], v[100:103], v[52:55]
    ds_read_b64_tr_b16 v[140:141], v16 offset:43008
    s_waitcnt lgkmcnt(5)
    v_mfma_f32_16x16x32_bf16 v[64:67], v[116:119], v[96:99], v[64:67]
    ds_read_b64_tr_b16 v[142:143], v16 offset:43776
    v_mfma_f32_16x16x32_bf16 v[68:71], v[116:119], v[100:103], v[68:71]
    s_add_u32 m0, s78, 47360
    s_mul_i32 s37, s79, 1536
    buffer_load_dwordx4 v4, s[48:51], s79 offen offset:0 lds
    v_mfma_f32_16x16x32_bf16 v[56:59], v[112:115], v[104:107], v[56:59]
    ds_read_b128 v[128:131], v13 offset:30720
    v_mfma_f32_16x16x32_bf16 v[72:75], v[116:119], v[104:107], v[72:75]
    ds_read_b64_tr_b16 v[144:145], v17 offset:43008
    s_waitcnt lgkmcnt(5)
    v_mfma_f32_16x16x32_bf16 v[60:63], v[112:115], v[108:111], v[60:63]
    ds_read_b64_tr_b16 v[146:147], v17 offset:43776
    v_mfma_f32_16x16x32_bf16 v[76:79], v[116:119], v[108:111], v[76:79]
    buffer_load_dwordx4 v5, s[48:51], s79 offen offset:1024 lds
    v_mfma_f32_16x16x32_bf16 v[80:83], v[120:123], v[96:99], v[80:83]
    ds_read_b128 v[132:135], v13 offset:35840
    v_mfma_f32_16x16x32_bf16 v[84:87], v[120:123], v[100:103], v[84:87]
    ds_read_b128 v[136:139], v13 offset:37888
    v_mfma_f32_16x16x32_bf16 v[88:91], v[120:123], v[104:107], v[88:91]
    ds_read_b64_tr_b16 v[148:149], v18 offset:43008
    ds_read_b64_tr_b16 v[150:151], v18 offset:43776
    v_mfma_f32_16x16x32_bf16 v[92:95], v[120:123], v[108:111], v[92:95]
    buffer_load_dwordx4 v6, s[48:51], s79 offen offset:2048 lds
    s_waitcnt vmcnt(10)
    s_waitcnt lgkmcnt(0)
    s_barrier
    v_mfma_f32_16x16x32_bf16 v[48:51], v[140:143], v[124:127], v[48:51]
    ds_read_b128 v[96:99], v14 offset:0
    v_mfma_f32_16x16x32_bf16 v[52:55], v[140:143], v[128:131], v[52:55]
    ds_read_b64_tr_b16 v[112:113], v19 offset:0
    v_mfma_f32_16x16x32_bf16 v[64:67], v[144:147], v[124:127], v[64:67]
    ds_read_b64_tr_b16 v[114:115], v19 offset:768
    buffer_load_dwordx4 v7, s[48:51], s79 offen offset:3072 lds
    s_add_u32 m0, m0, 4096
    v_mfma_f32_16x16x32_bf16 v[68:71], v[144:147], v[128:131], v[68:71]
    v_mfma_f32_16x16x32_bf16 v[56:59], v[140:143], v[132:135], v[56:59]
    ds_read_b128 v[100:103], v14 offset:2048
    v_mfma_f32_16x16x32_bf16 v[72:75], v[144:147], v[132:135], v[72:75]
    ds_read_b64_tr_b16 v[116:117], v20 offset:0
    buffer_load_dwordx4 v8, s[52:55], s37 offen offset:0 lds
    s_add_u32 s79, s79, 128
    v_mfma_f32_16x16x32_bf16 v[60:63], v[140:143], v[136:139], v[60:63]
    ds_read_b64_tr_b16 v[118:119], v20 offset:768
    v_mfma_f32_16x16x32_bf16 v[76:79], v[144:147], v[136:139], v[76:79]
    v_mfma_f32_16x16x32_bf16 v[80:83], v[148:151], v[124:127], v[80:83]
    ds_read_b128 v[104:107], v14 offset:7168
    buffer_load_dwordx4 v9, s[52:55], s37 offen offset:1024 lds
    s_cmp_ge_u32 s79, 1280
    s_cselect_b32 s79, 0, s79
    v_mfma_f32_16x16x32_bf16 v[84:87], v[148:151], v[128:131], v[84:87]
    ds_read_b128 v[108:111], v14 offset:9216
    v_mfma_f32_16x16x32_bf16 v[88:91], v[148:151], v[132:135], v[88:91]
    ds_read_b64_tr_b16 v[120:121], v21 offset:0
    ds_read_b64_tr_b16 v[122:123], v21 offset:768
    v_mfma_f32_16x16x32_bf16 v[92:95], v[148:151], v[136:139], v[92:95]
    buffer_load_dwordx4 v10, s[52:55], s37 offen offset:2048 lds
    s_waitcnt lgkmcnt(5)
    v_mfma_f32_16x16x32_bf16 v[48:51], v[112:115], v[96:99], v[48:51]
    ds_read_b128 v[124:127], v15 offset:0
    v_mfma_f32_16x16x32_bf16 v[52:55], v[112:115], v[100:103], v[52:55]
    ds_read_b64_tr_b16 v[140:141], v19 offset:14336
    s_waitcnt lgkmcnt(5)
    v_mfma_f32_16x16x32_bf16 v[64:67], v[116:119], v[96:99], v[64:67]
    ds_read_b64_tr_b16 v[142:143], v19 offset:15104
    v_mfma_f32_16x16x32_bf16 v[68:71], v[116:119], v[100:103], v[68:71]
    s_mov_b64 exec, s[98:99]
    buffer_store_dword v30, v31, s[60:63], 0 offen sc1
    s_mov_b64 exec, -1
    v_mfma_f32_16x16x32_bf16 v[56:59], v[112:115], v[104:107], v[56:59]
    ds_read_b128 v[128:131], v15 offset:2048
    v_mfma_f32_16x16x32_bf16 v[72:75], v[116:119], v[104:107], v[72:75]
    ds_read_b64_tr_b16 v[144:145], v20 offset:14336
    s_waitcnt lgkmcnt(5)
    v_mfma_f32_16x16x32_bf16 v[60:63], v[112:115], v[108:111], v[60:63]
    ds_read_b64_tr_b16 v[146:147], v20 offset:15104
    v_mfma_f32_16x16x32_bf16 v[76:79], v[116:119], v[108:111], v[76:79]
    s_add_u32 m0, s78, 76032
    s_mul_i32 s37, s79, 1536
    buffer_load_dwordx4 v4, s[48:51], s79 offen offset:0 lds
    v_mfma_f32_16x16x32_bf16 v[80:83], v[120:123], v[96:99], v[80:83]
    ds_read_b128 v[132:135], v15 offset:7168
    v_mfma_f32_16x16x32_bf16 v[84:87], v[120:123], v[100:103], v[84:87]
    ds_read_b128 v[136:139], v15 offset:9216
    v_mfma_f32_16x16x32_bf16 v[88:91], v[120:123], v[104:107], v[88:91]
    ds_read_b64_tr_b16 v[148:149], v21 offset:14336
    ds_read_b64_tr_b16 v[150:151], v21 offset:15104
    v_mfma_f32_16x16x32_bf16 v[92:95], v[120:123], v[108:111], v[92:95]
    buffer_load_dwordx4 v5, s[48:51], s79 offen offset:1024 lds
    s_waitcnt vmcnt(10)
    s_waitcnt lgkmcnt(0)
    s_barrier
    v_mfma_f32_16x16x32_bf16 v[48:51], v[140:143], v[124:127], v[48:51]
    ds_read_b128 v[96:99], v14 offset:28672
    v_mfma_f32_16x16x32_bf16 v[52:55], v[140:143], v[128:131], v[52:55]
    ds_read_b64_tr_b16 v[112:113], v19 offset:28672
    v_mfma_f32_16x16x32_bf16 v[64:67], v[144:147], v[124:127], v[64:67]
    ds_read_b64_tr_b16 v[114:115], v19 offset:29440
    buffer_load_dwordx4 v6, s[48:51], s79 offen offset:2048 lds
    v_mfma_f32_16x16x32_bf16 v[68:71], v[144:147], v[128:131], v[68:71]
    v_mfma_f32_16x16x32_bf16 v[56:59], v[140:143], v[132:135], v[56:59]
    ds_read_b128 v[100:103], v14 offset:30720
    v_mfma_f32_16x16x32_bf16 v[72:75], v[144:147], v[132:135], v[72:75]
    ds_read_b64_tr_b16 v[116:117], v20 offset:28672
    buffer_load_dwordx4 v7, s[48:51], s79 offen offset:3072 lds
    s_add_u32 m0, m0, 4096
    v_mfma_f32_16x16x32_bf16 v[60:63], v[140:143], v[136:139], v[60:63]
    ds_read_b64_tr_b16 v[118:119], v20 offset:29440
    v_mfma_f32_16x16x32_bf16 v[76:79], v[144:147], v[136:139], v[76:79]
    v_mfma_f32_16x16x32_bf16 v[80:83], v[148:151], v[124:127], v[80:83]
    ds_read_b128 v[104:107], v14 offset:35840
    buffer_load_dwordx4 v8, s[52:55], s37 offen offset:0 lds
    s_add_u32 s79, s79, 128
    v_mfma_f32_16x16x32_bf16 v[84:87], v[148:151], v[128:131], v[84:87]
    ds_read_b128 v[108:111], v14 offset:37888
    v_mfma_f32_16x16x32_bf16 v[88:91], v[148:151], v[132:135], v[88:91]
    ds_read_b64_tr_b16 v[120:121], v21 offset:28672
    ds_read_b64_tr_b16 v[122:123], v21 offset:29440
    v_mfma_f32_16x16x32_bf16 v[92:95], v[148:151], v[136:139], v[92:95]
    buffer_load_dwordx4 v9, s[52:55], s37 offen offset:1024 lds
    s_cmp_ge_u32 s79, 1280
    s_cselect_b32 s79, 0, s79
    s_waitcnt lgkmcnt(5)
    v_mfma_f32_16x16x32_bf16 v[48:51], v[112:115], v[96:99], v[48:51]
    ds_read_b128 v[124:127], v15 offset:28672
    v_add_u32 v40, 0, v0
    v_mfma_f32_16x16x32_bf16 v[52:55], v[112:115], v[100:103], v[52:55]
    ds_read_b64_tr_b16 v[140:141], v19 offset:43008
    v_min_u32 v40, 503, v40
    s_waitcnt lgkmcnt(5)
    v_mfma_f32_16x16x32_bf16 v[64:67], v[116:119], v[96:99], v[64:67]
    ds_read_b64_tr_b16 v[142:143], v19 offset:43776
    v_mul_u32_u24 v41, 6242, v40
    v_mfma_f32_16x16x32_bf16 v[68:71], v[116:119], v[100:103], v[68:71]
    buffer_load_dwordx4 v10, s[52:55], s37 offen offset:2048 lds
    v_mfma_f32_16x16x32_bf16 v[56:59], v[112:115], v[104:107], v[56:59]
    ds_read_b128 v[128:131], v15 offset:30720
    v_lshrrev_b32 v41, 20, v41
    v_mfma_f32_16x16x32_bf16 v[72:75], v[116:119], v[104:107], v[72:75]
    ds_read_b64_tr_b16 v[144:145], v20 offset:43008
    v_mul_u32_u24 v41, 13088, v41
    s_waitcnt lgkmcnt(5)
    v_mfma_f32_16x16x32_bf16 v[60:63], v[112:115], v[108:111], v[60:63]
    ds_read_b64_tr_b16 v[146:147], v20 offset:43776
    v_lshl_add_u32 v212, v40, 4, v41
    v_mfma_f32_16x16x32_bf16 v[76:79], v[116:119], v[108:111], v[76:79]
    s_add_u32 m0, s78, 104704
    s_mul_i32 s37, s79, 1536
    buffer_load_dwordx4 v4, s[48:51], s79 offen offset:0 lds
    v_mfma_f32_16x16x32_bf16 v[80:83], v[120:123], v[96:99], v[80:83]
    ds_read_b128 v[132:135], v15 offset:35840
    v_subrev_u32 v214, 8, v212
    v_mfma_f32_16x16x32_bf16 v[84:87], v[120:123], v[100:103], v[84:87]
    ds_read_b128 v[136:139], v15 offset:37888
    v_add_u32 v40, 256, v0
    v_mfma_f32_16x16x32_bf16 v[88:91], v[120:123], v[104:107], v[88:91]
    ds_read_b64_tr_b16 v[148:149], v21 offset:43008
    ds_read_b64_tr_b16 v[150:151], v21 offset:43776
    v_min_u32 v40, 503, v40
    v_mfma_f32_16x16x32_bf16 v[92:95], v[120:123], v[108:111], v[92:95]
    buffer_load_dwordx4 v5, s[48:51], s79 offen offset:1024 lds
    s_waitcnt vmcnt(10)
    s_waitcnt lgkmcnt(0)
    s_barrier
    v_mfma_f32_16x16x32_bf16 v[48:51], v[140:143], v[124:127], v[48:51]
    ds_read_b128 v[96:99], v12 offset:0
    v_mul_u32_u24 v41, 6242, v40
    v_mfma_f32_16x16x32_bf16 v[52:55], v[140:143], v[128:131], v[52:55]
    ds_read_b64_tr_b16 v[112:113], v16 offset:0
    v_lshrrev_b32 v41, 20, v41
    v_mfma_f32_16x16x32_bf16 v[64:67], v[144:147], v[124:127], v[64:67]
    ds_read_b64_tr_b16 v[114:115], v16 offset:768
    buffer_load_dwordx4 v6, s[48:51], s79 offen offset:2048 lds
    v_mfma_f32_16x16x32_bf16 v[68:71], v[144:147], v[128:131], v[68:71]
    v_mul_u32_u24 v41, 13088, v41
    v_mfma_f32_16x16x32_bf16 v[56:59], v[140:143], v[132:135], v[56:59]
    ds_read_b128 v[100:103], v12 offset:2048
    v_lshl_add_u32 v213, v40, 4, v41
    v_mfma_f32_16x16x32_bf16 v[72:75], v[144:147], v[132:135], v[72:75]
    ds_read_b64_tr_b16 v[116:117], v17 offset:0
    buffer_load_dwordx4 v7, s[48:51], s79 offen offset:3072 lds
    s_add_u32 m0, m0, 4096
    v_mfma_f32_16x16x32_bf16 v[60:63], v[140:143], v[136:139], v[60:63]
    ds_read_b64_tr_b16 v[118:119], v17 offset:768
    v_subrev_u32 v215, 8, v213
    v_mfma_f32_16x16x32_bf16 v[76:79], v[144:147], v[136:139], v[76:79]
    v_max_i32 v214, 0, v214
    v_mfma_f32_16x16x32_bf16 v[80:83], v[148:151], v[124:127], v[80:83]
    ds_read_b128 v[104:107], v12 offset:7168
    buffer_load_dwordx4 v8, s[52:55], s37 offen offset:0 lds
    s_add_u32 s79, s79, 128
    v_mfma_f32_16x16x32_bf16 v[84:87], v[148:151], v[128:131], v[84:87]
    ds_read_b128 v[108:111], v12 offset:9216
    v_lshrrev_b32 v40, 3, v1
    v_mfma_f32_16x16x32_bf16 v[88:91], v[148:151], v[132:135], v[88:91]
    ds_read_b64_tr_b16 v[120:121], v18 offset:0
    ds_read_b64_tr_b16 v[122:123], v18 offset:768
    v_and_b32 v41, 112, v2
    v_mfma_f32_16x16x32_bf16 v[92:95], v[148:151], v[136:139], v[92:95]
    buffer_load_dwordx4 v9, s[52:55], s37 offen offset:1024 lds
    s_cmp_ge_u32 s79, 1280
    s_cselect_b32 s79, 0, s79
    s_waitcnt lgkmcnt(5)
    v_mfma_f32_16x16x32_bf16 v[48:51], v[112:115], v[96:99], v[48:51]
    ds_read_b128 v[124:127], v13 offset:0
    v_lshl_add_u32 v227, v40, 12, v41
    v_mfma_f32_16x16x32_bf16 v[52:55], v[112:115], v[100:103], v[52:55]
    ds_read_b64_tr_b16 v[140:141], v16 offset:14336
    v_mul_u32_u24 v40, 160, v40
    s_waitcnt lgkmcnt(5)
    v_mfma_f32_16x16x32_bf16 v[64:67], v[116:119], v[96:99], v[64:67]
    ds_read_b64_tr_b16 v[142:143], v16 offset:15104
    v_and_b32 v41, 4, v1
    v_mfma_f32_16x16x32_bf16 v[68:71], v[116:119], v[100:103], v[68:71]
    buffer_load_dwordx4 v10, s[52:55], s37 offen offset:2048 lds
    v_mfma_f32_16x16x32_bf16 v[56:59], v[112:115], v[104:107], v[56:59]
    ds_read_b128 v[128:131], v13 offset:2048
    v_lshl_add_u32 v40, v41, 2, v40
    v_mfma_f32_16x16x32_bf16 v[72:75], v[116:119], v[104:107], v[72:75]
    ds_read_b64_tr_b16 v[144:145], v17 offset:14336
    v_lshl_add_u32 v40, v47, 5, v40
    s_waitcnt lgkmcnt(5)
    v_mfma_f32_16x16x32_bf16 v[60:63], v[112:115], v[108:111], v[60:63]
    ds_read_b64_tr_b16 v[146:147], v17 offset:15104
    s_mul_i32 s4, s8, 3200
    v_mfma_f32_16x16x32_bf16 v[76:79], v[116:119], v[108:111], v[76:79]
    s_add_u32 m0, s78, 133376
    s_mul_i32 s37, s79, 1536
    buffer_load_dwordx4 v4, s[48:51], s79 offen offset:0 lds
    v_mfma_f32_16x16x32_bf16 v[80:83], v[120:123], v[96:99], v[80:83]
    ds_read_b128 v[132:135], v13 offset:7168
    s_add_u32 s4, s4, 145664
    v_mfma_f32_16x16x32_bf16 v[84:87], v[120:123], v[100:103], v[84:87]
    ds_read_b128 v[136:139], v13 offset:9216
    v_add_u32 v228, s4, v40
    v_mfma_f32_16x16x32_bf16 v[88:91], v[120:123], v[104:107], v[88:91]
L_padL0:
    s_cbranch_execz L_padL1
    s_nop 0
    ds_read_b64_tr_b16 v[148:149], v18 offset:14336
    ds_read_b64_tr_b16 v[150:151], v18 offset:15104
    v_mul_u32_u24 v40, 3200, v28
    v_mfma_f32_16x16x32_bf16 v[92:95], v[120:123], v[108:111], v[92:95]
    buffer_load_dwordx4 v5, s[48:51], s79 offen offset:1024 lds
    s_waitcnt vmcnt(9)
    s_waitcnt lgkmcnt(0)
    s_barrier
    v_mfma_f32_16x16x32_bf16 v[48:51], v[140:143], v[124:127], v[48:51]
    ds_read_b128 v[96:99], v12 offset:28672
    s_load_dwordx8 s[16:23], s[46:47], s85 offset:393216 glc
    v_mfma_f32_16x16x32_bf16 v[52:55], v[140:143], v[128:131], v[52:55]
    ds_read_b64_tr_b16 v[112:113], v16 offset:28672
    s_load_dwordx8 s[24:31], s[46:47], s86 offset:0 glc
    v_mfma_f32_16x16x32_bf16 v[64:67], v[144:147], v[124:127], v[64:67]
    ds_read_b64_tr_b16 v[114:115], v16 offset:29440
    buffer_load_dwordx4 v6, s[48:51], s79 offen offset:2048 lds
    v_mfma_f32_16x16x32_bf16 v[68:71], v[144:147], v[128:131], v[68:71]
    v_mul_u32_u24 v41, 160, v46
    v_mfma_f32_16x16x32_bf16 v[56:59], v[140:143], v[132:135], v[56:59]
    ds_read_b128 v[100:103], v12 offset:30720
    s_lshl_b32 s4, s8, 5
    v_mfma_f32_16x16x32_bf16 v[72:75], v[144:147], v[132:135], v[72:75]
    ds_read_b64_tr_b16 v[116:117], v17 offset:28672
    buffer_load_dwordx4 v7, s[48:51], s79 offen offset:3072 lds
    s_add_u32 m0, m0, 4096
    v_mfma_f32_16x16x32_bf16 v[60:63], v[140:143], v[136:139], v[60:63]
    ds_read_b64_tr_b16 v[118:119], v17 offset:29440
    s_add_u32 s4, s4, 145664
    v_mfma_f32_16x16x32_bf16 v[76:79], v[144:147], v[136:139], v[76:79]
    v_add3_u32 v40, v40, v41, s4
    v_mfma_f32_16x16x32_bf16 v[80:83], v[148:151], v[124:127], v[80:83]
    ds_read_b128 v[104:107], v12 offset:35840
    buffer_load_dwordx4 v8, s[52:55], s37 offen offset:0 lds
    s_add_u32 s79, s79, 128
    v_mfma_f32_16x16x32_bf16 v[84:87], v[148:151], v[128:131], v[84:87]
    ds_read_b128 v[108:111], v12 offset:37888
    v_lshl_add_u32 v229, v47, 3, v40
    v_mfma_f32_16x16x32_bf16 v[88:91], v[148:151], v[132:135], v[88:91]
    ds_read_b64_tr_b16 v[120:121], v18 offset:28672
    ds_read_b64_tr_b16 v[122:123], v18 offset:29440
    v_lshlrev_b32 v40, 9, v28
    v_mfma_f32_16x16x32_bf16 v[92:95], v[148:151], v[136:139], v[92:95]
    buffer_load_dwordx4 v9, s[52:55], s37 offen offset:1024 lds
    s_cmp_ge_u32 s79, 1280
    s_cselect_b32 s79, 0, s79
    s_waitcnt lgkmcnt(5)
    v_mfma_f32_16x16x32_bf16 v[48:51], v[112:115], v[96:99], v[48:51]
    ds_read_b128 v[124:127], v13 offset:28672
    v_lshl_add_u32 v237, v29, 2, v40
    v_mfma_f32_16x16x32_bf16 v[52:55], v[112:115], v[100:103], v[52:55]
    ds_read_b64_tr_b16 v[140:141], v16 offset:43008
    s_mul_i32 s4, s8, 3072
    s_waitcnt lgkmcnt(5)
    v_mfma_f32_16x16x32_bf16 v[64:67], v[116:119], v[96:99], v[64:67]
    ds_read_b64_tr_b16 v[142:143], v16 offset:43776
    s_add_u32 s4, s4, 133376
    v_mfma_f32_16x16x32_bf16 v[68:71], v[116:119], v[100:103], v[68:71]
    buffer_load_dwordx4 v10, s[52:55], s37 offen offset:2048 lds
    v_mfma_f32_16x16x32_bf16 v[56:59], v[112:115], v[104:107], v[56:59]
    ds_read_b128 v[128:131], v13 offset:30720
    v_mul_u32_u24 v40, 40, v28
    v_mfma_f32_16x16x32_bf16 v[72:75], v[116:119], v[104:107], v[72:75]
    ds_read_b64_tr_b16 v[144:145], v17 offset:43008
    v_mul_u32_u24 v41, 176, v29
    s_waitcnt lgkmcnt(5)
    v_mfma_f32_16x16x32_bf16 v[60:63], v[112:115], v[108:111], v[60:63]
    ds_read_b64_tr_b16 v[146:147], v17 offset:43776
    v_add3_u32 v230, v40, v41, s4
    v_mfma_f32_16x16x32_bf16 v[76:79], v[116:119], v[108:111], v[76:79]
    s_add_u32 m0, s78, 47360
    s_mul_i32 s37, s79, 1536
    buffer_load_dwordx4 v4, s[48:51], s79 offen offset:0 lds
    v_mfma_f32_16x16x32_bf16 v[80:83], v[120:123], v[96:99], v[80:83]
    ds_read_b128 v[132:135], v13 offset:35840
    v_lshrrev_b32 v41, 3, v1
    v_mfma_f32_16x16x32_bf16 v[84:87], v[120:123], v[100:103], v[84:87]
    ds_read_b128 v[136:139], v13 offset:37888
    v_mul_u32_u24 v42, 48, v41
    v_mfma_f32_16x16x32_bf16 v[88:91], v[120:123], v[104:107], v[88:91]
    ds_read_b64_tr_b16 v[148:149], v18 offset:43008
    ds_read_b64_tr_b16 v[150:151], v18 offset:43776
    v_add3_u32 v231, v42, v2, s4
    v_mfma_f32_16x16x32_bf16 v[92:95], v[120:123], v[108:111], v[92:95]
    buffer_load_dwordx4 v5, s[48:51], s79 offen offset:1024 lds
    s_waitcnt vmcnt(9)
    s_waitcnt lgkmcnt(0)
    s_barrier
    v_mfma_f32_16x16x32_bf16 v[48:51], v[140:143], v[124:127], v[48:51]
    ds_read_b128 v[96:99], v14 offset:0
    s_waitcnt lgkmcnt(0)
    v_mfma_f32_16x16x32_bf16 v[52:55], v[140:143], v[128:131], v[52:55]
    ds_read_b64_tr_b16 v[112:113], v19 offset:0
    s_xor_b64 s[24:25], s[24:25], s[6:7]
    s_xor_b64 s[26:27], s[26:27], s[6:7]
    v_mfma_f32_16x16x32_bf16 v[64:67], v[144:147], v[124:127], v[64:67]
    ds_read_b64_tr_b16 v[114:115], v19 offset:768
    buffer_load_dwordx4 v6, s[48:51], s79 offen offset:2048 lds
    v_mfma_f32_16x16x32_bf16 v[68:71], v[144:147], v[128:131], v[68:71]
    s_or_b64 s[24:25], s[24:25], s[26:27]
    s_xor_b64 s[28:29], s[28:29], s[6:7]
    v_mfma_f32_16x16x32_bf16 v[56:59], v[140:143], v[132:135], v[56:59]
    ds_read_b128 v[100:103], v14 offset:2048
    s_or_b64 s[24:25], s[24:25], s[28:29]
    s_xor_b64 s[30:31], s[30:31], s[6:7]
    v_mfma_f32_16x16x32_bf16 v[72:75], v[144:147], v[132:135], v[72:75]
    ds_read_b64_tr_b16 v[116:117], v20 offset:0
    buffer_load_dwordx4 v7, s[48:51], s79 offen offset:3072 lds
    s_add_u32 m0, m0, 4096
    v_mfma_f32_16x16x32_bf16 v[60:63], v[140:143], v[136:139], v[60:63]
    ds_read_b64_tr_b16 v[118:119], v20 offset:768
    s_or_b64 s[24:25], s[24:25], s[30:31]
    s_cbranch_scc1 L_sw_slow
L_sw_ok:
    v_mfma_f32_16x16x32_bf16 v[76:79], v[144:147], v[136:139], v[76:79]
    s_xor_b64 s[16:17], s[16:17], s[6:7]
    s_xor_b64 s[18:19], s[18:19], s[6:7]
    v_mfma_f32_16x16x32_bf16 v[80:83], v[148:151], v[124:127], v[80:83]
    ds_read_b128 v[104:107], v14 offset:7168
    buffer_load_dwordx4 v8, s[52:55], s37 offen offset:0 lds
    s_add_u32 s79, s79, 128
    v_mfma_f32_16x16x32_bf16 v[84:87], v[148:151], v[128:131], v[84:87]
    ds_read_b128 v[108:111], v14 offset:9216
    s_or_b64 s[16:17], s[16:17], s[18:19]
    s_xor_b64 s[20:21], s[20:21], s[6:7]
    v_mfma_f32_16x16x32_bf16 v[88:91], v[148:151], v[132:135], v[88:91]
    ds_read_b64_tr_b16 v[120:121], v21 offset:0
    ds_read_b64_tr_b16 v[122:123], v21 offset:768
    s_or_b64 s[16:17], s[16:17], s[20:21]
    s_xor_b64 s[22:23], s[22:23], s[6:7]
    v_mfma_f32_16x16x32_bf16 v[92:95], v[148:151], v[136:139], v[92:95]
    buffer_load_dwordx4 v9, s[52:55], s37 offen offset:1024 lds
    s_cmp_ge_u32 s79, 1280
    s_cselect_b32 s79, 0, s79
    s_waitcnt lgkmcnt(5)
    v_mfma_f32_16x16x32_bf16 v[48:51], v[112:115], v[96:99], v[48:51]
    ds_read_b128 v[124:127], v15 offset:0
    s_or_b64 s[16:17], s[16:17], s[22:23]
    s_cbranch_scc1 L_su_slow
L_su_ok:
    v_mfma_f32_16x16x32_bf16 v[52:55], v[112:115], v[100:103], v[52:55]
    ds_read_b64_tr_b16 v[140:141], v19 offset:14336
    v_mul_u32_u24 v42, 1152, v41
    s_waitcnt lgkmcnt(5)
    v_mfma_f32_16x16x32_bf16 v[64:67], v[116:119], v[96:99], v[64:67]
    ds_read_b64_tr_b16 v[142:143], v19 offset:15104
    v_add_u32 v234, v42, v2
    v_mfma_f32_16x16x32_bf16 v[68:71], v[116:119], v[100:103], v[68:71]
    buffer_load_dwordx4 v10, s[52:55], s37 offen offset:2048 lds
    v_mfma_f32_16x16x32_bf16 v[56:59], v[112:115], v[104:107], v[56:59]
    ds_read_b128 v[128:131], v15 offset:2048
    v_lshrrev_b32 v41, 1, v44
    v_mfma_f32_16x16x32_bf16 v[72:75], v[116:119], v[104:107], v[72:75]
    ds_read_b64_tr_b16 v[144:145], v20 offset:14336
    v_lshlrev_b32 v40, 4, v44
    s_waitcnt lgkmcnt(5)
    v_mfma_f32_16x16x32_bf16 v[60:63], v[112:115], v[108:111], v[60:63]
    ds_read_b64_tr_b16 v[146:147], v20 offset:15104
    v_mul_u32_u24 v42, 144, v41
    v_mfma_f32_16x16x32_bf16 v[76:79], v[116:119], v[108:111], v[76:79]
    s_add_u32 m0, s78, 76032
    s_mul_i32 s37, s79, 1536
    buffer_load_dwordx4 v4, s[48:51], s79 offen offset:0 lds
    v_mfma_f32_16x16x32_bf16 v[80:83], v[120:123], v[96:99], v[80:83]
    ds_read_b128 v[132:135], v15 offset:7168
    v_add3_u32 v232, v42, v40, s4
    v_mfma_f32_16x16x32_bf16 v[84:87], v[120:123], v[100:103], v[84:87]
    ds_read_b128 v[136:139], v15 offset:9216
    v_mul_u32_u24 v42, 1248, v41
    v_mfma_f32_16x16x32_bf16 v[88:91], v[120:123], v[104:107], v[88:91]
    ds_read_b64_tr_b16 v[148:149], v21 offset:14336
    ds_read_b64_tr_b16 v[150:151], v21 offset:15104
    v_add_u32 v235, v42, v40
    v_mfma_f32_16x16x32_bf16 v[92:95], v[120:123], v[108:111], v[92:95]
    buffer_load_dwordx4 v5, s[48:51], s79 offen offset:1024 lds
    s_waitcnt vmcnt(9)
    s_barrier
    s_waitcnt lgkmcnt(5)
    v_mfma_f32_16x16x32_bf16 v[48:51], v[140:143], v[124:127], v[48:51]
    ds_read_b128 v[96:99], v14 offset:28672
    v_mfma_f32_16x16x32_bf16 v[52:55], v[140:143], v[128:131], v[52:55]
    ds_read_b64_tr_b16 v[112:113], v19 offset:28672
    s_waitcnt lgkmcnt(5)
    v_mfma_f32_16x16x32_bf16 v[64:67], v[144:147], v[124:127], v[64:67]
    ds_read_b64_tr_b16 v[114:115], v19 offset:29440
    buffer_load_dwordx4 v6, s[48:51], s79 offen offset:2048 lds
    v_mfma_f32_16x16x32_bf16 v[68:71], v[144:147], v[128:131], v[68:71]
    v_mfma_f32_16x16x32_bf16 v[56:59], v[140:143], v[132:135], v[56:59]
    ds_read_b128 v[100:103], v14 offset:30720
    v_mfma_f32_16x16x32_bf16 v[72:75], v[144:147], v[132:135], v[72:75]
    ds_read_b64_tr_b16 v[116:117], v20 offset:28672
    buffer_load_dwordx4 v7, s[48:51], s79 offen offset:3072 lds
    s_add_u32 m0, m0, 4096
    s_waitcnt lgkmcnt(5)
    v_mfma_f32_16x16x32_bf16 v[60:63], v[140:143], v[136:139], v[60:63]
    ds_read_b64_tr_b16 v[118:119], v20 offset:29440
    v_mfma_f32_16x16x32_bf16 v[76:79], v[144:147], v[136:139], v[76:79]
    v_mfma_f32_16x16x32_bf16 v[80:83], v[148:151], v[124:127], v[80:83]
    ds_read_b128 v[104:107], v14 offset:35840
    buffer_load_dwordx4 v8, s[52:55], s37 offen offset:0 lds
    s_add_u32 s79, s79, 128
    v_mfma_f32_16x16x32_bf16 v[84:87], v[148:151], v[128:131], v[84:87]
    ds_read_b128 v[108:111], v14 offset:37888
    v_mfma_f32_16x16x32_bf16 v[88:91], v[148:151], v[132:135], v[88:91]
    ds_read_b64_tr_b16 v[120:121], v21 offset:28672
    ds_read_b64_tr_b16 v[122:123], v21 offset:29440
    v_mfma_f32_16x16x32_bf16 v[92:95], v[148:151], v[136:139], v[92:95]
    buffer_load_dwordx4 v9, s[52:55], s37 offen offset:1024 lds
    s_cmp_ge_u32 s79, 1280
    s_cselect_b32 s79, 0, s79
    s_waitcnt lgkmcnt(5)
    v_mfma_f32_16x16x32_bf16 v[48:51], v[112:115], v[96:99], v[48:51]
    ds_read_b128 v[124:127], v15 offset:28672
    v_mfma_f32_16x16x32_bf16 v[52:55], v[112:115], v[100:103], v[52:55]
    ds_read_b64_tr_b16 v[140:141], v19 offset:43008
    s_waitcnt lgkmcnt(5)
    v_mfma_f32_16x16x32_bf16 v[64:67], v[116:119], v[96:99], v[64:67]
    ds_read_b64_tr_b16 v[142:143], v19 offset:43776
    v_mfma_f32_16x16x32_bf16 v[68:71], v[116:119], v[100:103], v[68:71]
    buffer_load_dwordx4 v10, s[52:55], s37 offen offset:2048 lds
    v_mfma_f32_16x16x32_bf16 v[56:59], v[112:115], v[104:107], v[56:59]
    ds_read_b128 v[128:131], v15 offset:30720
    v_mfma_f32_16x16x32_bf16 v[72:75], v[116:119], v[104:107], v[72:75]
    ds_read_b64_tr_b16 v[144:145], v20 offset:43008
    s_waitcnt lgkmcnt(5)
    v_mfma_f32_16x16x32_bf16 v[60:63], v[112:115], v[108:111], v[60:63]
    ds_read_b64_tr_b16 v[146:147], v20 offset:43776
    v_mfma_f32_16x16x32_bf16 v[76:79], v[116:119], v[108:111], v[76:79]
    buffer_load_dwordx4 v[160:163], v2, s[60:63], s88 offen sc1
    v_mfma_f32_16x16x32_bf16 v[80:83], v[120:123], v[96:99], v[80:83]
    ds_read_b128 v[132:135], v15 offset:35840
    v_mfma_f32_16x16x32_bf16 v[84:87], v[120:123], v[100:103], v[84:87]
    ds_read_b128 v[136:139], v15 offset:37888
    v_mfma_f32_16x16x32_bf16 v[88:91], v[120:123], v[104:107], v[88:91]
    ds_read_b64_tr_b16 v[148:149], v21 offset:43008
    ds_read_b64_tr_b16 v[150:151], v21 offset:43776
    v_mfma_f32_16x16x32_bf16 v[92:95], v[120:123], v[108:111], v[92:95]
    buffer_load_dwordx4 v[164:167], v2, s[60:63], s89 offen sc1
    s_waitcnt vmcnt(9)
    s_barrier
    s_waitcnt lgkmcnt(5)
    v_mfma_f32_16x16x32_bf16 v[48:51], v[140:143], v[124:127], v[48:51]
    ds_read_b128 v[96:99], v12 offset:0
    s_min_u32 s4, s8, 2
    s_mul_i32 s4, s4, 4608
    s_add_u32 s4, s4, 108800
    v_lshl_add_u32 v23, v1, 3, s4
    v_mov_b32 v24, 0
    v_mov_b32 v25, 0
    ds_write_b64 v23, v[24:25]
    v_mfma_f32_16x16x32_bf16 v[52:55], v[140:143], v[128:131], v[52:55]
    ds_read_b64_tr_b16 v[112:113], v16 offset:0
    ds_read_b128 v[176:179], v212
    s_waitcnt lgkmcnt(5)
    v_mfma_f32_16x16x32_bf16 v[64:67], v[144:147], v[124:127], v[64:67]
    ds_read_b64_tr_b16 v[114:115], v16 offset:768
    buffer_load_dwordx4 v[168:171], v2, s[60:63], s90 offen sc1
    v_mfma_f32_16x16x32_bf16 v[68:71], v[144:147], v[128:131], v[68:71]
    ds_read_b64 v[174:175], v214
    v_mfma_f32_16x16x32_bf16 v[56:59], v[140:143], v[132:135], v[56:59]
    ds_read_b128 v[100:103], v12 offset:2048
    ds_read_b128 v[184:187], v213
    v_mfma_f32_16x16x32_bf16 v[72:75], v[144:147], v[132:135], v[72:75]
    ds_read_b64_tr_b16 v[116:117], v17 offset:0
    buffer_load_dwordx4 a[0:3], v2, s[60:63], s87 offen offset:0 sc1
    v_mfma_f32_16x16x32_bf16 v[60:63], v[140:143], v[136:139], v[60:63]
    ds_read_b64_tr_b16 v[118:119], v17 offset:768
    ds_read_b64 v[182:183], v215
    v_mfma_f32_16x16x32_bf16 v[76:79], v[144:147], v[136:139], v[76:79]
    s_waitcnt lgkmcnt(5)
    v_mfma_f32_16x16x32_bf16 v[80:83], v[148:151], v[124:127], v[80:83]
    ds_read_b128 v[104:107], v12 offset:7168
    buffer_load_dwordx4 a[4:7], v2, s[60:63], s87 offen offset:1024 sc1
    v_mfma_f32_16x16x32_bf16 v[84:87], v[148:151], v[128:131], v[84:87]
    ds_read_b128 v[108:111], v12 offset:9216
    v_mfma_f32_16x16x32_bf16 v[88:91], v[148:151], v[132:135], v[88:91]
    ds_read_b64_tr_b16 v[120:121], v18 offset:0
    ds_read_b64_tr_b16 v[122:123], v18 offset:768
    v_mfma_f32_16x16x32_bf16 v[92:95], v[148:151], v[136:139], v[92:95]
    buffer_load_dwordx4 a[8:11], v2, s[60:63], s87 offen offset:2048 sc1
    v_mfma_f32_16x16x32_bf16 v[48:51], v[112:115], v[96:99], v[48:51]
    ds_read_b128 v[124:127], v13 offset:0
    s_waitcnt lgkmcnt(5)
    v_mfma_f32_16x16x32_bf16 v[52:55], v[112:115], v[100:103], v[52:55]
    ds_read_b64_tr_b16 v[140:141], v16 offset:14336
    v_mfma_f32_16x16x32_bf16 v[64:67], v[116:119], v[96:99], v[64:67]
    ds_read_b64_tr_b16 v[142:143], v16 offset:15104
    v_mfma_f32_16x16x32_bf16 v[68:71], v[116:119], v[100:103], v[68:71]
    buffer_load_dwordx4 a[12:15], v2, s[60:63], s87 offen offset:3072 sc1
    s_add_u32 s87, s87, 4096
    s_waitcnt lgkmcnt(5)
    v_mfma_f32_16x16x32_bf16 v[56:59], v[112:115], v[104:107], v[56:59]
    ds_read_b128 v[128:131], v13 offset:2048
    v_mfma_f32_16x16x32_bf16 v[72:75], v[116:119], v[104:107], v[72:75]
    ds_read_b64_tr_b16 v[144:145], v17 offset:14336
    v_alignbit_b32 v188, v176, v175, 16
    v_mfma_f32_16x16x32_bf16 v[60:63], v[112:115], v[108:111], v[60:63]
    ds_read_b64_tr_b16 v[146:147], v17 offset:15104
    v_alignbit_b32 v189, v177, v176, 16
    v_mfma_f32_16x16x32_bf16 v[76:79], v[116:119], v[108:111], v[76:79]
    buffer_load_dwordx4 a[16:19], v2, s[60:63], s87 offen offset:0 sc1
    s_waitcnt lgkmcnt(5)
    v_mfma_f32_16x16x32_bf16 v[80:83], v[120:123], v[96:99], v[80:83]
    ds_read_b128 v[132:135], v13 offset:7168
    v_alignbit_b32 v190, v178, v177, 16
    v_mfma_f32_16x16x32_bf16 v[84:87], v[120:123], v[100:103], v[84:87]
    ds_read_b128 v[136:139], v13 offset:9216
    v_alignbit_b32 v191, v179, v178, 16
    v_mfma_f32_16x16x32_bf16 v[88:91], v[120:123], v[104:107], v[88:91]
    ds_read_b64_tr_b16 v[148:149], v18 offset:14336
    ds_read_b64_tr_b16 v[150:151], v18 offset:15104
    v_mov_b32 v192, v175
    v_mfma_f32_16x16x32_bf16 v[92:95], v[120:123], v[108:111], v[92:95]
    buffer_load_dwordx4 a[20:23], v2, s[60:63], s87 offen offset:1024 sc1
    s_waitcnt vmcnt(9)
    s_barrier
    s_waitcnt lgkmcnt(5)
    v_mfma_f32_16x16x32_bf16 v[48:51], v[140:143], v[124:127], v[48:51]
    ds_read_b128 v[96:99], v12 offset:28672
    v_mov_b32 v193, v176
    v_mfma_f32_16x16x32_bf16 v[52:55], v[140:143], v[128:131], v[52:55]
    ds_read_b64_tr_b16 v[112:113], v16 offset:28672
    v_mov_b32 v194, v177
    s_waitcnt lgkmcnt(5)
    v_mfma_f32_16x16x32_bf16 v[64:67], v[144:147], v[124:127], v[64:67]
    ds_read_b64_tr_b16 v[114:115], v16 offset:29440
    buffer_load_dwordx4 a[24:27], v2, s[60:63], s87 offen offset:2048 sc1
    v_mfma_f32_16x16x32_bf16 v[68:71], v[144:147], v[128:131], v[68:71]
    v_mov_b32 v195, v178
    v_mfma_f32_16x16x32_bf16 v[56:59], v[140:143], v[132:135], v[56:59]
    ds_read_b128 v[100:103], v12 offset:30720
    v_alignbit_b32 v196, v175, v174, 16
    v_mfma_f32_16x16x32_bf16 v[72:75], v[144:147], v[132:135], v[72:75]
    ds_read_b64_tr_b16 v[116:117], v17 offset:28672
    buffer_load_dwordx4 a[28:31], v2, s[60:63], s87 offen offset:3072 sc1
    s_add_u32 s87, s87, 4096
    s_waitcnt lgkmcnt(5)
    v_mfma_f32_16x16x32_bf16 v[60:63], v[140:143], v[136:139], v[60:63]
    ds_read_b64_tr_b16 v[118:119], v17 offset:29440
    v_alignbit_b32 v197, v176, v175, 16
    v_mfma_f32_16x16x32_bf16 v[76:79], v[144:147], v[136:139], v[76:79]
    v_alignbit_b32 v198, v177, v176, 16
    v_mfma_f32_16x16x32_bf16 v[80:83], v[148:151], v[124:127], v[80:83]
    ds_read_b128 v[104:107], v12 offset:35840
    buffer_load_dwordx4 a[32:35], v2, s[60:63], s87 offen offset:0 sc1
    v_mfma_f32_16x16x32_bf16 v[84:87], v[148:151], v[128:131], v[84:87]
    ds_read_b128 v[108:111], v12 offset:37888
    v_alignbit_b32 v199, v178, v177, 16
    v_mfma_f32_16x16x32_bf16 v[88:91], v[148:151], v[132:135], v[88:91]
    ds_read_b64_tr_b16 v[120:121], v18 offset:28672
    ds_read_b64_tr_b16 v[122:123], v18 offset:29440
    v_mfma_f32_16x16x32_bf16 v[92:95], v[148:151], v[136:139], v[92:95]
    buffer_load_dwordx4 a[36:39], v2, s[60:63], s87 offen offset:1024 sc1
    s_waitcnt lgkmcnt(5)
    v_mfma_f32_16x16x32_bf16 v[48:51], v[112:115], v[96:99], v[48:51]
    ds_read_b128 v[124:127], v13 offset:28672
    v_alignbit_b32 v200, v184, v183, 16
    v_mfma_f32_16x16x32_bf16 v[52:55], v[112:115], v[100:103], v[52:55]
    ds_read_b64_tr_b16 v[140:141], v16 offset:43008
    v_alignbit_b32 v201, v185, v184, 16
    s_waitcnt lgkmcnt(5)
    v_mfma_f32_16x16x32_bf16 v[64:67], v[116:119], v[96:99], v[64:67]
    ds_read_b64_tr_b16 v[142:143], v16 offset:43776
    v_alignbit_b32 v202, v186, v185, 16
    v_mfma_f32_16x16x32_bf16 v[68:71], v[116:119], v[100:103], v[68:71]
    buffer_load_dwordx4 a[40:43], v2, s[60:63], s87 offen offset:2048 sc1
    v_mfma_f32_16x16x32_bf16 v[56:59], v[112:115], v[104:107], v[56:59]
    ds_read_b128 v[128:131], v13 offset:30720
    v_alignbit_b32 v203, v187, v186, 16
    v_mfma_f32_16x16x32_bf16 v[72:75], v[116:119], v[104:107], v[72:75]
    ds_read_b64_tr_b16 v[144:145], v17 offset:43008
    v_mov_b32 v204, v183
    s_waitcnt lgkmcnt(5)
    v_mfma_f32_16x16x32_bf16 v[60:63], v[112:115], v[108:111], v[60:63]
    ds_read_b64_tr_b16 v[146:147], v17 offset:43776
    v_mov_b32 v205, v184
    v_mfma_f32_16x16x32_bf16 v[76:79], v[116:119], v[108:111], v[76:79]
    buffer_load_dwordx4 a[44:47], v2, s[60:63], s87 offen offset:3072 sc1
    s_add_u32 s87, s87, 4096
    v_mfma_f32_16x16x32_bf16 v[80:83], v[120:123], v[96:99], v[80:83]
    ds_read_b128 v[132:135], v13 offset:35840
    v_mov_b32 v206, v185
    v_mfma_f32_16x16x32_bf16 v[84:87], v[120:123], v[100:103], v[84:87]
    ds_read_b128 v[136:139], v13 offset:37888
    v_mov_b32 v207, v186
    v_mfma_f32_16x16x32_bf16 v[88:91], v[120:123], v[104:107], v[88:91]
    ds_read_b64_tr_b16 v[148:149], v18 offset:43008
    ds_read_b64_tr_b16 v[150:151], v18 offset:43776
    v_alignbit_b32 v216, v183, v182, 16
    v_mfma_f32_16x16x32_bf16 v[92:95], v[120:123], v[108:111], v[92:95]
    buffer_load_dwordx4 a[48:51], v2, s[60:63], s87 offen offset:0 sc1
    s_waitcnt lgkmcnt(5)
    v_mfma_f32_16x16x32_bf16 v[48:51], v[140:143], v[124:127], v[48:51]
    s_waitcnt vmcnt(15)
    ds_write_b128 v238, v[160:163] offset:0
    v_mfma_f32_16x16x32_bf16 v[52:55], v[140:143], v[128:131], v[52:55]
    s_waitcnt lgkmcnt(5)
    v_mfma_f32_16x16x32_bf16 v[64:67], v[144:147], v[124:127], v[64:67]
    buffer_load_dwordx4 a[52:55], v2, s[60:63], s87 offen offset:1024 sc1
    v_mfma_f32_16x16x32_bf16 v[68:71], v[144:147], v[128:131], v[68:71]
    s_waitcnt lgkmcnt(4)
    v_mfma_f32_16x16x32_bf16 v[56:59], v[140:143], v[132:135], v[56:59]
    s_waitcnt vmcnt(15)
    ds_write_b128 v238, v[164:167] offset:4608
    v_mfma_f32_16x16x32_bf16 v[72:75], v[144:147], v[132:135], v[72:75]
    s_waitcnt lgkmcnt(4)
    v_mfma_f32_16x16x32_bf16 v[60:63], v[140:143], v[136:139], v[60:63]
    v_mfma_f32_16x16x32_bf16 v[76:79], v[144:147], v[136:139], v[76:79]
    s_waitcnt vmcnt(14)
    ds_write_b128 v238, v[168:171] offset:9216
    s_waitcnt lgkmcnt(3)
    v_mfma_f32_16x16x32_bf16 v[80:83], v[148:151], v[124:127], v[80:83]
    v_alignbit_b32 v217, v184, v183, 16
    v_mfma_f32_16x16x32_bf16 v[84:87], v[148:151], v[128:131], v[84:87]
    v_alignbit_b32 v218, v185, v184, 16
    v_mfma_f32_16x16x32_bf16 v[88:91], v[148:151], v[132:135], v[88:91]
    v_alignbit_b32 v219, v186, v185, 16
    v_mfma_f32_16x16x32_bf16 v[92:95], v[148:151], v[136:139], v[92:95]
    s_mov_b32 s72, 0xbfb8aa3b
    s_mov_b32 s73, 0xbfb8aa3b
    s_add_u32 s90, s91, 98304
    s_mov_b32 s74, 0xffff
    s_mov_b32 s75, 0xffff
    s_nop 0
    s_nop 0
    v_pk_mul_f32 v[96:97], v[48:49], s[72:73]
    v_pk_mul_f32 v[98:99], v[50:51], s[72:73]
    v_pk_mul_f32 v[100:101], v[52:53], s[72:73]
    v_pk_mul_f32 v[102:103], v[54:55], s[72:73]
    v_exp_f32 v96, v96
    v_exp_f32 v97, v97
    buffer_load_dwordx4 a[56:59], v2, s[60:63], s87 offen offset:2048 sc1
    v_exp_f32 v98, v98
    v_exp_f32 v99, v99
    v_exp_f32_e64 v100, v100
    ds_write_b128 v212, v[188:191] offset:3136
    v_exp_f32 v101, v101
    v_exp_f32 v102, v102
    v_exp_f32_e64 v103, v103
    v_pk_add_f32 v[96:97], v[96:97], 1.0 op_sel_hi:[1,0]
    v_pk_add_f32 v[98:99], v[98:99], 1.0 op_sel_hi:[1,0]
    v_pk_add_f32 v[100:101], v[100:101], 1.0 op_sel_hi:[1,0]
    v_pk_add_f32 v[102:103], v[102:103], 1.0 op_sel_hi:[1,0]
    v_rcp_f32 v96, v96
    v_rcp_f32 v97, v97
    v_rcp_f32 v98, v98
    v_rcp_f32 v99, v99
    buffer_load_dwordx4 a[60:63], v2, s[60:63], s87 offen offset:3072 sc1
    s_add_u32 s87, s87, 4096
    v_rcp_f32 v100, v100
    v_rcp_f32 v101, v101
    v_rcp_f32_e64 v102, v102
    ds_write_b128 v212, v[192:195] offset:6272
    v_rcp_f32_e64 v103, v103
    v_pk_mul_f32 v[96:97], v[96:97], v[48:49]
    v_pk_mul_f32 v[98:99], v[98:99], v[50:51]
    v_pk_mul_f32 v[100:101], v[100:101], v[52:53]
    v_pk_mul_f32 v[102:103], v[102:103], v[54:55]
    v_cvt_pk_bf16_f32 v208, v96, v97
    v_cvt_pk_bf16_f32 v210, v100, v101
    v_cvt_pk_bf16_f32 v209, v98, v99
    v_cvt_pk_bf16_f32 v211, v102, v103
    v_permlane16_swap_b32 v208, v210
    s_nop 0
    v_permlane16_swap_b32 v209, v211
    s_nop 0
    buffer_store_dwordx4 v[208:211], v239, s[60:63], s91 offen offset:0 sc1
    v_pk_mul_f32 v[104:105], v[56:57], s[72:73]
    v_pk_mul_f32 v[106:107], v[58:59], s[72:73]
    v_pk_mul_f32 v[108:109], v[60:61], s[72:73]
    v_pk_mul_f32 v[110:111], v[62:63], s[72:73]
    v_exp_f32 v104, v104
    v_exp_f32 v105, v105
    buffer_load_dwordx4 a[64:67], v2, s[60:63], s87 offen offset:0 sc1
    v_exp_f32 v106, v106
    v_exp_f32 v107, v107
    v_exp_f32_e64 v108, v108
    ds_write_b128 v212, v[196:199] offset:9408
    v_exp_f32 v109, v109
    v_exp_f32 v110, v110
    v_exp_f32_e64 v111, v111
    v_pk_add_f32 v[104:105], v[104:105], 1.0 op_sel_hi:[1,0]
    v_pk_add_f32 v[106:107], v[106:107], 1.0 op_sel_hi:[1,0]
    v_pk_add_f32 v[108:109], v[108:109], 1.0 op_sel_hi:[1,0]
    v_pk_add_f32 v[110:111], v[110:111], 1.0 op_sel_hi:[1,0]
    v_rcp_f32 v104, v104
    v_rcp_f32 v105, v105
    v_rcp_f32 v106, v106
    v_rcp_f32 v107, v107
    buffer_load_dwordx4 a[68:71], v2, s[60:63], s87 offen offset:1024 sc1
    v_rcp_f32 v108, v108
    v_rcp_f32 v109, v109
    v_rcp_f32 v110, v110
    v_rcp_f32 v111, v111
    v_pk_mul_f32 v[104:105], v[104:105], v[56:57]
    v_pk_mul_f32 v[106:107], v[106:107], v[58:59]
    v_pk_mul_f32 v[108:109], v[108:109], v[60:61]
    v_pk_mul_f32 v[110:111], v[110:111], v[62:63]
    v_cvt_pk_bf16_f32 v244, v104, v105
    v_cvt_pk_bf16_f32 v246, v108, v109
    v_cvt_pk_bf16_f32 v245, v106, v107
    v_cvt_pk_bf16_f32 v247, v110, v111
    v_permlane16_swap_b32 v244, v246
    s_nop 0
    v_permlane16_swap_b32 v245, v247
    s_nop 0
    buffer_store_dwordx4 v[244:247], v239, s[60:63], s90 offen offset:0 sc1
    v_pk_mul_f32 v[96:97], v[64:65], s[72:73]
    v_pk_mul_f32 v[98:99], v[66:67], s[72:73]
    v_pk_mul_f32 v[100:101], v[68:69], s[72:73]
    v_pk_mul_f32 v[102:103], v[70:71], s[72:73]
    v_exp_f32 v96, v96
    v_exp_f32 v97, v97
    buffer_load_dwordx4 a[72:75], v2, s[60:63], s87 offen offset:2048 sc1
    v_exp_f32 v98, v98
    v_exp_f32 v99, v99
    v_exp_f32_e64 v100, v100
    ds_write_b128 v213, v[200:203] offset:3136
    v_exp_f32 v101, v101
    v_exp_f32 v102, v102
    v_exp_f32_e64 v103, v103
    v_pk_add_f32 v[96:97], v[96:97], 1.0 op_sel_hi:[1,0]
    v_pk_add_f32 v[98:99], v[98:99], 1.0 op_sel_hi:[1,0]
    v_pk_add_f32 v[100:101], v[100:101], 1.0 op_sel_hi:[1,0]
    v_pk_add_f32 v[102:103], v[102:103], 1.0 op_sel_hi:[1,0]
    v_rcp_f32 v96, v96
    v_rcp_f32 v97, v97
    v_rcp_f32 v98, v98
    v_rcp_f32 v99, v99
    buffer_load_dwordx4 a[76:79], v2, s[60:63], s87 offen offset:3072 sc1
    s_add_u32 s87, s87, 4096
    v_rcp_f32 v100, v100
    v_rcp_f32 v101, v101
    v_rcp_f32 v102, v102
    v_rcp_f32 v103, v103
    v_pk_mul_f32 v[96:97], v[96:97], v[64:65]
    v_pk_mul_f32 v[98:99], v[98:99], v[66:67]
    v_pk_mul_f32 v[100:101], v[100:101], v[68:69]
    v_pk_mul_f32 v[102:103], v[102:103], v[70:71]
    v_cvt_pk_bf16_f32 v208, v96, v97
    v_cvt_pk_bf16_f32 v210, v100, v101
    v_cvt_pk_bf16_f32 v209, v98, v99
    v_cvt_pk_bf16_f32 v211, v102, v103
    v_permlane16_swap_b32 v208, v210
    s_nop 0
    v_permlane16_swap_b32 v209, v211
    s_nop 0
    buffer_store_dwordx4 v[208:211], v239, s[60:63], s91 offen offset:512 sc1
    v_pk_mul_f32 v[104:105], v[72:73], s[72:73]
    v_pk_mul_f32 v[106:107], v[74:75], s[72:73]
    v_pk_mul_f32 v[108:109], v[76:77], s[72:73]
    v_pk_mul_f32 v[110:111], v[78:79], s[72:73]
    v_exp_f32 v104, v104
    v_exp_f32 v105, v105
    buffer_load_dwordx4 a[80:83], v2, s[60:63], s87 offen offset:0 sc1
    v_exp_f32 v106, v106
    v_exp_f32 v107, v107
    v_exp_f32_e64 v108, v108
    ds_write_b128 v213, v[204:207] offset:6272
    v_exp_f32 v109, v109
    v_exp_f32 v110, v110
    v_exp_f32_e64 v111, v111
    v_pk_add_f32 v[104:105], v[104:105], 1.0 op_sel_hi:[1,0]
    v_pk_add_f32 v[106:107], v[106:107], 1.0 op_sel_hi:[1,0]
    v_pk_add_f32 v[108:109], v[108:109], 1.0 op_sel_hi:[1,0]
    v_pk_add_f32 v[110:111], v[110:111], 1.0 op_sel_hi:[1,0]
    v_rcp_f32 v104, v104
    v_rcp_f32 v105, v105
    v_rcp_f32 v106, v106
    v_rcp_f32 v107, v107
    buffer_load_dwordx4 a[84:87], v2, s[60:63], s87 offen offset:1024 sc1
    v_rcp_f32 v108, v108
    v_rcp_f32 v109, v109
    v_rcp_f32 v110, v110
    v_rcp_f32 v111, v111
    v_pk_mul_f32 v[104:105], v[104:105], v[72:73]
    v_pk_mul_f32 v[106:107], v[106:107], v[74:75]
    v_pk_mul_f32 v[108:109], v[108:109], v[76:77]
    v_pk_mul_f32 v[110:111], v[110:111], v[78:79]
    v_cvt_pk_bf16_f32 v244, v104, v105
    v_cvt_pk_bf16_f32 v246, v108, v109
    v_cvt_pk_bf16_f32 v245, v106, v107
    v_cvt_pk_bf16_f32 v247, v110, v111
    v_permlane16_swap_b32 v244, v246
    s_nop 0
    v_permlane16_swap_b32 v245, v247
    s_nop 0
    buffer_store_dwordx4 v[244:247], v239, s[60:63], s90 offen offset:512 sc1
    v_pk_mul_f32 v[96:97], v[80:81], s[72:73]
    v_pk_mul_f32 v[98:99], v[82:83], s[72:73]
    v_pk_mul_f32 v[100:101], v[84:85], s[72:73]
L_padL1:
    s_cbranch_execz L_backL
    s_nop 0
    v_pk_mul_f32 v[102:103], v[86:87], s[72:73]
    v_exp_f32 v96, v96
    v_exp_f32 v97, v97
    buffer_load_dwordx4 a[88:91], v2, s[60:63], s87 offen offset:2048 sc1
    v_exp_f32 v98, v98
    v_exp_f32 v99, v99
    v_exp_f32_e64 v100, v100
    ds_write_b128 v213, v[216:219] offset:9408
    v_exp_f32 v101, v101
    v_exp_f32 v102, v102
    v_exp_f32_e64 v103, v103
    v_pk_add_f32 v[96:97], v[96:97], 1.0 op_sel_hi:[1,0]
    v_pk_add_f32 v[98:99], v[98:99], 1.0 op_sel_hi:[1,0]
    v_pk_add_f32 v[100:101], v[100:101], 1.0 op_sel_hi:[1,0]
    v_pk_add_f32 v[102:103], v[102:103], 1.0 op_sel_hi:[1,0]
    v_rcp_f32 v96, v96
    v_rcp_f32 v97, v97
    v_rcp_f32 v98, v98
    v_rcp_f32 v99, v99
    buffer_load_dwordx4 a[92:95], v2, s[60:63], s87 offen offset:3072 sc1
    s_add_u32 s87, s87, 4096
    v_rcp_f32 v100, v100
    v_rcp_f32 v101, v101
    v_rcp_f32 v102, v102
    v_rcp_f32 v103, v103
    v_pk_mul_f32 v[96:97], v[96:97], v[80:81]
    v_pk_mul_f32 v[98:99], v[98:99], v[82:83]
    v_pk_mul_f32 v[100:101], v[100:101], v[84:85]
    v_pk_mul_f32 v[102:103], v[102:103], v[86:87]
    v_cvt_pk_bf16_f32 v208, v96, v97
    v_cvt_pk_bf16_f32 v210, v100, v101
    v_cvt_pk_bf16_f32 v209, v98, v99
    v_cvt_pk_bf16_f32 v211, v102, v103
    v_permlane16_swap_b32 v208, v210
    s_nop 0
    v_permlane16_swap_b32 v209, v211
    buffer_store_dwordx4 v[208:211], v239, s[60:63], s91 offen offset:1024 sc1
    s_waitcnt lgkmcnt(0)
    s_barrier
    s_cmp_eq_u32 s8, 3
    s_cbranch_scc1 L_cp3
    s_nop 0
    ds_read_b64_tr_b16 v[128:129], v32 offset:8
    ds_read_b64_tr_b16 v[130:131], v32 offset:0
    ds_read_b128 v[156:159], v33 offset:1984
    ds_read_b64_tr_b16 v[132:133], v32 offset:520
    ds_read_b64_tr_b16 v[134:135], v32 offset:512
    ds_read_b128 v[152:155], v33 offset:1472
    ds_read_b64_tr_b16 v[136:137], v32 offset:1032
    ds_read_b64_tr_b16 v[138:139], v32 offset:1024
    ds_read_b128 v[148:151], v33 offset:960
    ds_read_b64_tr_b16 v[140:141], v32 offset:1544
    ds_read_b64_tr_b16 v[142:143], v32 offset:1536
    ds_read_b128 v[144:147], v33 offset:448
    ds_read_b128 v[160:163], v33 offset:2496
    ds_read_b128 v[164:167], v33 offset:3008
    ds_read_b128 v[168:171], v33 offset:3520
    ds_read_b128 v[172:175], v33 offset:4032
    s_branch L_cpj
    s_nop 0
L_cp3:
    ds_read_b64_tr_b16 v[112:113], v32 offset:8
    ds_read_b64_tr_b16 v[114:115], v32 offset:0
    ds_read_b128 v[124:127], v33 offset:448
    ds_read_b128 v[128:131], v33 offset:960
    ds_read_b64_tr_b16 v[116:117], v32 offset:520
    ds_read_b64_tr_b16 v[118:119], v32 offset:512
    ds_read_b128 v[132:135], v33 offset:1472
    ds_read_b64_tr_b16 v[120:121], v32 offset:1032
    ds_read_b64_tr_b16 v[122:123], v32 offset:1024
    ds_read_b64_tr_b16 v[136:137], v32 offset:15784
    ds_read_b64_tr_b16 v[138:139], v32 offset:15776
    ds_read_b128 v[148:151], v33 offset:5056
    ds_read_b128 v[152:155], v33 offset:5568
    ds_read_b64_tr_b16 v[140:141], v32 offset:16296
    ds_read_b64_tr_b16 v[142:143], v32 offset:16288
    ds_read_b128 v[156:159], v33 offset:6080
    ds_read_b64_tr_b16 v[144:145], v32 offset:16808
    ds_read_b64_tr_b16 v[146:147], v32 offset:16800
L_cpj:
    v_pk_mul_f32 v[104:105], v[88:89], s[72:73]
    v_pk_mul_f32 v[106:107], v[90:91], s[72:73]
    v_pk_mul_f32 v[108:109], v[92:93], s[72:73]
    v_pk_mul_f32 v[110:111], v[94:95], s[72:73]
    v_exp_f32 v104, v104
    v_exp_f32 v105, v105
    buffer_load_dwordx4 a[96:99], v2, s[60:63], s87 offen offset:0 sc1
    v_exp_f32 v106, v106
    v_exp_f32 v107, v107
    v_exp_f32 v108, v108
    v_exp_f32 v109, v109
    v_exp_f32 v110, v110
    v_exp_f32 v111, v111
    v_pk_add_f32 v[104:105], v[104:105], 1.0 op_sel_hi:[1,0]
    v_pk_add_f32 v[106:107], v[106:107], 1.0 op_sel_hi:[1,0]
    v_pk_add_f32 v[108:109], v[108:109], 1.0 op_sel_hi:[1,0]
    v_pk_add_f32 v[110:111], v[110:111], 1.0 op_sel_hi:[1,0]
    v_rcp_f32 v104, v104
    v_rcp_f32 v105, v105
    v_rcp_f32 v106, v106
    v_rcp_f32 v107, v107
    buffer_load_dwordx4 a[100:103], v2, s[60:63], s87 offen offset:1024 sc1
    v_rcp_f32 v108, v108
    v_rcp_f32 v109, v109
    v_rcp_f32 v110, v110
    v_rcp_f32 v111, v111
    v_pk_mul_f32 v[104:105], v[104:105], v[88:89]
    v_pk_mul_f32 v[106:107], v[106:107], v[90:91]
    v_pk_mul_f32 v[108:109], v[108:109], v[92:93]
    v_pk_mul_f32 v[110:111], v[110:111], v[94:95]
    v_cvt_pk_bf16_f32 v244, v104, v105
    v_cvt_pk_bf16_f32 v246, v108, v109
    v_cvt_pk_bf16_f32 v245, v106, v107
    v_cvt_pk_bf16_f32 v247, v110, v111
    v_permlane16_swap_b32 v244, v246
    s_nop 0
    v_permlane16_swap_b32 v245, v247
    buffer_store_dwordx4 v[244:247], v239, s[60:63], s90 offen offset:1024 sc1
    s_cmp_eq_u32 s8, 3
    s_cbranch_scc1 L_conv3
    s_waitcnt lgkmcnt(5)
    v_mfma_f32_16x16x32_bf16 v[4:7], v[128:131], v[156:159], 0
    ds_read_b64_tr_b16 v[176:177], v32 offset:2056
    v_mfma_f32_16x16x32_bf16 v[4:7], v[132:135], v[152:155], v[4:7]
    buffer_load_dwordx4 a[104:107], v2, s[60:63], s87 offen offset:2048 sc1
    v_mfma_f32_16x16x32_bf16 v[4:7], v[136:139], v[148:151], v[4:7]
    ds_read_b64_tr_b16 v[178:179], v32 offset:2048
    s_waitcnt lgkmcnt(5)
    v_mfma_f32_16x16x32_bf16 v[4:7], v[140:143], v[144:147], v[4:7]
    ds_read_b128 v[112:115], v33 offset:432
    v_mfma_f32_16x16x32_bf16 v[8:11], v[132:135], v[156:159], 0
    ds_read_b128 v[116:119], v33 offset:944
    v_mfma_f32_16x16x32_bf16 v[8:11], v[136:139], v[152:155], v[8:11]
    buffer_load_dwordx4 a[108:111], v2, s[60:63], s87 offen offset:3072 sc1
    s_add_u32 s87, s87, 4096
    v_mfma_f32_16x16x32_bf16 v[8:11], v[140:143], v[148:151], v[8:11]
    ds_read_b128 v[120:123], v33 offset:1456
    v_mfma_f32_16x16x32_bf16 v[8:11], v[128:131], v[160:163], v[8:11]
    ds_read_b128 v[124:127], v33 offset:1968
    v_mfma_f32_16x16x32_bf16 v[12:15], v[136:139], v[156:159], 0
    ds_read_b64_tr_b16 v[48:49], v32 offset:72
    v_mfma_f32_16x16x32_bf16 v[12:15], v[140:143], v[152:155], v[12:15]
    buffer_load_dwordx4 a[112:115], v2, s[60:63], s87 offen offset:0 sc1
    v_mfma_f32_16x16x32_bf16 v[12:15], v[132:135], v[160:163], v[12:15]
    ds_read_b64_tr_b16 v[50:51], v32 offset:64
    s_waitcnt lgkmcnt(5)
    v_mfma_f32_16x16x32_bf16 v[12:15], v[128:131], v[164:167], v[12:15]
    ds_read_b128 v[76:79], v33 offset:1920
    v_mfma_f32_16x16x32_bf16 v[16:19], v[140:143], v[156:159], 0
    ds_read_b64_tr_b16 v[52:53], v32 offset:584
    v_mfma_f32_16x16x32_bf16 v[16:19], v[136:139], v[160:163], v[16:19]
    buffer_load_dwordx4 a[116:119], v2, s[60:63], s87 offen offset:1024 sc1
    v_mfma_f32_16x16x32_bf16 v[16:19], v[132:135], v[164:167], v[16:19]
    ds_read_b64_tr_b16 v[54:55], v32 offset:576
    v_mfma_f32_16x16x32_bf16 v[16:19], v[128:131], v[168:171], v[16:19]
    ds_read_b128 v[72:75], v33 offset:1408
    v_mfma_f32_16x16x32_bf16 v[20:23], v[140:143], v[160:163], 0
    ds_read_b64_tr_b16 v[56:57], v32 offset:1096
    v_mfma_f32_16x16x32_bf16 v[20:23], v[136:139], v[164:167], v[20:23]
    buffer_load_dwordx4 a[120:123], v2, s[60:63], s87 offen offset:2048 sc1
    v_mfma_f32_16x16x32_bf16 v[20:23], v[132:135], v[168:171], v[20:23]
    ds_read_b64_tr_b16 v[58:59], v32 offset:1088
    v_mfma_f32_16x16x32_bf16 v[20:23], v[128:131], v[172:175], v[20:23]
    ds_read_b128 v[68:71], v33 offset:896
    v_mfma_f32_16x16x32_bf16 v[8:11], v[176:179], v[144:147], v[8:11]
    ds_read_b64_tr_b16 v[60:61], v32 offset:1608
    v_mfma_f32_16x16x32_bf16 v[180:183], v[144:147], a[240:243], 0
    buffer_load_dwordx4 a[124:127], v2, s[60:63], s87 offen offset:3072 sc1
    s_add_u32 s87, s87, 4096
    v_mfma_f32_16x16x32_bf16 v[196:199], v[112:115], a[244:247], 0
    ds_read_b64_tr_b16 v[62:63], v32 offset:1600
    v_mfma_f32_16x16x32_bf16 v[12:15], v[176:179], v[148:151], v[12:15]
    ds_read_b128 v[64:67], v33 offset:384
    v_mfma_f32_16x16x32_bf16 v[184:187], v[148:151], a[240:243], 0
    ds_read_b128 v[80:83], v33 offset:2432
    s_waitcnt lgkmcnt(5)
    v_mfma_f32_16x16x32_bf16 v[200:203], v[116:119], a[244:247], 0
    buffer_load_dwordx4 a[128:131], v2, s[60:63], s87 offen offset:0 sc1
    v_mfma_f32_16x16x32_bf16 v[16:19], v[176:179], v[152:155], v[16:19]
    ds_read_b128 v[84:87], v33 offset:2944
    v_mfma_f32_16x16x32_bf16 v[188:191], v[152:155], a[240:243], 0
    ds_read_b128 v[88:91], v33 offset:3456
    v_mfma_f32_16x16x32_bf16 v[204:207], v[120:123], a[244:247], 0
    ds_read_b128 v[92:95], v33 offset:3968
    v_mfma_f32_16x16x32_bf16 v[20:23], v[176:179], v[156:159], v[20:23]
    buffer_load_dwordx4 a[132:135], v2, s[60:63], s87 offen offset:1024 sc1
    v_mfma_f32_16x16x32_bf16 v[192:195], v[156:159], a[240:243], 0
    v_mfma_f32_16x16x32_bf16 v[208:211], v[124:127], a[244:247], 0
    v_mfma_f32_16x16x32_bf16 v[4:7], v[48:51], v[76:79], v[4:7]
    ds_read_b64_tr_b16 v[128:129], v32 offset:136
    ds_read_b64_tr_b16 v[130:131], v32 offset:128
    v_mfma_f32_16x16x32_bf16 v[4:7], v[52:55], v[72:75], v[4:7]
    buffer_load_dwordx4 a[136:139], v2, s[60:63], s87 offen offset:2048 sc1
    s_waitcnt lgkmcnt(5)
    v_mfma_f32_16x16x32_bf16 v[4:7], v[56:59], v[68:71], v[4:7]
    ds_read_b128 v[156:159], v33 offset:1856
    ds_read_b64_tr_b16 v[132:133], v32 offset:648
    v_mfma_f32_16x16x32_bf16 v[4:7], v[60:63], v[64:67], v[4:7]
    ds_read_b64_tr_b16 v[134:135], v32 offset:640
    v_cvt_pk_bf16_f32 v96, v180, v181
    v_mfma_f32_16x16x32_bf16 v[8:11], v[52:55], v[76:79], v[8:11]
    ds_read_b128 v[152:155], v33 offset:1344
    ds_read_b64_tr_b16 v[136:137], v32 offset:1160
    v_cvt_pk_bf16_f32 v97, v182, v183
    v_mfma_f32_16x16x32_bf16 v[8:11], v[56:59], v[72:75], v[8:11]
    buffer_load_dwordx4 a[140:143], v2, s[60:63], s87 offen offset:3072 sc1
    s_add_u32 s87, s87, 4096
    v_cvt_pk_bf16_f32 v98, v184, v185
    v_mfma_f32_16x16x32_bf16 v[8:11], v[60:63], v[68:71], v[8:11]
    ds_read_b64_tr_b16 v[138:139], v32 offset:1152
    v_cvt_pk_bf16_f32 v99, v186, v187
    v_mfma_f32_16x16x32_bf16 v[8:11], v[48:51], v[80:83], v[8:11]
    ds_read_b128 v[148:151], v33 offset:832
    ds_read_b64_tr_b16 v[140:141], v32 offset:1672
    v_cvt_pk_bf16_f32 v100, v188, v189
    v_mfma_f32_16x16x32_bf16 v[12:15], v[56:59], v[76:79], v[12:15]
    ds_read_b64_tr_b16 v[142:143], v32 offset:1664
    ds_read_b128 v[144:147], v33 offset:320
    v_cvt_pk_bf16_f32 v101, v190, v191
    v_mfma_f32_16x16x32_bf16 v[12:15], v[60:63], v[72:75], v[12:15]
    s_waitcnt vmcnt(10)
    s_mov_b64 exec, 3
    buffer_store_dword v30, v224, s[60:63], s81 offen sc1
    s_mov_b64 exec, -1
    v_cvt_pk_bf16_f32 v102, v192, v193
    v_mfma_f32_16x16x32_bf16 v[12:15], v[52:55], v[80:83], v[12:15]
    ds_read_b128 v[160:163], v33 offset:2368
    v_cvt_pk_bf16_f32 v103, v194, v195
    s_waitcnt lgkmcnt(5)
    v_mfma_f32_16x16x32_bf16 v[12:15], v[48:51], v[84:87], v[12:15]
    ds_read_b128 v[164:167], v33 offset:2880
    ds_read_b128 v[168:171], v33 offset:3392
    v_cvt_pk_bf16_f32 v104, v196, v197
    v_mfma_f32_16x16x32_bf16 v[16:19], v[60:63], v[76:79], v[16:19]
    ds_read_b128 v[172:175], v33 offset:3904
    v_cvt_pk_bf16_f32 v105, v198, v199
    v_mfma_f32_16x16x32_bf16 v[16:19], v[56:59], v[80:83], v[16:19]
    buffer_load_dwordx4 a[144:147], v2, s[60:63], s87 offen offset:0 sc1
    v_cvt_pk_bf16_f32 v106, v200, v201
    v_mfma_f32_16x16x32_bf16 v[16:19], v[52:55], v[84:87], v[16:19]
    ds_read_b64_tr_b16 v[112:113], v225 offset:32
    ds_read_b64_tr_b16 v[114:115], v225 offset:0
    v_cvt_pk_bf16_f32 v107, v202, v203
    v_mfma_f32_16x16x32_bf16 v[16:19], v[48:51], v[88:91], v[16:19]
    ds_read_b64_tr_b16 v[116:117], v225 offset:64
    ds_read_b64_tr_b16 v[118:119], v225 offset:32
    v_cvt_pk_bf16_f32 v108, v204, v205
    v_mfma_f32_16x16x32_bf16 v[20:23], v[60:63], v[80:83], v[20:23]
    buffer_load_dwordx4 a[148:151], v2, s[60:63], s87 offen offset:1024 sc1
    v_cvt_pk_bf16_f32 v109, v206, v207
    v_mfma_f32_16x16x32_bf16 v[20:23], v[56:59], v[84:87], v[20:23]
    ds_read_b64_tr_b16 v[120:121], v225 offset:96
    v_cvt_pk_bf16_f32 v110, v208, v209
    v_mfma_f32_16x16x32_bf16 v[20:23], v[52:55], v[88:91], v[20:23]
    ds_read_b64_tr_b16 v[122:123], v225 offset:64
    ds_read_b64_tr_b16 v[124:125], v225 offset:128
    v_cvt_pk_bf16_f32 v111, v210, v211
    v_mfma_f32_16x16x32_bf16 v[20:23], v[48:51], v[92:95], v[20:23]
    ds_read_b64_tr_b16 v[126:127], v225 offset:96
    v_mfma_f32_16x16x32_bf16 v[4:7], v[128:131], v[156:159], v[4:7]
    buffer_load_dwordx4 a[152:155], v2, s[60:63], s87 offen offset:2048 sc1
    v_mfma_f32_16x16x32_bf16 v[4:7], v[132:135], v[152:155], v[4:7]
    ds_read_b64_tr_b16 v[48:49], v32 offset:200
    s_waitcnt lgkmcnt(5)
    v_mfma_f32_16x16x32_bf16 v[4:7], v[136:139], v[148:151], v[4:7]
    ds_read_b64_tr_b16 v[50:51], v32 offset:192
    v_mfma_f32_16x16x32_bf16 v[4:7], v[140:143], v[144:147], v[4:7]
    ds_read_b128 v[76:79], v33 offset:1792
    v_mfma_f32_16x16x32_bf16 v[8:11], v[132:135], v[156:159], v[8:11]
    buffer_load_dwordx4 a[156:159], v2, s[60:63], s87 offen offset:3072 sc1
    s_add_u32 s87, s87, 4096
    v_mfma_f32_16x16x32_bf16 v[8:11], v[136:139], v[152:155], v[8:11]
    ds_read_b64_tr_b16 v[52:53], v32 offset:712
    v_mfma_f32_16x16x32_bf16 v[8:11], v[140:143], v[148:151], v[8:11]
    ds_read_b64_tr_b16 v[54:55], v32 offset:704
    v_mfma_f32_16x16x32_bf16 v[8:11], v[128:131], v[160:163], v[8:11]
    ds_read_b128 v[72:75], v33 offset:1280
    v_mfma_f32_16x16x32_bf16 v[12:15], v[136:139], v[156:159], v[12:15]
    buffer_load_dwordx4 a[160:163], v2, s[60:63], s87 offen offset:0 sc1
    v_mfma_f32_16x16x32_bf16 v[12:15], v[140:143], v[152:155], v[12:15]
    ds_read_b64_tr_b16 v[56:57], v32 offset:1224
    v_mfma_f32_16x16x32_bf16 v[12:15], v[132:135], v[160:163], v[12:15]
    ds_read_b64_tr_b16 v[58:59], v32 offset:1216
    v_mfma_f32_16x16x32_bf16 v[12:15], v[128:131], v[164:167], v[12:15]
    ds_read_b128 v[68:71], v33 offset:768
    v_mfma_f32_16x16x32_bf16 v[16:19], v[140:143], v[156:159], v[16:19]
    buffer_load_dwordx4 a[164:167], v2, s[60:63], s87 offen offset:1024 sc1
    v_mfma_f32_16x16x32_bf16 v[16:19], v[136:139], v[160:163], v[16:19]
    ds_read_b64_tr_b16 v[60:61], v32 offset:1736
    v_mfma_f32_16x16x32_bf16 v[16:19], v[132:135], v[164:167], v[16:19]
    ds_read_b64_tr_b16 v[62:63], v32 offset:1728
    v_mfma_f32_16x16x32_bf16 v[16:19], v[128:131], v[168:171], v[16:19]
    ds_read_b128 v[64:67], v33 offset:256
    v_mfma_f32_16x16x32_bf16 v[20:23], v[140:143], v[160:163], v[20:23]
    buffer_load_dwordx4 a[168:171], v2, s[60:63], s87 offen offset:2048 sc1
    v_mfma_f32_16x16x32_bf16 v[20:23], v[136:139], v[164:167], v[20:23]
    ds_read_b128 v[80:83], v33 offset:2304
    v_mfma_f32_16x16x32_bf16 v[20:23], v[132:135], v[168:171], v[20:23]
    ds_read_b128 v[84:87], v33 offset:2816
    v_mfma_f32_16x16x32_bf16 v[20:23], v[128:131], v[172:175], v[20:23]
    ds_read_b128 v[88:91], v33 offset:3328
    v_mfma_f32_16x16x32_bf16 v[8:11], v[96:99], v[112:115], v[8:11]
    buffer_load_dwordx4 a[172:175], v2, s[60:63], s87 offen offset:3072 sc1
    s_add_u32 s87, s87, 4096
    v_mfma_f32_16x16x32_bf16 v[12:15], v[96:99], v[116:119], v[12:15]
    ds_read_b128 v[92:95], v33 offset:3840
    s_waitcnt lgkmcnt(5)
    v_mfma_f32_16x16x32_bf16 v[16:19], v[96:99], v[120:123], v[16:19]
    v_mfma_f32_16x16x32_bf16 v[16:19], v[100:103], v[112:115], v[16:19]
    v_mfma_f32_16x16x32_bf16 v[20:23], v[96:99], v[124:127], v[20:23]
    buffer_load_dwordx4 a[176:179], v2, s[60:63], s87 offen offset:0 sc1
    v_mfma_f32_16x16x32_bf16 v[20:23], v[100:103], v[116:119], v[20:23]
    v_mfma_f32_16x16x32_bf16 v[4:7], v[48:51], v[76:79], v[4:7]
    ds_read_b64_tr_b16 v[128:129], v32 offset:264
    ds_read_b64_tr_b16 v[130:131], v32 offset:256
    v_mfma_f32_16x16x32_bf16 v[4:7], v[52:55], v[72:75], v[4:7]
    ds_read_b128 v[156:159], v33 offset:1728
    ds_read_b64_tr_b16 v[132:133], v32 offset:776
    v_mfma_f32_16x16x32_bf16 v[4:7], v[56:59], v[68:71], v[4:7]
    buffer_load_dwordx4 a[180:183], v2, s[60:63], s87 offen offset:1024 sc1
    s_waitcnt lgkmcnt(5)
    v_mfma_f32_16x16x32_bf16 v[4:7], v[60:63], v[64:67], v[4:7]
    ds_read_b64_tr_b16 v[134:135], v32 offset:768
    v_mfma_f32_16x16x32_bf16 v[8:11], v[52:55], v[76:79], v[8:11]
    ds_read_b128 v[152:155], v33 offset:1216
    ds_read_b64_tr_b16 v[136:137], v32 offset:1288
    v_mfma_f32_16x16x32_bf16 v[8:11], v[56:59], v[72:75], v[8:11]
    ds_read_b64_tr_b16 v[138:139], v32 offset:1280
    v_mfma_f32_16x16x32_bf16 v[8:11], v[60:63], v[68:71], v[8:11]
    buffer_load_dwordx4 a[184:187], v2, s[60:63], s87 offen offset:2048 sc1
    v_mfma_f32_16x16x32_bf16 v[8:11], v[48:51], v[80:83], v[8:11]
    ds_read_b128 v[148:151], v33 offset:704
    ds_read_b64_tr_b16 v[140:141], v32 offset:1800
    v_mfma_f32_16x16x32_bf16 v[12:15], v[56:59], v[76:79], v[12:15]
    ds_read_b64_tr_b16 v[142:143], v32 offset:1792
    ds_read_b128 v[144:147], v33 offset:192
    v_mfma_f32_16x16x32_bf16 v[12:15], v[60:63], v[72:75], v[12:15]
    ds_read_b128 v[160:163], v33 offset:2240
    v_mfma_f32_16x16x32_bf16 v[12:15], v[52:55], v[80:83], v[12:15]
    buffer_load_dwordx4 a[188:191], v2, s[60:63], s87 offen offset:3072 sc1
    s_add_u32 s87, s87, 4096
    v_mfma_f32_16x16x32_bf16 v[12:15], v[48:51], v[84:87], v[12:15]
    ds_read_b128 v[164:167], v33 offset:2752
    ds_read_b128 v[168:171], v33 offset:3264
    v_mfma_f32_16x16x32_bf16 v[16:19], v[60:63], v[76:79], v[16:19]
    ds_read_b128 v[172:175], v33 offset:3776
    v_mfma_f32_16x16x32_bf16 v[16:19], v[56:59], v[80:83], v[16:19]
    ds_read_b64_tr_b16 v[112:113], v225 offset:288
    ds_read_b64_tr_b16 v[114:115], v225 offset:256
    v_mfma_f32_16x16x32_bf16 v[16:19], v[52:55], v[84:87], v[16:19]
    buffer_load_dwordx4 a[192:195], v2, s[60:63], s87 offen offset:0 sc1
    v_mfma_f32_16x16x32_bf16 v[16:19], v[48:51], v[88:91], v[16:19]
    ds_read_b64_tr_b16 v[116:117], v225 offset:320
    ds_read_b64_tr_b16 v[118:119], v225 offset:288
    v_mfma_f32_16x16x32_bf16 v[20:23], v[60:63], v[80:83], v[20:23]
    ds_read_b64_tr_b16 v[120:121], v225 offset:352
    v_mfma_f32_16x16x32_bf16 v[20:23], v[56:59], v[84:87], v[20:23]
    buffer_load_dwordx4 a[196:199], v2, s[60:63], s87 offen offset:1024 sc1
    v_mfma_f32_16x16x32_bf16 v[20:23], v[52:55], v[88:91], v[20:23]
    ds_read_b64_tr_b16 v[122:123], v225 offset:320
    ds_read_b64_tr_b16 v[124:125], v225 offset:384
    s_waitcnt lgkmcnt(5)
    v_mfma_f32_16x16x32_bf16 v[20:23], v[48:51], v[92:95], v[20:23]
    ds_read_b64_tr_b16 v[126:127], v225 offset:352
    s_load_dwordx8 s[16:23], s[46:47], s92 offset:131072 glc
    v_mfma_f32_16x16x32_bf16 v[4:7], v[128:131], v[156:159], v[4:7]
    ds_read_b64_tr_b16 v[48:49], v32 offset:328
    v_mfma_f32_16x16x32_bf16 v[4:7], v[132:135], v[152:155], v[4:7]
    buffer_load_dwordx4 a[200:203], v2, s[60:63], s87 offen offset:2048 sc1
    v_mfma_f32_16x16x32_bf16 v[4:7], v[136:139], v[148:151], v[4:7]
    ds_read_b64_tr_b16 v[50:51], v32 offset:320
    v_mfma_f32_16x16x32_bf16 v[4:7], v[140:143], v[144:147], v[4:7]
    ds_read_b128 v[76:79], v33 offset:1664
    v_mfma_f32_16x16x32_bf16 v[8:11], v[132:135], v[156:159], v[8:11]
    ds_read_b64_tr_b16 v[52:53], v32 offset:840
    v_mfma_f32_16x16x32_bf16 v[8:11], v[136:139], v[152:155], v[8:11]
    buffer_load_dwordx4 a[204:207], v2, s[60:63], s87 offen offset:3072 sc1
    s_add_u32 s87, s87, 4096
    v_mfma_f32_16x16x32_bf16 v[8:11], v[140:143], v[148:151], v[8:11]
    ds_read_b64_tr_b16 v[54:55], v32 offset:832
    v_mfma_f32_16x16x32_bf16 v[8:11], v[128:131], v[160:163], v[8:11]
    ds_read_b128 v[72:75], v33 offset:1152
    v_mfma_f32_16x16x32_bf16 v[12:15], v[136:139], v[156:159], v[12:15]
    ds_read_b64_tr_b16 v[56:57], v32 offset:1352
    v_mfma_f32_16x16x32_bf16 v[12:15], v[140:143], v[152:155], v[12:15]
    buffer_load_dwordx4 a[208:211], v2, s[60:63], s87 offen offset:0 sc1
    v_mfma_f32_16x16x32_bf16 v[12:15], v[132:135], v[160:163], v[12:15]
    ds_read_b64_tr_b16 v[58:59], v32 offset:1344
    v_mfma_f32_16x16x32_bf16 v[12:15], v[128:131], v[164:167], v[12:15]
    ds_read_b128 v[68:71], v33 offset:640
    v_mfma_f32_16x16x32_bf16 v[16:19], v[140:143], v[156:159], v[16:19]
    ds_read_b64_tr_b16 v[60:61], v32 offset:1864
    v_mfma_f32_16x16x32_bf16 v[16:19], v[136:139], v[160:163], v[16:19]
    buffer_load_dwordx4 a[212:215], v2, s[60:63], s87 offen offset:1024 sc1
    v_mfma_f32_16x16x32_bf16 v[16:19], v[132:135], v[164:167], v[16:19]
    ds_read_b64_tr_b16 v[62:63], v32 offset:1856
    v_mfma_f32_16x16x32_bf16 v[16:19], v[128:131], v[168:171], v[16:19]
    ds_read_b128 v[64:67], v33 offset:128
    v_mfma_f32_16x16x32_bf16 v[20:23], v[140:143], v[160:163], v[20:23]
    ds_read_b128 v[80:83], v33 offset:2176
    v_mfma_f32_16x16x32_bf16 v[20:23], v[136:139], v[164:167], v[20:23]
    buffer_load_dwordx4 a[216:219], v2, s[60:63], s87 offen offset:2048 sc1
    v_mfma_f32_16x16x32_bf16 v[20:23], v[132:135], v[168:171], v[20:23]
    ds_read_b128 v[84:87], v33 offset:2688
    s_waitcnt lgkmcnt(0)
    v_mfma_f32_16x16x32_bf16 v[20:23], v[128:131], v[172:175], v[20:23]
    ds_read_b128 v[88:91], v33 offset:3200
    s_xor_b64 s[16:17], s[16:17], s[6:7]
    v_mfma_f32_16x16x32_bf16 v[8:11], v[104:107], v[112:115], v[8:11]
    ds_read_b128 v[92:95], v33 offset:3712
    s_xor_b64 s[18:19], s[18:19], s[6:7]
    v_mfma_f32_16x16x32_bf16 v[12:15], v[104:107], v[116:119], v[12:15]
    buffer_load_dwordx4 a[220:223], v2, s[60:63], s87 offen offset:3072 sc1
    s_add_u32 s87, s87, 4096
    s_or_b64 s[16:17], s[16:17], s[18:19]
    v_mfma_f32_16x16x32_bf16 v[16:19], v[104:107], v[120:123], v[16:19]
    s_xor_b64 s[20:21], s[20:21], s[6:7]
    v_mfma_f32_16x16x32_bf16 v[16:19], v[108:111], v[112:115], v[16:19]
    s_or_b64 s[16:17], s[16:17], s[20:21]
    v_mfma_f32_16x16x32_bf16 v[20:23], v[104:107], v[124:127], v[20:23]
    s_xor_b64 s[22:23], s[22:23], s[6:7]
    v_mfma_f32_16x16x32_bf16 v[20:23], v[108:111], v[116:119], v[20:23]
    buffer_load_dwordx4 a[224:227], v2, s[60:63], s87 offen offset:0 sc1
    s_or_b64 s[16:17], s[16:17], s[22:23]
    s_cbranch_scc1 L_shm_slow
L_shm_ok:
    v_mfma_f32_16x16x32_bf16 v[4:7], v[48:51], v[76:79], v[4:7]
    ds_read_b64_tr_b16 v[128:129], v32 offset:392
    ds_read_b64_tr_b16 v[130:131], v32 offset:384
    v_mfma_f32_16x16x32_bf16 v[4:7], v[52:55], v[72:75], v[4:7]
    ds_read_b128 v[156:159], v33 offset:1600
    v_mfma_f32_16x16x32_bf16 v[4:7], v[56:59], v[68:71], v[4:7]
    ds_read_b64_tr_b16 v[132:133], v32 offset:904
    v_mfma_f32_16x16x32_bf16 v[4:7], v[60:63], v[64:67], v[4:7]
    buffer_load_dwordx4 v[176:179], v2, s[60:63], s94 offen offset:0 sc1
    v_mfma_f32_16x16x32_bf16 v[8:11], v[52:55], v[76:79], v[8:11]
    ds_read_b64_tr_b16 v[134:135], v32 offset:896
    v_mfma_f32_16x16x32_bf16 v[8:11], v[56:59], v[72:75], v[8:11]
    ds_read_b128 v[152:155], v33 offset:1088
    v_mfma_f32_16x16x32_bf16 v[8:11], v[60:63], v[68:71], v[8:11]
    ds_read_b64_tr_b16 v[136:137], v32 offset:1416
    v_mfma_f32_16x16x32_bf16 v[8:11], v[48:51], v[80:83], v[8:11]
    buffer_load_dwordx4 a[228:231], v2, s[60:63], s87 offen offset:1024 sc1
    v_mfma_f32_16x16x32_bf16 v[12:15], v[56:59], v[76:79], v[12:15]
    ds_read_b64_tr_b16 v[138:139], v32 offset:1408
    v_mfma_f32_16x16x32_bf16 v[12:15], v[60:63], v[72:75], v[12:15]
    ds_read_b128 v[148:151], v33 offset:576
    v_mfma_f32_16x16x32_bf16 v[12:15], v[52:55], v[80:83], v[12:15]
    ds_read_b64_tr_b16 v[140:141], v32 offset:1928
    v_mfma_f32_16x16x32_bf16 v[12:15], v[48:51], v[84:87], v[12:15]
    buffer_load_dwordx4 v[180:183], v2, s[60:63], s94 offen offset:1024 sc1
    v_mfma_f32_16x16x32_bf16 v[16:19], v[60:63], v[76:79], v[16:19]
    ds_read_b64_tr_b16 v[142:143], v32 offset:1920
    v_mfma_f32_16x16x32_bf16 v[16:19], v[56:59], v[80:83], v[16:19]
    ds_read_b128 v[144:147], v33 offset:64
    v_mfma_f32_16x16x32_bf16 v[16:19], v[52:55], v[84:87], v[16:19]
    buffer_load_dwordx4 a[232:235], v2, s[60:63], s87 offen offset:2048 sc1
    s_waitcnt lgkmcnt(5)
    v_mfma_f32_16x16x32_bf16 v[16:19], v[48:51], v[88:91], v[16:19]
    ds_read_b128 v[160:163], v33 offset:2112
    v_mfma_f32_16x16x32_bf16 v[20:23], v[60:63], v[80:83], v[20:23]
    ds_read_b128 v[164:167], v33 offset:2624
    v_mfma_f32_16x16x32_bf16 v[20:23], v[56:59], v[84:87], v[20:23]
    ds_read_b128 v[168:171], v33 offset:3136
    v_mfma_f32_16x16x32_bf16 v[20:23], v[52:55], v[88:91], v[20:23]
    buffer_load_dwordx4 v[184:187], v2, s[60:63], s94 offen offset:2048 sc1
    v_mfma_f32_16x16x32_bf16 v[20:23], v[48:51], v[92:95], v[20:23]
    ds_read_b128 v[172:175], v33 offset:3648
    v_mfma_f32_16x16x32_bf16 v[4:7], v[128:131], v[156:159], v[4:7]
    ds_read_b64_tr_b16 v[48:49], v32 offset:456
    ds_read_b64_tr_b16 v[50:51], v32 offset:448
    v_mfma_f32_16x16x32_bf16 v[4:7], v[132:135], v[152:155], v[4:7]
    ds_read_b128 v[76:79], v33 offset:1536
    s_waitcnt lgkmcnt(5)
    v_mfma_f32_16x16x32_bf16 v[4:7], v[136:139], v[148:151], v[4:7]
    buffer_load_dwordx4 a[236:239], v2, s[60:63], s87 offen offset:3072 sc1
    s_add_u32 s87, s87, 4096
    v_mfma_f32_16x16x32_bf16 v[4:7], v[140:143], v[144:147], v[4:7]
    ds_read_b64_tr_b16 v[52:53], v32 offset:968
    v_mfma_f32_16x16x32_bf16 v[8:11], v[132:135], v[156:159], v[8:11]
    ds_read_b64_tr_b16 v[54:55], v32 offset:960
    v_mfma_f32_16x16x32_bf16 v[8:11], v[136:139], v[152:155], v[8:11]
    ds_read_b128 v[72:75], v33 offset:1024
    v_mfma_f32_16x16x32_bf16 v[8:11], v[140:143], v[148:151], v[8:11]
    buffer_load_dwordx4 v[188:191], v2, s[60:63], s94 offen offset:3072 sc1
    s_add_u32 s94, s94, 4096
    v_mfma_f32_16x16x32_bf16 v[8:11], v[128:131], v[160:163], v[8:11]
    ds_read_b64_tr_b16 v[56:57], v32 offset:1480
    v_mfma_f32_16x16x32_bf16 v[12:15], v[136:139], v[156:159], v[12:15]
    ds_read_b64_tr_b16 v[58:59], v32 offset:1472
    v_mfma_f32_16x16x32_bf16 v[12:15], v[140:143], v[152:155], v[12:15]
    ds_read_b128 v[68:71], v33 offset:512
    v_mfma_f32_16x16x32_bf16 v[12:15], v[132:135], v[160:163], v[12:15]
    buffer_load_dwordx4 v[192:195], v2, s[60:63], s94 offen offset:0 sc1
    v_mfma_f32_16x16x32_bf16 v[12:15], v[128:131], v[164:167], v[12:15]
    ds_read_b64_tr_b16 v[60:61], v32 offset:1992
    v_mfma_f32_16x16x32_bf16 v[16:19], v[140:143], v[156:159], v[16:19]
    ds_read_b64_tr_b16 v[62:63], v32 offset:1984
    v_mfma_f32_16x16x32_bf16 v[16:19], v[136:139], v[160:163], v[16:19]
    ds_read_b128 v[64:67], v33 offset:0
    v_mfma_f32_16x16x32_bf16 v[16:19], v[132:135], v[164:167], v[16:19]
    buffer_load_dwordx4 v[196:199], v2, s[60:63], s94 offen offset:1024 sc1
    s_waitcnt lgkmcnt(5)
    v_mfma_f32_16x16x32_bf16 v[16:19], v[128:131], v[168:171], v[16:19]
    ds_read_b128 v[80:83], v33 offset:2048
    v_mfma_f32_16x16x32_bf16 v[20:23], v[140:143], v[160:163], v[20:23]
    ds_read_b128 v[84:87], v33 offset:2560
    v_mfma_f32_16x16x32_bf16 v[20:23], v[136:139], v[164:167], v[20:23]
    ds_read_b128 v[88:91], v33 offset:3072
    v_mfma_f32_16x16x32_bf16 v[20:23], v[132:135], v[168:171], v[20:23]
    buffer_load_dwordx4 v[200:203], v2, s[60:63], s94 offen offset:2048 sc1
    v_mfma_f32_16x16x32_bf16 v[20:23], v[128:131], v[172:175], v[20:23]
    ds_read_b128 v[92:95], v33 offset:3584
    v_mfma_f32_16x16x32_bf16 v[4:7], v[48:51], v[76:79], v[4:7]
    v_mfma_f32_16x16x32_bf16 v[4:7], v[52:55], v[72:75], v[4:7]
    s_waitcnt lgkmcnt(5)
    v_mfma_f32_16x16x32_bf16 v[4:7], v[56:59], v[68:71], v[4:7]
    buffer_load_dwordx4 v[204:207], v2, s[60:63], s94 offen offset:3072 sc1
    s_add_u32 s94, s94, 4096
    s_waitcnt lgkmcnt(4)
    v_mfma_f32_16x16x32_bf16 v[4:7], v[60:63], v[64:67], v[4:7]
    v_mfma_f32_16x16x32_bf16 v[8:11], v[52:55], v[76:79], v[8:11]
    v_mfma_f32_16x16x32_bf16 v[8:11], v[56:59], v[72:75], v[8:11]
    v_mfma_f32_16x16x32_bf16 v[8:11], v[60:63], v[68:71], v[8:11]
    buffer_load_dwordx4 v[208:211], v2, s[60:63], s94 offen offset:0 sc1
    s_waitcnt lgkmcnt(3)
    v_mfma_f32_16x16x32_bf16 v[8:11], v[48:51], v[80:83], v[8:11]
    v_mfma_f32_16x16x32_bf16 v[12:15], v[56:59], v[76:79], v[12:15]
    v_mfma_f32_16x16x32_bf16 v[12:15], v[60:63], v[72:75], v[12:15]
    v_mfma_f32_16x16x32_bf16 v[12:15], v[52:55], v[80:83], v[12:15]
    buffer_load_dwordx4 v[212:215], v2, s[60:63], s94 offen offset:1024 sc1
    s_waitcnt lgkmcnt(2)
    v_mfma_f32_16x16x32_bf16 v[12:15], v[48:51], v[84:87], v[12:15]
    v_mfma_f32_16x16x32_bf16 v[16:19], v[60:63], v[76:79], v[16:19]
    v_mfma_f32_16x16x32_bf16 v[16:19], v[56:59], v[80:83], v[16:19]
    v_mfma_f32_16x16x32_bf16 v[16:19], v[52:55], v[84:87], v[16:19]
    buffer_load_dwordx4 v[216:219], v2, s[60:63], s94 offen offset:2048 sc1
    s_waitcnt lgkmcnt(1)
    v_mfma_f32_16x16x32_bf16 v[16:19], v[48:51], v[88:91], v[16:19]
    v_mfma_f32_16x16x32_bf16 v[20:23], v[60:63], v[80:83], v[20:23]
    v_mfma_f32_16x16x32_bf16 v[20:23], v[56:59], v[84:87], v[20:23]
    v_mfma_f32_16x16x32_bf16 v[20:23], v[52:55], v[88:91], v[20:23]
    buffer_load_dwordx4 v[220:223], v2, s[60:63], s94 offen offset:3072 sc1
    s_waitcnt lgkmcnt(0)
    v_mfma_f32_16x16x32_bf16 v[20:23], v[48:51], v[92:95], v[20:23]
    s_nop 3
    v_cvt_pk_bf16_f32 v40, v8, v9
    v_cvt_pk_bf16_f32 v42, v12, v13
    v_cvt_pk_bf16_f32 v41, v10, v11
    v_cvt_pk_bf16_f32 v43, v14, v15
    v_permlane16_swap_b32 v40, v42
    s_nop 0
    v_permlane16_swap_b32 v41, v43
    buffer_store_dwordx4 v[40:43], v34, s[60:63], s68 offen offset:2048 sc1
L_padM0:
    s_cbranch_execz L_padM1
    s_nop 0
    v_cvt_pk_bf16_f32 v28, v4, v5
    v_cvt_pk_bf16_f32 v29, v6, v7
    buffer_store_dwordx2 v[28:29], v35, s[60:63], s68 offen offset:1536 sc1
    v_cvt_pk_bf16_f32 v44, v16, v17
    v_cvt_pk_bf16_f32 v46, v20, v21
    v_cvt_pk_bf16_f32 v45, v18, v19
    v_cvt_pk_bf16_f32 v47, v22, v23
    v_permlane16_swap_b32 v44, v46
    s_nop 0
    v_permlane16_swap_b32 v45, v47
    buffer_store_dwordx4 v[44:47], v34, s[60:63], s68 offen offset:3072 sc1
    s_branch L_convdone
L_conv3:
L_padM1:
    s_cbranch_execz L_padM2
    s_nop 0
    ds_read_b64_tr_b16 v[64:65], v32 offset:31560
    ds_read_b64_tr_b16 v[66:67], v32 offset:31552
    ds_read_b128 v[76:79], v33 offset:9664
    ds_read_b128 v[80:83], v33 offset:10176
    ds_read_b64_tr_b16 v[68:69], v32 offset:32072
    ds_read_b64_tr_b16 v[70:71], v32 offset:32064
    ds_read_b128 v[84:87], v33 offset:10688
    ds_read_b64_tr_b16 v[72:73], v32 offset:32584
    ds_read_b64_tr_b16 v[74:75], v32 offset:32576
    s_waitcnt lgkmcnt(5)
    v_mfma_f32_16x16x32_bf16 v[4:7], v[112:115], v[124:127], 0
    ds_read_b64_tr_b16 v[88:89], v32 offset:72
    ds_read_b64_tr_b16 v[90:91], v32 offset:64
    ds_read_b128 v[100:103], v33 offset:384
    v_mfma_f32_16x16x32_bf16 v[8:11], v[112:115], v[128:131], 0
    buffer_load_dwordx4 a[104:107], v2, s[60:63], s87 offen offset:2048 sc1
    v_mfma_f32_16x16x32_bf16 v[8:11], v[116:119], v[124:127], v[8:11]
    ds_read_b128 v[104:107], v33 offset:896
    ds_read_b64_tr_b16 v[92:93], v32 offset:584
    v_mfma_f32_16x16x32_bf16 v[12:15], v[116:119], v[128:131], 0
    ds_read_b64_tr_b16 v[94:95], v32 offset:576
    ds_read_b128 v[108:111], v33 offset:1408
    v_mfma_f32_16x16x32_bf16 v[12:15], v[112:115], v[132:135], v[12:15]
    buffer_load_dwordx4 a[108:111], v2, s[60:63], s87 offen offset:3072 sc1
    s_add_u32 s87, s87, 4096
    v_mfma_f32_16x16x32_bf16 v[12:15], v[120:123], v[124:127], v[12:15]
    ds_read_b64_tr_b16 v[96:97], v32 offset:1096
    ds_read_b64_tr_b16 v[98:99], v32 offset:1088
    v_mfma_f32_16x16x32_bf16 v[16:19], v[136:139], v[148:151], 0
    ds_read_b64_tr_b16 v[112:113], v32 offset:15848
    ds_read_b64_tr_b16 v[114:115], v32 offset:15840
    ds_read_b128 v[124:127], v33 offset:4992
    v_mfma_f32_16x16x32_bf16 v[20:23], v[136:139], v[152:155], 0
    buffer_load_dwordx4 a[112:115], v2, s[60:63], s87 offen offset:0 sc1
    v_mfma_f32_16x16x32_bf16 v[20:23], v[140:143], v[148:151], v[20:23]
    ds_read_b128 v[128:131], v33 offset:5504
    ds_read_b64_tr_b16 v[116:117], v32 offset:16360
    v_mfma_f32_16x16x32_bf16 v[48:51], v[140:143], v[152:155], 0
    ds_read_b64_tr_b16 v[118:119], v32 offset:16352
    ds_read_b128 v[132:135], v33 offset:6016
    v_mfma_f32_16x16x32_bf16 v[48:51], v[136:139], v[156:159], v[48:51]
    buffer_load_dwordx4 a[116:119], v2, s[60:63], s87 offen offset:1024 sc1
    v_mfma_f32_16x16x32_bf16 v[48:51], v[144:147], v[148:151], v[48:51]
    ds_read_b64_tr_b16 v[120:121], v32 offset:16872
    ds_read_b64_tr_b16 v[122:123], v32 offset:16864
    v_mfma_f32_16x16x32_bf16 v[52:55], v[64:67], v[76:79], 0
    ds_read_b64_tr_b16 v[136:137], v32 offset:31624
    ds_read_b64_tr_b16 v[138:139], v32 offset:31616
    ds_read_b128 v[148:151], v33 offset:9600
    v_mfma_f32_16x16x32_bf16 v[56:59], v[64:67], v[80:83], 0
    buffer_load_dwordx4 a[120:123], v2, s[60:63], s87 offen offset:2048 sc1
    s_waitcnt lgkmcnt(5)
    v_mfma_f32_16x16x32_bf16 v[56:59], v[68:71], v[76:79], v[56:59]
    ds_read_b128 v[152:155], v33 offset:10112
    ds_read_b64_tr_b16 v[140:141], v32 offset:32136
    v_mfma_f32_16x16x32_bf16 v[60:63], v[68:71], v[80:83], 0
    ds_read_b64_tr_b16 v[142:143], v32 offset:32128
    ds_read_b128 v[156:159], v33 offset:10624
    v_mfma_f32_16x16x32_bf16 v[60:63], v[64:67], v[84:87], v[60:63]
    buffer_load_dwordx4 a[124:127], v2, s[60:63], s87 offen offset:3072 sc1
    s_add_u32 s87, s87, 4096
    v_mfma_f32_16x16x32_bf16 v[60:63], v[72:75], v[76:79], v[60:63]
    ds_read_b64_tr_b16 v[144:145], v32 offset:32648
    ds_read_b64_tr_b16 v[146:147], v32 offset:32640
    v_mfma_f32_16x16x32_bf16 v[4:7], v[88:91], v[100:103], v[4:7]
    ds_read_b64_tr_b16 v[64:65], v32 offset:136
    ds_read_b64_tr_b16 v[66:67], v32 offset:128
    ds_read_b128 v[76:79], v33 offset:320
    v_mfma_f32_16x16x32_bf16 v[8:11], v[88:91], v[104:107], v[8:11]
    buffer_load_dwordx4 a[128:131], v2, s[60:63], s87 offen offset:0 sc1
    v_mfma_f32_16x16x32_bf16 v[8:11], v[92:95], v[100:103], v[8:11]
    ds_read_b128 v[80:83], v33 offset:832
    ds_read_b64_tr_b16 v[68:69], v32 offset:648
    v_mfma_f32_16x16x32_bf16 v[12:15], v[92:95], v[104:107], v[12:15]
    ds_read_b64_tr_b16 v[70:71], v32 offset:640
    ds_read_b128 v[84:87], v33 offset:1344
    v_mfma_f32_16x16x32_bf16 v[12:15], v[88:91], v[108:111], v[12:15]
    buffer_load_dwordx4 a[132:135], v2, s[60:63], s87 offen offset:1024 sc1
    v_mfma_f32_16x16x32_bf16 v[12:15], v[96:99], v[100:103], v[12:15]
    ds_read_b64_tr_b16 v[72:73], v32 offset:1160
    ds_read_b64_tr_b16 v[74:75], v32 offset:1152
    v_mfma_f32_16x16x32_bf16 v[16:19], v[112:115], v[124:127], v[16:19]
    ds_read_b64_tr_b16 v[88:89], v32 offset:15912
    ds_read_b64_tr_b16 v[90:91], v32 offset:15904
    ds_read_b128 v[100:103], v33 offset:4928
    v_mfma_f32_16x16x32_bf16 v[20:23], v[112:115], v[128:131], v[20:23]
    ds_read_b128 v[104:107], v33 offset:5440
    ds_read_b64_tr_b16 v[92:93], v32 offset:16424
    v_mfma_f32_16x16x32_bf16 v[20:23], v[116:119], v[124:127], v[20:23]
    buffer_load_dwordx4 a[136:139], v2, s[60:63], s87 offen offset:2048 sc1
    v_mfma_f32_16x16x32_bf16 v[48:51], v[116:119], v[128:131], v[48:51]
    ds_read_b64_tr_b16 v[94:95], v32 offset:16416
    ds_read_b128 v[108:111], v33 offset:5952
    v_mfma_f32_16x16x32_bf16 v[48:51], v[112:115], v[132:135], v[48:51]
    ds_read_b64_tr_b16 v[96:97], v32 offset:16936
    ds_read_b64_tr_b16 v[98:99], v32 offset:16928
    s_waitcnt lgkmcnt(5)
    v_mfma_f32_16x16x32_bf16 v[48:51], v[120:123], v[124:127], v[48:51]
    buffer_load_dwordx4 a[140:143], v2, s[60:63], s87 offen offset:3072 sc1
    s_add_u32 s87, s87, 4096
    v_mfma_f32_16x16x32_bf16 v[52:55], v[136:139], v[148:151], v[52:55]
    ds_read_b64_tr_b16 v[112:113], v32 offset:31688
    ds_read_b64_tr_b16 v[114:115], v32 offset:31680
    ds_read_b128 v[124:127], v33 offset:9536
    v_mfma_f32_16x16x32_bf16 v[56:59], v[136:139], v[152:155], v[56:59]
    ds_read_b128 v[128:131], v33 offset:10048
    ds_read_b64_tr_b16 v[116:117], v32 offset:32200
    v_mfma_f32_16x16x32_bf16 v[56:59], v[140:143], v[148:151], v[56:59]
    s_waitcnt vmcnt(10)
    s_mov_b64 exec, 3
    buffer_store_dword v30, v224, s[60:63], s81 offen sc1
    s_mov_b64 exec, -1
    v_mfma_f32_16x16x32_bf16 v[60:63], v[140:143], v[152:155], v[60:63]
    ds_read_b64_tr_b16 v[118:119], v32 offset:32192
    ds_read_b128 v[132:135], v33 offset:10560
    v_mfma_f32_16x16x32_bf16 v[60:63], v[136:139], v[156:159], v[60:63]
    ds_read_b64_tr_b16 v[120:121], v32 offset:32712
    ds_read_b64_tr_b16 v[122:123], v32 offset:32704
    v_mfma_f32_16x16x32_bf16 v[60:63], v[144:147], v[148:151], v[60:63]
    buffer_load_dwordx4 a[144:147], v2, s[60:63], s87 offen offset:0 sc1
    v_mfma_f32_16x16x32_bf16 v[4:7], v[64:67], v[76:79], v[4:7]
    ds_read_b64_tr_b16 v[136:137], v32 offset:200
    ds_read_b64_tr_b16 v[138:139], v32 offset:192
    ds_read_b128 v[148:151], v33 offset:256
    v_mfma_f32_16x16x32_bf16 v[8:11], v[64:67], v[80:83], v[8:11]
    ds_read_b128 v[152:155], v33 offset:768
    ds_read_b64_tr_b16 v[140:141], v32 offset:712
    v_mfma_f32_16x16x32_bf16 v[8:11], v[68:71], v[76:79], v[8:11]
    buffer_load_dwordx4 a[148:151], v2, s[60:63], s87 offen offset:1024 sc1
    v_mfma_f32_16x16x32_bf16 v[12:15], v[68:71], v[80:83], v[12:15]
    ds_read_b64_tr_b16 v[142:143], v32 offset:704
    ds_read_b128 v[156:159], v33 offset:1280
    v_mfma_f32_16x16x32_bf16 v[12:15], v[64:67], v[84:87], v[12:15]
    ds_read_b64_tr_b16 v[144:145], v32 offset:1224
    ds_read_b64_tr_b16 v[146:147], v32 offset:1216
    v_mfma_f32_16x16x32_bf16 v[12:15], v[72:75], v[76:79], v[12:15]
    buffer_load_dwordx4 a[152:155], v2, s[60:63], s87 offen offset:2048 sc1
    v_mfma_f32_16x16x32_bf16 v[16:19], v[88:91], v[100:103], v[16:19]
    ds_read_b64_tr_b16 v[64:65], v32 offset:15976
    ds_read_b64_tr_b16 v[66:67], v32 offset:15968
    ds_read_b128 v[76:79], v33 offset:4864
    v_mfma_f32_16x16x32_bf16 v[20:23], v[88:91], v[104:107], v[20:23]
    ds_read_b128 v[80:83], v33 offset:5376
    ds_read_b64_tr_b16 v[68:69], v32 offset:16488
    s_waitcnt lgkmcnt(5)
    v_mfma_f32_16x16x32_bf16 v[20:23], v[92:95], v[100:103], v[20:23]
    buffer_load_dwordx4 a[156:159], v2, s[60:63], s87 offen offset:3072 sc1
    s_add_u32 s87, s87, 4096
    v_mfma_f32_16x16x32_bf16 v[48:51], v[92:95], v[104:107], v[48:51]
    ds_read_b64_tr_b16 v[70:71], v32 offset:16480
    ds_read_b128 v[84:87], v33 offset:5888
    v_mfma_f32_16x16x32_bf16 v[48:51], v[88:91], v[108:111], v[48:51]
    ds_read_b64_tr_b16 v[72:73], v32 offset:17000
    ds_read_b64_tr_b16 v[74:75], v32 offset:16992
    v_mfma_f32_16x16x32_bf16 v[48:51], v[96:99], v[100:103], v[48:51]
    buffer_load_dwordx4 a[160:163], v2, s[60:63], s87 offen offset:0 sc1
    v_mfma_f32_16x16x32_bf16 v[52:55], v[112:115], v[124:127], v[52:55]
    ds_read_b64_tr_b16 v[88:89], v32 offset:31752
    ds_read_b64_tr_b16 v[90:91], v32 offset:31744
    ds_read_b128 v[100:103], v33 offset:9472
    v_mfma_f32_16x16x32_bf16 v[56:59], v[112:115], v[128:131], v[56:59]
    ds_read_b128 v[104:107], v33 offset:9984
    ds_read_b64_tr_b16 v[92:93], v32 offset:32264
    v_mfma_f32_16x16x32_bf16 v[56:59], v[116:119], v[124:127], v[56:59]
    buffer_load_dwordx4 a[164:167], v2, s[60:63], s87 offen offset:1024 sc1
    v_mfma_f32_16x16x32_bf16 v[60:63], v[116:119], v[128:131], v[60:63]
    ds_read_b64_tr_b16 v[94:95], v32 offset:32256
    ds_read_b128 v[108:111], v33 offset:10496
    v_mfma_f32_16x16x32_bf16 v[60:63], v[112:115], v[132:135], v[60:63]
    ds_read_b64_tr_b16 v[96:97], v32 offset:32776
    ds_read_b64_tr_b16 v[98:99], v32 offset:32768
    v_mfma_f32_16x16x32_bf16 v[60:63], v[120:123], v[124:127], v[60:63]
    buffer_load_dwordx4 a[168:171], v2, s[60:63], s87 offen offset:2048 sc1
    v_mfma_f32_16x16x32_bf16 v[4:7], v[136:139], v[148:151], v[4:7]
    ds_read_b64_tr_b16 v[112:113], v32 offset:264
    ds_read_b64_tr_b16 v[114:115], v32 offset:256
    ds_read_b128 v[124:127], v33 offset:192
    v_mfma_f32_16x16x32_bf16 v[8:11], v[136:139], v[152:155], v[8:11]
    ds_read_b128 v[128:131], v33 offset:704
    ds_read_b64_tr_b16 v[116:117], v32 offset:776
    v_mfma_f32_16x16x32_bf16 v[8:11], v[140:143], v[148:151], v[8:11]
    buffer_load_dwordx4 a[172:175], v2, s[60:63], s87 offen offset:3072 sc1
    s_add_u32 s87, s87, 4096
    v_mfma_f32_16x16x32_bf16 v[12:15], v[140:143], v[152:155], v[12:15]
    ds_read_b64_tr_b16 v[118:119], v32 offset:768
    ds_read_b128 v[132:135], v33 offset:1216
    v_mfma_f32_16x16x32_bf16 v[12:15], v[136:139], v[156:159], v[12:15]
    ds_read_b64_tr_b16 v[120:121], v32 offset:1288
    ds_read_b64_tr_b16 v[122:123], v32 offset:1280
    v_mfma_f32_16x16x32_bf16 v[12:15], v[144:147], v[148:151], v[12:15]
    buffer_load_dwordx4 a[176:179], v2, s[60:63], s87 offen offset:0 sc1
    s_waitcnt lgkmcnt(5)
    v_mfma_f32_16x16x32_bf16 v[16:19], v[64:67], v[76:79], v[16:19]
    ds_read_b64_tr_b16 v[136:137], v32 offset:16040
    ds_read_b64_tr_b16 v[138:139], v32 offset:16032
    ds_read_b128 v[148:151], v33 offset:4800
    v_mfma_f32_16x16x32_bf16 v[20:23], v[64:67], v[80:83], v[20:23]
    ds_read_b128 v[152:155], v33 offset:5312
    ds_read_b64_tr_b16 v[140:141], v32 offset:16552
    v_mfma_f32_16x16x32_bf16 v[20:23], v[68:71], v[76:79], v[20:23]
    buffer_load_dwordx4 a[180:183], v2, s[60:63], s87 offen offset:1024 sc1
    v_mfma_f32_16x16x32_bf16 v[48:51], v[68:71], v[80:83], v[48:51]
    ds_read_b64_tr_b16 v[142:143], v32 offset:16544
    ds_read_b128 v[156:159], v33 offset:5824
    v_mfma_f32_16x16x32_bf16 v[48:51], v[64:67], v[84:87], v[48:51]
    ds_read_b64_tr_b16 v[144:145], v32 offset:17064
    ds_read_b64_tr_b16 v[146:147], v32 offset:17056
    v_mfma_f32_16x16x32_bf16 v[48:51], v[72:75], v[76:79], v[48:51]
    buffer_load_dwordx4 a[184:187], v2, s[60:63], s87 offen offset:2048 sc1
    v_mfma_f32_16x16x32_bf16 v[52:55], v[88:91], v[100:103], v[52:55]
    ds_read_b64_tr_b16 v[64:65], v32 offset:31816
    ds_read_b64_tr_b16 v[66:67], v32 offset:31808
    v_mfma_f32_16x16x32_bf16 v[56:59], v[88:91], v[104:107], v[56:59]
    ds_read_b128 v[76:79], v33 offset:9408
    ds_read_b128 v[80:83], v33 offset:9920
    v_mfma_f32_16x16x32_bf16 v[56:59], v[92:95], v[100:103], v[56:59]
    buffer_load_dwordx4 a[188:191], v2, s[60:63], s87 offen offset:3072 sc1
    s_add_u32 s87, s87, 4096
    v_mfma_f32_16x16x32_bf16 v[60:63], v[92:95], v[104:107], v[60:63]
    ds_read_b64_tr_b16 v[68:69], v32 offset:32328
    ds_read_b64_tr_b16 v[70:71], v32 offset:32320
    v_mfma_f32_16x16x32_bf16 v[60:63], v[88:91], v[108:111], v[60:63]
    ds_read_b128 v[84:87], v33 offset:10432
    ds_read_b64_tr_b16 v[72:73], v32 offset:32840
    v_mfma_f32_16x16x32_bf16 v[60:63], v[96:99], v[100:103], v[60:63]
    ds_read_b64_tr_b16 v[74:75], v32 offset:32832
    v_mfma_f32_16x16x32_bf16 v[4:7], v[112:115], v[124:127], v[4:7]
    buffer_load_dwordx4 a[192:195], v2, s[60:63], s87 offen offset:0 sc1
    v_mfma_f32_16x16x32_bf16 v[8:11], v[112:115], v[128:131], v[8:11]
    ds_read_b64_tr_b16 v[88:89], v32 offset:328
    ds_read_b64_tr_b16 v[90:91], v32 offset:320
    ds_read_b128 v[100:103], v33 offset:128
    s_waitcnt lgkmcnt(5)
    v_mfma_f32_16x16x32_bf16 v[8:11], v[116:119], v[124:127], v[8:11]
    ds_read_b128 v[104:107], v33 offset:640
    ds_read_b64_tr_b16 v[92:93], v32 offset:840
    v_mfma_f32_16x16x32_bf16 v[12:15], v[116:119], v[128:131], v[12:15]
    buffer_load_dwordx4 a[196:199], v2, s[60:63], s87 offen offset:1024 sc1
    v_mfma_f32_16x16x32_bf16 v[12:15], v[112:115], v[132:135], v[12:15]
    ds_read_b64_tr_b16 v[94:95], v32 offset:832
    ds_read_b128 v[108:111], v33 offset:1152
    s_load_dwordx8 s[16:23], s[46:47], s92 offset:131072 glc
    v_mfma_f32_16x16x32_bf16 v[12:15], v[120:123], v[124:127], v[12:15]
    ds_read_b64_tr_b16 v[96:97], v32 offset:1352
    ds_read_b64_tr_b16 v[98:99], v32 offset:1344
    v_mfma_f32_16x16x32_bf16 v[16:19], v[136:139], v[148:151], v[16:19]
    buffer_load_dwordx4 a[200:203], v2, s[60:63], s87 offen offset:2048 sc1
    v_mfma_f32_16x16x32_bf16 v[20:23], v[136:139], v[152:155], v[20:23]
    ds_read_b64_tr_b16 v[112:113], v32 offset:16104
    ds_read_b64_tr_b16 v[114:115], v32 offset:16096
    ds_read_b128 v[124:127], v33 offset:4736
    v_mfma_f32_16x16x32_bf16 v[20:23], v[140:143], v[148:151], v[20:23]
    ds_read_b128 v[128:131], v33 offset:5248
    ds_read_b64_tr_b16 v[116:117], v32 offset:16616
    v_mfma_f32_16x16x32_bf16 v[48:51], v[140:143], v[152:155], v[48:51]
    buffer_load_dwordx4 a[204:207], v2, s[60:63], s87 offen offset:3072 sc1
    s_add_u32 s87, s87, 4096
    v_mfma_f32_16x16x32_bf16 v[48:51], v[136:139], v[156:159], v[48:51]
    ds_read_b64_tr_b16 v[118:119], v32 offset:16608
    ds_read_b128 v[132:135], v33 offset:5760
    v_mfma_f32_16x16x32_bf16 v[48:51], v[144:147], v[148:151], v[48:51]
    ds_read_b64_tr_b16 v[120:121], v32 offset:17128
    ds_read_b64_tr_b16 v[122:123], v32 offset:17120
    v_mfma_f32_16x16x32_bf16 v[52:55], v[64:67], v[76:79], v[52:55]
    buffer_load_dwordx4 a[208:211], v2, s[60:63], s87 offen offset:0 sc1
    v_mfma_f32_16x16x32_bf16 v[56:59], v[64:67], v[80:83], v[56:59]
    ds_read_b64_tr_b16 v[136:137], v32 offset:31880
    ds_read_b64_tr_b16 v[138:139], v32 offset:31872
    ds_read_b128 v[148:151], v33 offset:9344
    v_mfma_f32_16x16x32_bf16 v[56:59], v[68:71], v[76:79], v[56:59]
    ds_read_b128 v[152:155], v33 offset:9856
    ds_read_b64_tr_b16 v[140:141], v32 offset:32392
    v_mfma_f32_16x16x32_bf16 v[60:63], v[68:71], v[80:83], v[60:63]
    buffer_load_dwordx4 a[212:215], v2, s[60:63], s87 offen offset:1024 sc1
    v_mfma_f32_16x16x32_bf16 v[60:63], v[64:67], v[84:87], v[60:63]
    ds_read_b64_tr_b16 v[142:143], v32 offset:32384
    ds_read_b128 v[156:159], v33 offset:10368
    s_waitcnt lgkmcnt(5)
    v_mfma_f32_16x16x32_bf16 v[60:63], v[72:75], v[76:79], v[60:63]
    ds_read_b64_tr_b16 v[144:145], v32 offset:32904
    ds_read_b64_tr_b16 v[146:147], v32 offset:32896
    s_waitcnt lgkmcnt(0)
    v_mfma_f32_16x16x32_bf16 v[4:7], v[88:91], v[100:103], v[4:7]
    buffer_load_dwordx4 a[216:219], v2, s[60:63], s87 offen offset:2048 sc1
    s_xor_b64 s[16:17], s[16:17], s[6:7]
    v_mfma_f32_16x16x32_bf16 v[8:11], v[88:91], v[104:107], v[8:11]
    ds_read_b64_tr_b16 v[64:65], v32 offset:392
    ds_read_b64_tr_b16 v[66:67], v32 offset:384
    ds_read_b128 v[76:79], v33 offset:64
    s_xor_b64 s[18:19], s[18:19], s[6:7]
    v_mfma_f32_16x16x32_bf16 v[8:11], v[92:95], v[100:103], v[8:11]
    ds_read_b128 v[80:83], v33 offset:576
    ds_read_b64_tr_b16 v[68:69], v32 offset:904
    s_or_b64 s[16:17], s[16:17], s[18:19]
    v_mfma_f32_16x16x32_bf16 v[12:15], v[92:95], v[104:107], v[12:15]
    buffer_load_dwordx4 a[220:223], v2, s[60:63], s87 offen offset:3072 sc1
    s_add_u32 s87, s87, 4096
    s_xor_b64 s[20:21], s[20:21], s[6:7]
    v_mfma_f32_16x16x32_bf16 v[12:15], v[88:91], v[108:111], v[12:15]
    ds_read_b64_tr_b16 v[70:71], v32 offset:896
    ds_read_b128 v[84:87], v33 offset:1088
    s_or_b64 s[16:17], s[16:17], s[20:21]
    v_mfma_f32_16x16x32_bf16 v[12:15], v[96:99], v[100:103], v[12:15]
    ds_read_b64_tr_b16 v[72:73], v32 offset:1416
    ds_read_b64_tr_b16 v[74:75], v32 offset:1408
    s_xor_b64 s[22:23], s[22:23], s[6:7]
    v_mfma_f32_16x16x32_bf16 v[16:19], v[112:115], v[124:127], v[16:19]
    buffer_load_dwordx4 a[224:227], v2, s[60:63], s87 offen offset:0 sc1
    s_or_b64 s[16:17], s[16:17], s[22:23]
    s_cbranch_scc1 L_shw_slow
L_shw_ok:
    v_mfma_f32_16x16x32_bf16 v[20:23], v[112:115], v[128:131], v[20:23]
    ds_read_b64_tr_b16 v[88:89], v32 offset:16168
    ds_read_b64_tr_b16 v[90:91], v32 offset:16160
    ds_read_b128 v[100:103], v33 offset:4672
    v_mfma_f32_16x16x32_bf16 v[20:23], v[116:119], v[124:127], v[20:23]
    ds_read_b128 v[104:107], v33 offset:5184
    ds_read_b64_tr_b16 v[92:93], v32 offset:16680
    v_mfma_f32_16x16x32_bf16 v[48:51], v[116:119], v[128:131], v[48:51]
    buffer_load_dwordx4 v[176:179], v2, s[60:63], s94 offen offset:0 sc1
    v_mfma_f32_16x16x32_bf16 v[48:51], v[112:115], v[132:135], v[48:51]
    ds_read_b64_tr_b16 v[94:95], v32 offset:16672
    ds_read_b128 v[108:111], v33 offset:5696
    v_mfma_f32_16x16x32_bf16 v[48:51], v[120:123], v[124:127], v[48:51]
    ds_read_b64_tr_b16 v[96:97], v32 offset:17192
    ds_read_b64_tr_b16 v[98:99], v32 offset:17184
    v_mfma_f32_16x16x32_bf16 v[52:55], v[136:139], v[148:151], v[52:55]
    buffer_load_dwordx4 a[228:231], v2, s[60:63], s87 offen offset:1024 sc1
    v_mfma_f32_16x16x32_bf16 v[56:59], v[136:139], v[152:155], v[56:59]
    ds_read_b64_tr_b16 v[112:113], v32 offset:31944
    ds_read_b64_tr_b16 v[114:115], v32 offset:31936
    ds_read_b128 v[124:127], v33 offset:9280
    v_mfma_f32_16x16x32_bf16 v[56:59], v[140:143], v[148:151], v[56:59]
    ds_read_b128 v[128:131], v33 offset:9792
    ds_read_b64_tr_b16 v[116:117], v32 offset:32456
    v_mfma_f32_16x16x32_bf16 v[60:63], v[140:143], v[152:155], v[60:63]
    buffer_load_dwordx4 v[180:183], v2, s[60:63], s94 offen offset:1024 sc1
    v_mfma_f32_16x16x32_bf16 v[60:63], v[136:139], v[156:159], v[60:63]
    ds_read_b64_tr_b16 v[118:119], v32 offset:32448
    ds_read_b128 v[132:135], v33 offset:10304
    v_mfma_f32_16x16x32_bf16 v[60:63], v[144:147], v[148:151], v[60:63]
    ds_read_b64_tr_b16 v[120:121], v32 offset:32968
    ds_read_b64_tr_b16 v[122:123], v32 offset:32960
    s_waitcnt lgkmcnt(5)
    v_mfma_f32_16x16x32_bf16 v[4:7], v[64:67], v[76:79], v[4:7]
    buffer_load_dwordx4 a[232:235], v2, s[60:63], s87 offen offset:2048 sc1
    v_mfma_f32_16x16x32_bf16 v[8:11], v[64:67], v[80:83], v[8:11]
    ds_read_b64_tr_b16 v[136:137], v32 offset:456
    ds_read_b64_tr_b16 v[138:139], v32 offset:448
    ds_read_b128 v[148:151], v33 offset:0
    v_mfma_f32_16x16x32_bf16 v[8:11], v[68:71], v[76:79], v[8:11]
    ds_read_b128 v[152:155], v33 offset:512
    ds_read_b64_tr_b16 v[140:141], v32 offset:968
    v_mfma_f32_16x16x32_bf16 v[12:15], v[68:71], v[80:83], v[12:15]
    buffer_load_dwordx4 v[184:187], v2, s[60:63], s94 offen offset:2048 sc1
    v_mfma_f32_16x16x32_bf16 v[12:15], v[64:67], v[84:87], v[12:15]
    ds_read_b64_tr_b16 v[142:143], v32 offset:960
    ds_read_b128 v[156:159], v33 offset:1024
    v_mfma_f32_16x16x32_bf16 v[12:15], v[72:75], v[76:79], v[12:15]
    ds_read_b64_tr_b16 v[144:145], v32 offset:1480
    ds_read_b64_tr_b16 v[146:147], v32 offset:1472
    v_mfma_f32_16x16x32_bf16 v[16:19], v[88:91], v[100:103], v[16:19]
    buffer_load_dwordx4 a[236:239], v2, s[60:63], s87 offen offset:3072 sc1
    s_add_u32 s87, s87, 4096
    v_mfma_f32_16x16x32_bf16 v[20:23], v[88:91], v[104:107], v[20:23]
    ds_read_b64_tr_b16 v[64:65], v32 offset:16232
    ds_read_b64_tr_b16 v[66:67], v32 offset:16224
    ds_read_b128 v[76:79], v33 offset:4608
    v_mfma_f32_16x16x32_bf16 v[20:23], v[92:95], v[100:103], v[20:23]
    ds_read_b128 v[80:83], v33 offset:5120
    ds_read_b64_tr_b16 v[68:69], v32 offset:16744
    v_mfma_f32_16x16x32_bf16 v[48:51], v[92:95], v[104:107], v[48:51]
    buffer_load_dwordx4 v[188:191], v2, s[60:63], s94 offen offset:3072 sc1
    s_add_u32 s94, s94, 4096
    v_mfma_f32_16x16x32_bf16 v[48:51], v[88:91], v[108:111], v[48:51]
    ds_read_b64_tr_b16 v[70:71], v32 offset:16736
    ds_read_b128 v[84:87], v33 offset:5632
    v_mfma_f32_16x16x32_bf16 v[48:51], v[96:99], v[100:103], v[48:51]
    ds_read_b64_tr_b16 v[72:73], v32 offset:17256
    ds_read_b64_tr_b16 v[74:75], v32 offset:17248
    v_mfma_f32_16x16x32_bf16 v[52:55], v[112:115], v[124:127], v[52:55]
    ds_read_b64_tr_b16 v[88:89], v32 offset:32008
    ds_read_b64_tr_b16 v[90:91], v32 offset:32000
    ds_read_b128 v[100:103], v33 offset:9216
    v_mfma_f32_16x16x32_bf16 v[56:59], v[112:115], v[128:131], v[56:59]
    buffer_load_dwordx4 v[192:195], v2, s[60:63], s94 offen offset:0 sc1
    s_waitcnt lgkmcnt(5)
    v_mfma_f32_16x16x32_bf16 v[56:59], v[116:119], v[124:127], v[56:59]
    ds_read_b128 v[104:107], v33 offset:9728
    ds_read_b64_tr_b16 v[92:93], v32 offset:32520
    v_mfma_f32_16x16x32_bf16 v[60:63], v[116:119], v[128:131], v[60:63]
    ds_read_b64_tr_b16 v[94:95], v32 offset:32512
    ds_read_b128 v[108:111], v33 offset:10240
    v_mfma_f32_16x16x32_bf16 v[60:63], v[112:115], v[132:135], v[60:63]
    buffer_load_dwordx4 v[196:199], v2, s[60:63], s94 offen offset:1024 sc1
    v_mfma_f32_16x16x32_bf16 v[60:63], v[120:123], v[124:127], v[60:63]
    ds_read_b64_tr_b16 v[96:97], v32 offset:33032
    ds_read_b64_tr_b16 v[98:99], v32 offset:33024
    v_mfma_f32_16x16x32_bf16 v[4:7], v[136:139], v[148:151], v[4:7]
    v_mfma_f32_16x16x32_bf16 v[8:11], v[136:139], v[152:155], v[8:11]
    buffer_load_dwordx4 v[200:203], v2, s[60:63], s94 offen offset:2048 sc1
    v_mfma_f32_16x16x32_bf16 v[8:11], v[140:143], v[148:151], v[8:11]
    v_mfma_f32_16x16x32_bf16 v[12:15], v[140:143], v[152:155], v[12:15]
    v_mfma_f32_16x16x32_bf16 v[12:15], v[136:139], v[156:159], v[12:15]
    buffer_load_dwordx4 v[204:207], v2, s[60:63], s94 offen offset:3072 sc1
    s_add_u32 s94, s94, 4096
    v_mfma_f32_16x16x32_bf16 v[12:15], v[144:147], v[148:151], v[12:15]
    v_mfma_f32_16x16x32_bf16 v[16:19], v[64:67], v[76:79], v[16:19]
    v_mfma_f32_16x16x32_bf16 v[20:23], v[64:67], v[80:83], v[20:23]
    buffer_load_dwordx4 v[208:211], v2, s[60:63], s94 offen offset:0 sc1
    v_mfma_f32_16x16x32_bf16 v[20:23], v[68:71], v[76:79], v[20:23]
    v_mfma_f32_16x16x32_bf16 v[48:51], v[68:71], v[80:83], v[48:51]
    v_mfma_f32_16x16x32_bf16 v[48:51], v[64:67], v[84:87], v[48:51]
    buffer_load_dwordx4 v[212:215], v2, s[60:63], s94 offen offset:1024 sc1
    s_waitcnt lgkmcnt(5)
    v_mfma_f32_16x16x32_bf16 v[48:51], v[72:75], v[76:79], v[48:51]
    v_mfma_f32_16x16x32_bf16 v[52:55], v[88:91], v[100:103], v[52:55]
    v_mfma_f32_16x16x32_bf16 v[56:59], v[88:91], v[104:107], v[56:59]
    buffer_load_dwordx4 v[216:219], v2, s[60:63], s94 offen offset:2048 sc1
    s_waitcnt lgkmcnt(3)
    v_mfma_f32_16x16x32_bf16 v[56:59], v[92:95], v[100:103], v[56:59]
    v_mfma_f32_16x16x32_bf16 v[60:63], v[92:95], v[104:107], v[60:63]
    s_waitcnt lgkmcnt(2)
    v_mfma_f32_16x16x32_bf16 v[60:63], v[88:91], v[108:111], v[60:63]
    buffer_load_dwordx4 v[220:223], v2, s[60:63], s94 offen offset:3072 sc1
    s_waitcnt lgkmcnt(0)
    v_mfma_f32_16x16x32_bf16 v[60:63], v[96:99], v[100:103], v[60:63]
    v_cvt_pk_bf16_f32 v160, v4, v5
    v_cvt_pk_bf16_f32 v162, v8, v9
    v_cvt_pk_bf16_f32 v161, v6, v7
    v_cvt_pk_bf16_f32 v163, v10, v11
    v_permlane16_swap_b32 v160, v162
    s_nop 0
    v_permlane16_swap_b32 v161, v163
    buffer_store_dwordx4 v[160:163], v34, s[60:63], s68 offen offset:0 sc1
    v_cvt_pk_bf16_f32 v40, v12, v13
    v_cvt_pk_bf16_f32 v41, v14, v15
    buffer_store_dwordx2 v[40:41], v35, s[60:63], s68 offen offset:1024 sc1
    v_cvt_pk_bf16_f32 v164, v16, v17
    v_cvt_pk_bf16_f32 v166, v20, v21
    v_cvt_pk_bf16_f32 v165, v18, v19
    v_cvt_pk_bf16_f32 v167, v22, v23
    v_permlane16_swap_b32 v164, v166
    s_nop 0
    v_permlane16_swap_b32 v165, v167
    buffer_store_dwordx4 v[164:167], v34, s[60:63], s69 offen offset:0 sc1
    v_cvt_pk_bf16_f32 v42, v48, v49
    v_cvt_pk_bf16_f32 v43, v50, v51
    buffer_store_dwordx2 v[42:43], v35, s[60:63], s69 offen offset:1024 sc1
    v_cvt_pk_bf16_f32 v168, v52, v53
    v_cvt_pk_bf16_f32 v170, v56, v57
    v_cvt_pk_bf16_f32 v169, v54, v55
    v_cvt_pk_bf16_f32 v171, v58, v59
    v_permlane16_swap_b32 v168, v170
    s_nop 0
    v_permlane16_swap_b32 v169, v171
    buffer_store_dwordx4 v[168:171], v34, s[60:63], s70 offen offset:0 sc1
    v_cvt_pk_bf16_f32 v44, v60, v61
    v_cvt_pk_bf16_f32 v45, v62, v63
    buffer_store_dwordx2 v[44:45], v35, s[60:63], s70 offen offset:1024 sc1
L_convdone:
    s_waitcnt vmcnt(17)
    v_mfma_f32_16x16x32_bf16 v[4:7], a[0:3], v[176:179], 0
    buffer_load_dwordx4 v[48:51], v2, s[60:63], s95 offen offset:0 sc1
    s_waitcnt vmcnt(16)
    v_mfma_f32_16x16x32_bf16 v[4:7], a[20:23], v[180:183], v[4:7]
    s_waitcnt vmcnt(14)
    v_mfma_f32_16x16x32_bf16 v[4:7], a[40:43], v[184:187], v[4:7]
    s_waitcnt vmcnt(12)
    v_mfma_f32_16x16x32_bf16 v[4:7], a[60:63], v[188:191], v[4:7]
    v_mfma_f32_16x16x32_bf16 v[8:11], a[4:7], v[176:179], 0
    v_mfma_f32_16x16x32_bf16 v[8:11], a[24:27], v[180:183], v[8:11]
    buffer_load_dwordx4 v[52:55], v2, s[60:63], s95 offen offset:1024 sc1
    v_mfma_f32_16x16x32_bf16 v[8:11], a[44:47], v[184:187], v[8:11]
    v_mfma_f32_16x16x32_bf16 v[8:11], a[64:67], v[188:191], v[8:11]
    v_mfma_f32_16x16x32_bf16 v[12:15], a[8:11], v[176:179], 0
    v_mfma_f32_16x16x32_bf16 v[12:15], a[28:31], v[180:183], v[12:15]
    v_mfma_f32_16x16x32_bf16 v[12:15], a[48:51], v[184:187], v[12:15]
    buffer_load_dwordx4 v[56:59], v2, s[60:63], s95 offen offset:2048 sc1
    v_mfma_f32_16x16x32_bf16 v[12:15], a[68:71], v[188:191], v[12:15]
    v_mfma_f32_16x16x32_bf16 v[16:19], a[12:15], v[176:179], 0
    v_mfma_f32_16x16x32_bf16 v[16:19], a[32:35], v[180:183], v[16:19]
    v_mfma_f32_16x16x32_bf16 v[16:19], a[52:55], v[184:187], v[16:19]
    v_mfma_f32_16x16x32_bf16 v[16:19], a[72:75], v[188:191], v[16:19]
    buffer_load_dwordx4 v[60:63], v2, s[60:63], s95 offen offset:3072 sc1
    s_add_u32 s95, s95, 4096
    v_mfma_f32_16x16x32_bf16 v[20:23], a[16:19], v[176:179], 0
    v_mfma_f32_16x16x32_bf16 v[20:23], a[36:39], v[180:183], v[20:23]
    v_mfma_f32_16x16x32_bf16 v[20:23], a[56:59], v[184:187], v[20:23]
    v_mfma_f32_16x16x32_bf16 v[20:23], a[76:79], v[188:191], v[20:23]
    s_waitcnt vmcnt(14)
    v_mfma_f32_16x16x32_bf16 v[4:7], a[80:83], v[192:195], v[4:7]
    buffer_load_dwordx4 v[64:67], v2, s[60:63], s95 offen offset:0 sc1
    s_waitcnt vmcnt(14)
    v_mfma_f32_16x16x32_bf16 v[4:7], a[100:103], v[196:199], v[4:7]
    s_waitcnt vmcnt(13)
    v_mfma_f32_16x16x32_bf16 v[4:7], a[120:123], v[200:203], v[4:7]
    s_waitcnt vmcnt(12)
    v_mfma_f32_16x16x32_bf16 v[4:7], a[140:143], v[204:207], v[4:7]
    v_mfma_f32_16x16x32_bf16 v[8:11], a[84:87], v[192:195], v[8:11]
    v_mfma_f32_16x16x32_bf16 v[8:11], a[104:107], v[196:199], v[8:11]
    buffer_load_dwordx4 v[68:71], v2, s[60:63], s95 offen offset:1024 sc1
    v_mfma_f32_16x16x32_bf16 v[8:11], a[124:127], v[200:203], v[8:11]
    v_mfma_f32_16x16x32_bf16 v[8:11], a[144:147], v[204:207], v[8:11]
    v_mfma_f32_16x16x32_bf16 v[12:15], a[88:91], v[192:195], v[12:15]
    v_mfma_f32_16x16x32_bf16 v[12:15], a[108:111], v[196:199], v[12:15]
    v_mfma_f32_16x16x32_bf16 v[12:15], a[128:131], v[200:203], v[12:15]
    buffer_load_dwordx4 v[72:75], v2, s[60:63], s95 offen offset:2048 sc1
    v_mfma_f32_16x16x32_bf16 v[12:15], a[148:151], v[204:207], v[12:15]
    v_mfma_f32_16x16x32_bf16 v[16:19], a[92:95], v[192:195], v[16:19]
    v_mfma_f32_16x16x32_bf16 v[16:19], a[112:115], v[196:199], v[16:19]
    v_mfma_f32_16x16x32_bf16 v[16:19], a[132:135], v[200:203], v[16:19]
    v_mfma_f32_16x16x32_bf16 v[16:19], a[152:155], v[204:207], v[16:19]
    buffer_load_dwordx4 v[76:79], v2, s[60:63], s95 offen offset:3072 sc1
    s_add_u32 s95, s95, 4096
    v_mfma_f32_16x16x32_bf16 v[20:23], a[96:99], v[192:195], v[20:23]
    v_mfma_f32_16x16x32_bf16 v[20:23], a[116:119], v[196:199], v[20:23]
    v_mfma_f32_16x16x32_bf16 v[20:23], a[136:139], v[200:203], v[20:23]
    v_mfma_f32_16x16x32_bf16 v[20:23], a[156:159], v[204:207], v[20:23]
    s_waitcnt vmcnt(14)
    v_mfma_f32_16x16x32_bf16 v[4:7], a[160:163], v[208:211], v[4:7]
    buffer_load_dwordx4 v[80:83], v2, s[60:63], s95 offen offset:0 sc1
    s_waitcnt vmcnt(14)
    v_mfma_f32_16x16x32_bf16 v[4:7], a[180:183], v[212:215], v[4:7]
L_padM2:
    s_cbranch_execz L_backM
    s_nop 0
    s_waitcnt vmcnt(13)
    v_mfma_f32_16x16x32_bf16 v[4:7], a[200:203], v[216:219], v[4:7]
    s_waitcnt vmcnt(12)
    v_mfma_f32_16x16x32_bf16 v[4:7], a[220:223], v[220:223], v[4:7]
    v_mfma_f32_16x16x32_bf16 v[8:11], a[164:167], v[208:211], v[8:11]
    v_mfma_f32_16x16x32_bf16 v[8:11], a[184:187], v[212:215], v[8:11]
    buffer_load_dwordx4 v[84:87], v2, s[60:63], s95 offen offset:1024 sc1
    v_mfma_f32_16x16x32_bf16 v[8:11], a[204:207], v[216:219], v[8:11]
    v_mfma_f32_16x16x32_bf16 v[8:11], a[224:227], v[220:223], v[8:11]
    v_mfma_f32_16x16x32_bf16 v[12:15], a[168:171], v[208:211], v[12:15]
    v_mfma_f32_16x16x32_bf16 v[12:15], a[188:191], v[212:215], v[12:15]
    s_waitcnt vmcnt(10)
    s_barrier
    s_mov_b64 exec, 3
    buffer_store_dword v30, v226, s[60:63], s83 offen sc1
    s_mov_b64 exec, -1
    v_mfma_f32_16x16x32_bf16 v[12:15], a[208:211], v[216:219], v[12:15]
    buffer_load_dwordx4 v[88:91], v2, s[60:63], s95 offen offset:2048 sc1
    v_mfma_f32_16x16x32_bf16 v[12:15], a[228:231], v[220:223], v[12:15]
    ds_write_b128 v36, v[4:7] offset:0
    v_mfma_f32_16x16x32_bf16 v[16:19], a[172:175], v[208:211], v[16:19]
    buffer_load_dword v24, v237, s[60:63], s77 offen sc1
    v_mfma_f32_16x16x32_bf16 v[16:19], a[192:195], v[212:215], v[16:19]
    buffer_load_dword v26, v237, s[60:63], s77 offen offset:2048 sc1
    v_mfma_f32_16x16x32_bf16 v[16:19], a[212:215], v[216:219], v[16:19]
    s_mov_b32 exec_hi, 0
    buffer_load_dword v27, v237, s[60:63], s84 offen sc1
    s_mov_b32 exec_hi, -1
    v_mfma_f32_16x16x32_bf16 v[16:19], a[232:235], v[220:223], v[16:19]
    buffer_load_dwordx4 v[92:95], v2, s[60:63], s95 offen offset:3072 sc1
    v_mfma_f32_16x16x32_bf16 v[20:23], a[176:179], v[208:211], v[20:23]
    ds_write_b128 v36, v[8:11] offset:1024
    v_mfma_f32_16x16x32_bf16 v[20:23], a[196:199], v[212:215], v[20:23]
    v_mfma_f32_16x16x32_bf16 v[20:23], a[216:219], v[216:219], v[20:23]
    v_mfma_f32_16x16x32_bf16 v[20:23], a[236:239], v[220:223], v[20:23]
    s_waitcnt vmcnt(15)
    v_mfma_f32_16x16x32_bf16 v[40:43], a[0:3], v[48:51], 0
    buffer_load_dwordx4 v[96:99], v2, s[60:63], s96 offen offset:0 sc1
    s_waitcnt vmcnt(15)
    v_mfma_f32_16x16x32_bf16 v[40:43], a[20:23], v[52:55], v[40:43]
    ds_write_b128 v36, v[12:15] offset:2048
    s_waitcnt vmcnt(14)
    v_mfma_f32_16x16x32_bf16 v[40:43], a[40:43], v[56:59], v[40:43]
    s_waitcnt vmcnt(13)
    v_mfma_f32_16x16x32_bf16 v[40:43], a[60:63], v[60:63], v[40:43]
    v_mfma_f32_16x16x32_bf16 v[44:47], a[4:7], v[48:51], 0
    v_mfma_f32_16x16x32_bf16 v[44:47], a[24:27], v[52:55], v[44:47]
    buffer_load_dwordx4 v[100:103], v2, s[60:63], s96 offen offset:1024 sc1
    v_mfma_f32_16x16x32_bf16 v[44:47], a[44:47], v[56:59], v[44:47]
    ds_write_b128 v36, v[16:19] offset:3072
    v_mfma_f32_16x16x32_bf16 v[44:47], a[64:67], v[60:63], v[44:47]
    v_mfma_f32_16x16x32_bf16 v[240:243], a[8:11], v[48:51], 0
    v_mfma_f32_16x16x32_bf16 v[240:243], a[28:31], v[52:55], v[240:243]
    v_mfma_f32_16x16x32_bf16 v[240:243], a[48:51], v[56:59], v[240:243]
    buffer_load_dwordx4 v[104:107], v2, s[60:63], s96 offen offset:2048 sc1
    v_mfma_f32_16x16x32_bf16 v[240:243], a[68:71], v[60:63], v[240:243]
    ds_write_b128 v36, v[20:23] offset:4096
    v_mfma_f32_16x16x32_bf16 v[244:247], a[12:15], v[48:51], 0
    v_mfma_f32_16x16x32_bf16 v[244:247], a[32:35], v[52:55], v[244:247]
    v_mfma_f32_16x16x32_bf16 v[244:247], a[52:55], v[56:59], v[244:247]
    v_mfma_f32_16x16x32_bf16 v[244:247], a[72:75], v[60:63], v[244:247]
    buffer_load_dwordx4 v[108:111], v2, s[60:63], s96 offen offset:3072 sc1
    s_add_u32 s96, s96, 4096
    v_mfma_f32_16x16x32_bf16 v[248:251], a[16:19], v[48:51], 0
    v_mfma_f32_16x16x32_bf16 v[248:251], a[36:39], v[52:55], v[248:251]
    v_mfma_f32_16x16x32_bf16 v[248:251], a[56:59], v[56:59], v[248:251]
    v_mfma_f32_16x16x32_bf16 v[248:251], a[76:79], v[60:63], v[248:251]
    s_waitcnt vmcnt(15)
    v_mfma_f32_16x16x32_bf16 v[40:43], a[80:83], v[64:67], v[40:43]
    buffer_load_dwordx4 v[112:115], v2, s[60:63], s96 offen offset:0 sc1
    s_waitcnt vmcnt(15)
    v_mfma_f32_16x16x32_bf16 v[40:43], a[100:103], v[68:71], v[40:43]
    s_waitcnt vmcnt(14)
    v_mfma_f32_16x16x32_bf16 v[40:43], a[120:123], v[72:75], v[40:43]
    s_waitcnt vmcnt(13)
    v_mfma_f32_16x16x32_bf16 v[40:43], a[140:143], v[76:79], v[40:43]
    v_mfma_f32_16x16x32_bf16 v[44:47], a[84:87], v[64:67], v[44:47]
    v_mfma_f32_16x16x32_bf16 v[44:47], a[104:107], v[68:71], v[44:47]
    buffer_load_dwordx4 v[116:119], v2, s[60:63], s96 offen offset:1024 sc1
    v_mfma_f32_16x16x32_bf16 v[44:47], a[124:127], v[72:75], v[44:47]
    v_mfma_f32_16x16x32_bf16 v[44:47], a[144:147], v[76:79], v[44:47]
    v_mfma_f32_16x16x32_bf16 v[240:243], a[88:91], v[64:67], v[240:243]
    v_mfma_f32_16x16x32_bf16 v[240:243], a[108:111], v[68:71], v[240:243]
    v_mfma_f32_16x16x32_bf16 v[240:243], a[128:131], v[72:75], v[240:243]
    buffer_load_dwordx4 v[120:123], v2, s[60:63], s96 offen offset:2048 sc1
    v_mfma_f32_16x16x32_bf16 v[240:243], a[148:151], v[76:79], v[240:243]
    v_mfma_f32_16x16x32_bf16 v[244:247], a[92:95], v[64:67], v[244:247]
    v_mfma_f32_16x16x32_bf16 v[244:247], a[112:115], v[68:71], v[244:247]
    v_mfma_f32_16x16x32_bf16 v[244:247], a[132:135], v[72:75], v[244:247]
    v_mfma_f32_16x16x32_bf16 v[244:247], a[152:155], v[76:79], v[244:247]
    buffer_load_dwordx4 v[124:127], v2, s[60:63], s96 offen offset:3072 sc1
    s_add_u32 s96, s96, 4096
    v_mfma_f32_16x16x32_bf16 v[248:251], a[96:99], v[64:67], v[248:251]
    v_mfma_f32_16x16x32_bf16 v[248:251], a[116:119], v[68:71], v[248:251]
    v_mfma_f32_16x16x32_bf16 v[248:251], a[136:139], v[72:75], v[248:251]
    v_mfma_f32_16x16x32_bf16 v[248:251], a[156:159], v[76:79], v[248:251]
    s_load_dwordx8 s[16:23], s[46:47], s86 offset:262144 glc
    s_waitcnt vmcnt(15)
    v_mfma_f32_16x16x32_bf16 v[40:43], a[160:163], v[80:83], v[40:43]
    buffer_load_dwordx4 v[128:131], v2, s[60:63], s96 offen offset:0 sc1
    s_waitcnt vmcnt(15)
    v_mfma_f32_16x16x32_bf16 v[40:43], a[180:183], v[84:87], v[40:43]
    s_waitcnt vmcnt(13)
    v_mfma_f32_16x16x32_bf16 v[40:43], a[200:203], v[88:91], v[40:43]
    s_waitcnt vmcnt(9)
    v_mfma_f32_16x16x32_bf16 v[40:43], a[220:223], v[92:95], v[40:43]
    v_mfma_f32_16x16x32_bf16 v[44:47], a[164:167], v[80:83], v[44:47]
    v_mfma_f32_16x16x32_bf16 v[44:47], a[184:187], v[84:87], v[44:47]
    buffer_load_dwordx4 v[132:135], v2, s[60:63], s96 offen offset:1024 sc1
    v_mfma_f32_16x16x32_bf16 v[44:47], a[204:207], v[88:91], v[44:47]
    v_add_f32 v24, v24, v26
    v_mfma_f32_16x16x32_bf16 v[44:47], a[224:227], v[92:95], v[44:47]
    v_add_f32 v24, v24, v27
    v_mfma_f32_16x16x32_bf16 v[240:243], a[168:171], v[80:83], v[240:243]
    v_mov_b32 v26, v24
    v_mfma_f32_16x16x32_bf16 v[240:243], a[188:191], v[84:87], v[240:243]
    s_nop 0
    v_mfma_f32_16x16x32_bf16 v[240:243], a[208:211], v[88:91], v[240:243]
    buffer_load_dwordx4 v[136:139], v2, s[60:63], s96 offen offset:2048 sc1
    v_mfma_f32_16x16x32_bf16 v[240:243], a[228:231], v[92:95], v[240:243]
    ds_write_b128 v37, v[40:43] offset:0
    v_mfma_f32_16x16x32_bf16 v[244:247], a[172:175], v[80:83], v[244:247]
    v_permlane32_swap_b32 v24, v26
    v_mfma_f32_16x16x32_bf16 v[244:247], a[192:195], v[84:87], v[244:247]
    v_add_f32 v24, v24, v26
    v_mfma_f32_16x16x32_bf16 v[244:247], a[212:215], v[88:91], v[244:247]
    v_mov_b32 v26, v24
    v_mfma_f32_16x16x32_bf16 v[244:247], a[232:235], v[92:95], v[244:247]
    buffer_load_dwordx4 v[140:143], v2, s[60:63], s96 offen offset:3072 sc1
    v_mfma_f32_16x16x32_bf16 v[248:251], a[176:179], v[80:83], v[248:251]
    ds_write_b128 v37, v[44:47] offset:1024
    v_mfma_f32_16x16x32_bf16 v[248:251], a[196:199], v[84:87], v[248:251]
    s_nop 0
    v_mfma_f32_16x16x32_bf16 v[248:251], a[216:219], v[88:91], v[248:251]
    v_permlane16_swap_b32 v24, v26
    v_mfma_f32_16x16x32_bf16 v[248:251], a[236:239], v[92:95], v[248:251]
    v_add_f32 v24, v24, v26
    s_waitcnt vmcnt(11)
    v_mfma_f32_16x16x32_bf16 v[4:7], a[0:3], v[96:99], 0
    buffer_load_dwordx4 v[176:179], v2, s[60:63], s97 offen offset:0 sc1
    s_waitcnt vmcnt(11)
    v_mfma_f32_16x16x32_bf16 v[4:7], a[20:23], v[100:103], v[4:7]
    ds_write_b128 v37, v[240:243] offset:2048
    s_waitcnt vmcnt(10)
    v_mfma_f32_16x16x32_bf16 v[4:7], a[40:43], v[104:107], v[4:7]
    v_mul_f32 v24, s72, v24
    s_waitcnt vmcnt(9)
    v_mfma_f32_16x16x32_bf16 v[4:7], a[60:63], v[108:111], v[4:7]
    v_exp_f32 v24, v24
    v_mfma_f32_16x16x32_bf16 v[8:11], a[4:7], v[96:99], 0
    v_add_f32 v24, 1.0, v24
    v_mfma_f32_16x16x32_bf16 v[8:11], a[24:27], v[100:103], v[8:11]
    buffer_load_dwordx4 v[180:183], v2, s[60:63], s97 offen offset:1024 sc1
    v_mfma_f32_16x16x32_bf16 v[8:11], a[44:47], v[104:107], v[8:11]
    ds_write_b128 v37, v[244:247] offset:3072
    v_mfma_f32_16x16x32_bf16 v[8:11], a[64:67], v[108:111], v[8:11]
    v_rcp_f32 v24, v24
    v_mfma_f32_16x16x32_bf16 v[12:15], a[8:11], v[96:99], 0
    v_sub_f32 v26, 1.0, v24
    v_mfma_f32_16x16x32_bf16 v[12:15], a[28:31], v[100:103], v[12:15]
    v_mfma_f32_16x16x32_bf16 v[12:15], a[48:51], v[104:107], v[12:15]
    buffer_load_dwordx4 v[184:187], v2, s[60:63], s97 offen offset:2048 sc1
    v_mfma_f32_16x16x32_bf16 v[12:15], a[68:71], v[108:111], v[12:15]
    ds_write_b128 v37, v[248:251] offset:4096
    v_mfma_f32_16x16x32_bf16 v[16:19], a[12:15], v[96:99], 0
    v_mfma_f32_16x16x32_bf16 v[16:19], a[32:35], v[100:103], v[16:19]
    v_mfma_f32_16x16x32_bf16 v[16:19], a[52:55], v[104:107], v[16:19]
    s_waitcnt lgkmcnt(0)
    s_xor_b64 s[16:17], s[16:17], s[6:7]
    s_xor_b64 s[18:19], s[18:19], s[6:7]
    s_or_b64 s[16:17], s[16:17], s[18:19]
    s_xor_b64 s[20:21], s[20:21], s[6:7]
    s_or_b64 s[16:17], s[16:17], s[20:21]
    s_xor_b64 s[22:23], s[22:23], s[6:7]
    s_or_b64 s[16:17], s[16:17], s[22:23]
    s_cbranch_scc1 L_sa_slow
L_sa_ok:
    s_waitcnt lgkmcnt(0)
    s_barrier
    v_mfma_f32_16x16x32_bf16 v[16:19], a[72:75], v[108:111], v[16:19]
    buffer_load_dwordx4 v[188:191], v2, s[60:63], s97 offen offset:3072 sc1
    s_add_u32 s97, s97, 4096
    v_mfma_f32_16x16x32_bf16 v[20:23], a[16:19], v[96:99], 0
    buffer_load_dwordx4 v[164:167], v227, s[60:63], s76 offen sc1
    s_add_u32 s76, s76, 32768
    v_mfma_f32_16x16x32_bf16 v[20:23], a[36:39], v[100:103], v[20:23]
    buffer_load_dwordx4 v[168:171], v227, s[60:63], s76 offen sc1
    s_add_u32 s76, s76, 32768
    v_mfma_f32_16x16x32_bf16 v[20:23], a[56:59], v[104:107], v[20:23]
    s_mov_b32 exec_hi, 0
    buffer_load_dwordx4 v[172:175], v227, s[60:63], s76 offen sc1
    s_mov_b32 exec_hi, -1
    v_mfma_f32_16x16x32_bf16 v[20:23], a[76:79], v[108:111], v[20:23]
    ds_read_b128 v[48:51], v39 offset:0
    s_waitcnt vmcnt(14)
    v_mfma_f32_16x16x32_bf16 v[4:7], a[80:83], v[112:115], v[4:7]
    buffer_load_dwordx4 v[192:195], v2, s[60:63], s97 offen offset:0 sc1
    s_waitcnt vmcnt(14)
    v_mfma_f32_16x16x32_bf16 v[4:7], a[100:103], v[116:119], v[4:7]
    ds_read_b128 v[52:55], v39 offset:1024
    s_waitcnt vmcnt(13)
    v_mfma_f32_16x16x32_bf16 v[4:7], a[120:123], v[120:123], v[4:7]
    ds_read_b128 v[56:59], v39 offset:2048
    s_waitcnt vmcnt(12)
    v_mfma_f32_16x16x32_bf16 v[4:7], a[140:143], v[124:127], v[4:7]
    ds_read_b128 v[60:63], v39 offset:3072
    v_mfma_f32_16x16x32_bf16 v[8:11], a[84:87], v[112:115], v[8:11]
    ds_read_b128 v[64:67], v39 offset:4096
    v_mfma_f32_16x16x32_bf16 v[8:11], a[104:107], v[116:119], v[8:11]
    buffer_load_dwordx4 v[196:199], v2, s[60:63], s97 offen offset:1024 sc1
    v_mfma_f32_16x16x32_bf16 v[8:11], a[124:127], v[120:123], v[8:11]
    ds_read_b128 v[68:71], v39 offset:5120
    v_mfma_f32_16x16x32_bf16 v[8:11], a[144:147], v[124:127], v[8:11]
    ds_read_b128 v[72:75], v39 offset:6144
    v_mfma_f32_16x16x32_bf16 v[12:15], a[88:91], v[112:115], v[12:15]
    ds_read_b128 v[76:79], v39 offset:7168
    v_mfma_f32_16x16x32_bf16 v[12:15], a[108:111], v[116:119], v[12:15]
    ds_read_b128 v[80:83], v39 offset:8192
    v_mfma_f32_16x16x32_bf16 v[12:15], a[128:131], v[120:123], v[12:15]
    buffer_load_dwordx4 v[200:203], v2, s[60:63], s97 offen offset:2048 sc1
    v_mfma_f32_16x16x32_bf16 v[12:15], a[148:151], v[124:127], v[12:15]
    ds_read_b128 v[84:87], v39 offset:9216
    v_mfma_f32_16x16x32_bf16 v[16:19], a[92:95], v[112:115], v[16:19]
    v_mfma_f32_16x16x32_bf16 v[16:19], a[112:115], v[116:119], v[16:19]
    v_mfma_f32_16x16x32_bf16 v[16:19], a[132:135], v[120:123], v[16:19]
    v_mfma_f32_16x16x32_bf16 v[16:19], a[152:155], v[124:127], v[16:19]
    buffer_load_dwordx4 v[204:207], v2, s[60:63], s97 offen offset:3072 sc1
    s_add_u32 s97, s97, 4096
    v_mfma_f32_16x16x32_bf16 v[20:23], a[96:99], v[112:115], v[20:23]
    s_waitcnt lgkmcnt(4)
    v_mul_f32 v144, v26, v68
    v_mul_f32 v145, v26, v69
    v_mfma_f32_16x16x32_bf16 v[20:23], a[116:119], v[116:119], v[20:23]
    v_mul_f32 v146, v26, v70
    v_mul_f32 v147, v26, v71
    v_mfma_f32_16x16x32_bf16 v[20:23], a[136:139], v[120:123], v[20:23]
    s_waitcnt lgkmcnt(3)
    v_mul_f32 v148, v26, v72
    v_mul_f32 v149, v26, v73
    v_mfma_f32_16x16x32_bf16 v[20:23], a[156:159], v[124:127], v[20:23]
    v_mul_f32 v150, v26, v74
    v_mul_f32 v151, v26, v75
    s_waitcnt vmcnt(14)
    v_mfma_f32_16x16x32_bf16 v[4:7], a[160:163], v[128:131], v[4:7]
    buffer_load_dwordx4 v[208:211], v2, s[60:63], s97 offen offset:0 sc1
    s_waitcnt vmcnt(14)
    v_mfma_f32_16x16x32_bf16 v[4:7], a[180:183], v[132:135], v[4:7]
    s_waitcnt lgkmcnt(2)
    v_mul_f32 v152, v26, v76
    v_mul_f32 v153, v26, v77
    s_waitcnt vmcnt(13)
    v_mfma_f32_16x16x32_bf16 v[4:7], a[200:203], v[136:139], v[4:7]
    v_mul_f32 v154, v26, v78
    v_mul_f32 v155, v26, v79
    s_waitcnt vmcnt(12)
    v_mfma_f32_16x16x32_bf16 v[4:7], a[220:223], v[140:143], v[4:7]
    s_waitcnt lgkmcnt(1)
    v_mul_f32 v156, v26, v80
    v_mul_f32 v157, v26, v81
    v_mfma_f32_16x16x32_bf16 v[8:11], a[164:167], v[128:131], v[8:11]
    v_mul_f32 v158, v26, v82
    v_mul_f32 v159, v26, v83
    v_mfma_f32_16x16x32_bf16 v[8:11], a[184:187], v[132:135], v[8:11]
    buffer_load_dwordx4 v[212:215], v2, s[60:63], s97 offen offset:1024 sc1
    v_mfma_f32_16x16x32_bf16 v[8:11], a[204:207], v[136:139], v[8:11]
    s_waitcnt lgkmcnt(0)
    v_mul_f32 v160, v26, v84
    v_mul_f32 v161, v26, v85
    v_mfma_f32_16x16x32_bf16 v[8:11], a[224:227], v[140:143], v[8:11]
    v_mul_f32 v162, v26, v86
    v_mul_f32 v163, v26, v87
    v_mfma_f32_16x16x32_bf16 v[12:15], a[168:171], v[128:131], v[12:15]
    s_waitcnt vmcnt(8)
    ds_write_b128 v228, v[164:167] offset:0
    v_mfma_f32_16x16x32_bf16 v[12:15], a[188:191], v[132:135], v[12:15]
    v_mfma_f32_16x16x32_bf16 v[12:15], a[208:211], v[136:139], v[12:15]
    buffer_load_dwordx4 v[216:219], v2, s[60:63], s97 offen offset:2048 sc1
    v_mfma_f32_16x16x32_bf16 v[12:15], a[228:231], v[140:143], v[12:15]
    ds_write_b128 v38, v[4:7] offset:0
    v_mfma_f32_16x16x32_bf16 v[16:19], a[172:175], v[128:131], v[16:19]
    v_mfma_f32_16x16x32_bf16 v[16:19], a[192:195], v[132:135], v[16:19]
    s_waitcnt vmcnt(8)
    ds_write_b128 v228, v[168:171] offset:1280
    v_mfma_f32_16x16x32_bf16 v[16:19], a[212:215], v[136:139], v[16:19]
    v_mfma_f32_16x16x32_bf16 v[16:19], a[232:235], v[140:143], v[16:19]
    buffer_load_dwordx4 v[220:223], v2, s[60:63], s97 offen offset:3072 sc1
    v_mfma_f32_16x16x32_bf16 v[20:23], a[176:179], v[128:131], v[20:23]
    ds_write_b128 v38, v[8:11] offset:1024
    v_mfma_f32_16x16x32_bf16 v[20:23], a[196:199], v[132:135], v[20:23]
    v_mfma_f32_16x16x32_bf16 v[20:23], a[216:219], v[136:139], v[20:23]
    s_waitcnt vmcnt(8)
    s_mov_b32 exec_hi, 0
    ds_write_b128 v228, v[172:175] offset:2560
    s_mov_b32 exec_hi, -1
    v_mfma_f32_16x16x32_bf16 v[20:23], a[236:239], v[140:143], v[20:23]
    ds_write_b128 v38, v[12:15] offset:2048
    v_mfma_f32_16x16x32_bf16 v[40:43], a[0:3], v[176:179], v[48:51]
    v_mfma_f32_16x16x32_bf16 v[40:43], a[20:23], v[180:183], v[40:43]
    v_mfma_f32_16x16x32_bf16 v[40:43], a[40:43], v[184:187], v[40:43]
    v_mfma_f32_16x16x32_bf16 v[40:43], a[60:63], v[188:191], v[40:43]
    ds_write_b128 v38, v[16:19] offset:3072
    v_mfma_f32_16x16x32_bf16 v[44:47], a[4:7], v[176:179], v[52:55]
    v_mfma_f32_16x16x32_bf16 v[44:47], a[24:27], v[180:183], v[44:47]
    v_mfma_f32_16x16x32_bf16 v[44:47], a[44:47], v[184:187], v[44:47]
    v_mfma_f32_16x16x32_bf16 v[44:47], a[64:67], v[188:191], v[44:47]
    ds_write_b128 v38, v[20:23] offset:4096
    v_mfma_f32_16x16x32_bf16 v[240:243], a[8:11], v[176:179], v[56:59]
    v_mfma_f32_16x16x32_bf16 v[240:243], a[28:31], v[180:183], v[240:243]
    s_waitcnt lgkmcnt(0)
    s_barrier
    v_mfma_f32_16x16x32_bf16 v[240:243], a[48:51], v[184:187], v[240:243]
    ds_read_b64_tr_b16 v[164:165], v229 offset:0
    v_mfma_f32_16x16x32_bf16 v[240:243], a[68:71], v[188:191], v[240:243]
    ds_read_b64_tr_b16 v[166:167], v229 offset:640
    v_mfma_f32_16x16x32_bf16 v[244:247], a[12:15], v[176:179], v[60:63]
    ds_read_b64_tr_b16 v[168:169], v229 offset:1280
    v_mfma_f32_16x16x32_bf16 v[244:247], a[32:35], v[180:183], v[244:247]
    ds_read_b64_tr_b16 v[170:171], v229 offset:1920
    v_mfma_f32_16x16x32_bf16 v[244:247], a[52:55], v[184:187], v[244:247]
    ds_read_b64_tr_b16 v[172:173], v229 offset:2560
    v_mfma_f32_16x16x32_bf16 v[244:247], a[72:75], v[188:191], v[244:247]
    ds_read_b128 v[96:99], v39 offset:10240
    v_mfma_f32_16x16x32_bf16 v[248:251], a[16:19], v[176:179], v[64:67]
    ds_read_b128 v[100:103], v39 offset:11264
    v_mfma_f32_16x16x32_bf16 v[248:251], a[36:39], v[180:183], v[248:251]
    ds_read_b128 v[104:107], v39 offset:12288
    v_mfma_f32_16x16x32_bf16 v[248:251], a[56:59], v[184:187], v[248:251]
    ds_read_b128 v[108:111], v39 offset:13312
    v_mfma_f32_16x16x32_bf16 v[248:251], a[76:79], v[188:191], v[248:251]
    ds_read_b128 v[112:115], v39 offset:14336
    s_waitcnt vmcnt(7)
    v_mfma_f32_16x16x32_bf16 v[40:43], a[80:83], v[192:195], v[40:43]
    s_waitcnt lgkmcnt(9)
    v_lshlrev_b32 v68, 16, v164
    s_waitcnt vmcnt(6)
    v_mfma_f32_16x16x32_bf16 v[40:43], a[100:103], v[196:199], v[40:43]
    v_and_b32 v69, s93, v164
    v_fmac_f32 v144, v24, v68
    s_waitcnt vmcnt(5)
    v_mfma_f32_16x16x32_bf16 v[40:43], a[120:123], v[200:203], v[40:43]
    v_lshlrev_b32 v70, 16, v165
    v_fmac_f32 v145, v24, v69
    s_waitcnt vmcnt(4)
    v_mfma_f32_16x16x32_bf16 v[40:43], a[140:143], v[204:207], v[40:43]
    v_and_b32 v71, s93, v165
    v_fmac_f32 v146, v24, v70
    v_mfma_f32_16x16x32_bf16 v[44:47], a[84:87], v[192:195], v[44:47]
    s_waitcnt lgkmcnt(8)
    v_lshlrev_b32 v72, 16, v166
    v_fmac_f32 v147, v24, v71
    v_mfma_f32_16x16x32_bf16 v[44:47], a[104:107], v[196:199], v[44:47]
    v_and_b32 v73, s93, v166
    v_fmac_f32 v148, v24, v72
    v_mfma_f32_16x16x32_bf16 v[44:47], a[124:127], v[200:203], v[44:47]
    v_lshlrev_b32 v74, 16, v167
    v_fmac_f32 v149, v24, v73
    v_mfma_f32_16x16x32_bf16 v[44:47], a[144:147], v[204:207], v[44:47]
    v_and_b32 v75, s93, v167
    v_fmac_f32 v150, v24, v74
    v_mfma_f32_16x16x32_bf16 v[240:243], a[88:91], v[192:195], v[240:243]
    s_waitcnt lgkmcnt(7)
    v_lshlrev_b32 v76, 16, v168
    v_fmac_f32 v151, v24, v75
    v_mfma_f32_16x16x32_bf16 v[240:243], a[108:111], v[196:199], v[240:243]
    v_and_b32 v77, s93, v168
    v_fmac_f32 v152, v24, v76
    v_mfma_f32_16x16x32_bf16 v[240:243], a[128:131], v[200:203], v[240:243]
    v_lshlrev_b32 v78, 16, v169
    v_fmac_f32 v153, v24, v77
    v_mfma_f32_16x16x32_bf16 v[240:243], a[148:151], v[204:207], v[240:243]
    v_and_b32 v79, s93, v169
    v_fmac_f32 v154, v24, v78
    v_mfma_f32_16x16x32_bf16 v[244:247], a[92:95], v[192:195], v[244:247]
    s_waitcnt lgkmcnt(6)
    v_lshlrev_b32 v80, 16, v170
    v_fmac_f32 v155, v24, v79
    v_mfma_f32_16x16x32_bf16 v[244:247], a[112:115], v[196:199], v[244:247]
    v_and_b32 v81, s93, v170
    v_fmac_f32 v156, v24, v80
    v_mfma_f32_16x16x32_bf16 v[244:247], a[132:135], v[200:203], v[244:247]
    v_lshlrev_b32 v82, 16, v171
    v_fmac_f32 v157, v24, v81
    v_mfma_f32_16x16x32_bf16 v[244:247], a[152:155], v[204:207], v[244:247]
    v_and_b32 v83, s93, v171
    v_fmac_f32 v158, v24, v82
    v_mfma_f32_16x16x32_bf16 v[248:251], a[96:99], v[192:195], v[248:251]
    s_waitcnt lgkmcnt(5)
    v_lshlrev_b32 v84, 16, v172
    v_fmac_f32 v159, v24, v83
    v_mfma_f32_16x16x32_bf16 v[248:251], a[116:119], v[196:199], v[248:251]
    v_and_b32 v85, s93, v172
    v_fmac_f32 v160, v24, v84
    v_mfma_f32_16x16x32_bf16 v[248:251], a[136:139], v[200:203], v[248:251]
    v_lshlrev_b32 v86, 16, v173
    v_fmac_f32 v161, v24, v85
    v_mfma_f32_16x16x32_bf16 v[248:251], a[156:159], v[204:207], v[248:251]
    v_and_b32 v87, s93, v173
    v_fmac_f32 v162, v24, v86
    s_waitcnt vmcnt(3)
    v_mfma_f32_16x16x32_bf16 v[40:43], a[160:163], v[208:211], v[40:43]
    v_fmac_f32 v163, v24, v87
    s_waitcnt vmcnt(2)
    v_mfma_f32_16x16x32_bf16 v[40:43], a[180:183], v[212:215], v[40:43]
    s_waitcnt lgkmcnt(4)
    v_fmac_f32 v144, v26, v96
    v_fmac_f32 v145, v26, v97
    s_waitcnt vmcnt(1)
    v_mfma_f32_16x16x32_bf16 v[40:43], a[200:203], v[216:219], v[40:43]
    v_fmac_f32 v146, v26, v98
    v_fmac_f32 v147, v26, v99
    s_waitcnt vmcnt(0)
    v_mfma_f32_16x16x32_bf16 v[40:43], a[220:223], v[220:223], v[40:43]
    s_waitcnt lgkmcnt(3)
    v_fmac_f32 v148, v26, v100
    v_fmac_f32 v149, v26, v101
    v_mfma_f32_16x16x32_bf16 v[44:47], a[164:167], v[208:211], v[44:47]
    v_fmac_f32 v150, v26, v102
    v_fmac_f32 v151, v26, v103
    v_mfma_f32_16x16x32_bf16 v[44:47], a[184:187], v[212:215], v[44:47]
    s_waitcnt lgkmcnt(2)
    v_fmac_f32 v152, v26, v104
    v_fmac_f32 v153, v26, v105
    v_mfma_f32_16x16x32_bf16 v[44:47], a[204:207], v[216:219], v[44:47]
    v_fmac_f32 v154, v26, v106
    v_fmac_f32 v155, v26, v107
    v_mfma_f32_16x16x32_bf16 v[44:47], a[224:227], v[220:223], v[44:47]
    s_waitcnt lgkmcnt(1)
    v_fmac_f32 v156, v26, v108
    v_fmac_f32 v157, v26, v109
    v_mfma_f32_16x16x32_bf16 v[240:243], a[168:171], v[208:211], v[240:243]
    v_fmac_f32 v158, v26, v110
    v_fmac_f32 v159, v26, v111
    v_mfma_f32_16x16x32_bf16 v[240:243], a[188:191], v[212:215], v[240:243]
    s_waitcnt lgkmcnt(0)
    v_fmac_f32 v160, v26, v112
    v_fmac_f32 v161, v26, v113
    v_mfma_f32_16x16x32_bf16 v[240:243], a[208:211], v[216:219], v[240:243]
    v_fmac_f32 v162, v26, v114
    v_fmac_f32 v163, v26, v115
    v_mfma_f32_16x16x32_bf16 v[240:243], a[228:231], v[220:223], v[240:243]
    v_fmac_f32 v144, v26, v40
    v_fmac_f32 v145, v26, v41
    v_mfma_f32_16x16x32_bf16 v[244:247], a[172:175], v[208:211], v[244:247]
    v_fmac_f32 v146, v26, v42
    v_fmac_f32 v147, v26, v43
    v_mfma_f32_16x16x32_bf16 v[244:247], a[192:195], v[212:215], v[244:247]
    v_cvt_pk_bf16_f32 v128, v144, v145
    v_cvt_pk_bf16_f32 v129, v146, v147
    v_mfma_f32_16x16x32_bf16 v[244:247], a[212:215], v[216:219], v[244:247]
    ds_write_b64 v230, v[128:129] offset:0
    v_mfma_f32_16x16x32_bf16 v[244:247], a[232:235], v[220:223], v[244:247]
    v_fmac_f32 v148, v26, v44
    v_fmac_f32 v149, v26, v45
    v_mfma_f32_16x16x32_bf16 v[248:251], a[176:179], v[208:211], v[248:251]
    v_fmac_f32 v150, v26, v46
    v_fmac_f32 v151, v26, v47
    v_mfma_f32_16x16x32_bf16 v[248:251], a[196:199], v[212:215], v[248:251]
    v_cvt_pk_bf16_f32 v130, v148, v149
    v_cvt_pk_bf16_f32 v131, v150, v151
    v_mfma_f32_16x16x32_bf16 v[248:251], a[216:219], v[216:219], v[248:251]
    ds_write_b64 v230, v[130:131] offset:8
    v_mfma_f32_16x16x32_bf16 v[248:251], a[236:239], v[220:223], v[248:251]
    v_fmac_f32 v152, v26, v240
    v_fmac_f32 v153, v26, v241
    s_nop 3
    v_fmac_f32 v154, v26, v242
    v_fmac_f32_e64 v155, v26, v243
    v_cvt_pk_bf16_f32 v132, v152, v153
    v_cvt_pk_bf16_f32 v133, v154, v155
    v_fmac_f32 v156, v26, v244
    v_fmac_f32 v157, v26, v245
    v_fmac_f32 v158, v26, v246
    v_fmac_f32 v159, v26, v247
    v_cvt_pk_bf16_f32 v134, v156, v157
    v_cvt_pk_bf16_f32 v135, v158, v159
    v_fmac_f32 v160, v26, v248
    v_fmac_f32 v161, v26, v249
    v_fmac_f32 v162, v26, v250
    v_fmac_f32 v163, v26, v251
    v_cvt_pk_bf16_f32 v136, v160, v161
    v_cvt_pk_bf16_f32 v137, v162, v163
    ds_write_b64 v230, v[132:133] offset:16
    ds_write_b64 v230, v[134:135] offset:24
    ds_write_b64 v230, v[136:137] offset:32
    ds_read_b128 v[48:51], v231 offset:0
    ds_read_b128 v[52:55], v231 offset:1408
    ds_read_b128 v[56:59], v232 offset:128
    s_add_u32 s4, s71, 10240
    s_waitcnt lgkmcnt(2)
    buffer_store_dwordx4 v[48:51], v234, s[64:67], s71 offen sc1
    s_waitcnt lgkmcnt(1)
    buffer_store_dwordx4 v[52:55], v234, s[64:67], s4 offen sc1
    s_waitcnt lgkmcnt(0)
    s_mov_b32 exec_hi, 0
    buffer_store_dwordx4 v[56:59], v235, s[64:67], s80 offen sc1
    s_mov_b32 exec_hi, -1
L_end:
    s_endpgm
L_sw_slow:
    s_mov_b32 s82, 0x20000
L_sw_lp:
    s_sub_u32 s82, s82, 1
    s_cbranch_scc1 L_sw_ok
    s_load_dwordx8 s[24:31], s[46:47], s86 offset:0 glc
    s_waitcnt lgkmcnt(0)
    s_cmp_lg_u64 s[24:25], s[6:7]
    s_cbranch_scc1 L_sw_lp
    s_cmp_lg_u64 s[26:27], s[6:7]
    s_cbranch_scc1 L_sw_lp
    s_cmp_lg_u64 s[28:29], s[6:7]
    s_cbranch_scc1 L_sw_lp
    s_cmp_lg_u64 s[30:31], s[6:7]
    s_cbranch_scc1 L_sw_lp
    s_branch L_sw_ok
L_su_slow:
    s_mov_b32 s82, 0x20000
L_su_lp:
    s_sub_u32 s82, s82, 1
    s_cbranch_scc1 L_su_ok
    s_load_dwordx8 s[16:23], s[46:47], s85 offset:393216 glc
    s_waitcnt lgkmcnt(0)
    s_cmp_lg_u64 s[16:17], s[6:7]
    s_cbranch_scc1 L_su_lp
    s_cmp_lg_u64 s[18:19], s[6:7]
    s_cbranch_scc1 L_su_lp
    s_cmp_lg_u64 s[20:21], s[6:7]
    s_cbranch_scc1 L_su_lp
    s_cmp_lg_u64 s[22:23], s[6:7]
    s_cbranch_scc1 L_su_lp
    s_branch L_su_ok
L_shm_slow:
    s_mov_b32 s82, 0x20000
L_shm_lp:
    s_sub_u32 s82, s82, 1
    s_cbranch_scc1 L_shm_ok
    s_load_dwordx8 s[16:23], s[46:47], s92 offset:131072 glc
    s_waitcnt lgkmcnt(0)
    s_cmp_lg_u64 s[16:17], s[6:7]
    s_cbranch_scc1 L_shm_lp
    s_cmp_lg_u64 s[18:19], s[6:7]
    s_cbranch_scc1 L_shm_lp
    s_cmp_lg_u64 s[20:21], s[6:7]
    s_cbranch_scc1 L_shm_lp
    s_cmp_lg_u64 s[22:23], s[6:7]
    s_cbranch_scc1 L_shm_lp
    s_branch L_shm_ok
L_shw_slow:
    s_mov_b32 s82, 0x20000
L_shw_lp:
    s_sub_u32 s82, s82, 1
    s_cbranch_scc1 L_shw_ok
    s_load_dwordx8 s[16:23], s[46:47], s92 offset:131072 glc
    s_waitcnt lgkmcnt(0)
    s_cmp_lg_u64 s[16:17], s[6:7]
    s_cbranch_scc1 L_shw_lp
    s_cmp_lg_u64 s[18:19], s[6:7]
    s_cbranch_scc1 L_shw_lp
    s_cmp_lg_u64 s[20:21], s[6:7]
    s_cbranch_scc1 L_shw_lp
    s_cmp_lg_u64 s[22:23], s[6:7]
    s_cbranch_scc1 L_shw_lp
    s_branch L_shw_ok
L_sa_slow:
    s_mov_b32 s82, 0x20000
L_sa_lp:
    s_sub_u32 s82, s82, 1
    s_cbranch_scc1 L_sa_ok
    s_load_dwordx8 s[16:23], s[46:47], s86 offset:262144 glc
    s_waitcnt lgkmcnt(0)
    s_cmp_lg_u64 s[16:17], s[6:7]
    s_cbranch_scc1 L_sa_lp
    s_cmp_lg_u64 s[18:19], s[6:7]
    s_cbranch_scc1 L_sa_lp
    s_cmp_lg_u64 s[20:21], s[6:7]
    s_cbranch_scc1 L_sa_lp
    s_cmp_lg_u64 s[22:23], s[6:7]
    s_cbranch_scc1 L_sa_lp
    s_branch L_sa_ok
L_codeend:
.p2align 12, 0
.type L_stab,@object
L_stab:
.long 5242880,5246976,5251072,0,0,393216,0,1,5242880,524288,0,384,512,131072,0,262144
.long 528384,0,0,8388608,1048704,1052928,1057152,16777216,0,4294901760,16826368,16875520,16924672,16777216,771,0
.long 5246976,5246976,5251072,20480,8,393216,4096,1,5324800,524352,7168,384,20992,131076,0,266240
.long 528448,128,128,8450048,1049728,1053952,1058176,16778752,128,4294901760,16887808,16936960,16789504,16838656,771,0
.long 5251072,5246976,5251072,40960,16,393216,8192,1,5406720,524416,14336,384,41472,131584,0,270336
.long 528512,0,256,8511488,1050752,1054976,1059200,16973824,256,4294901760,16949248,16801792,16850944,16900096,771,0
.long 5242880,5246976,5251072,61440,24,393216,12288,1,5488640,524480,21504,384,61952,131588,0,274432
.long 528576,128,384,8572928,1051776,1056000,1060224,16975360,384,4294901760,16814080,16863232,16912384,16961536,771,0
.long 5263360,5267456,5271552,640,32,393216,65536,0,6553600,524288,0,512,1152,131328,0,262152
.long 528384,0,65536,9371648,1069824,1074048,1078272,16801792,65536,4294901760,16826368,16875520,16924672,16777216,3,0
.long 5267456,5267456,5271552,21120,40,393216,69632,0,6635520,524352,7168,512,21632,131332,0,266248
.long 528448,128,65664,9433088,1070848,1075072,1079296,16803328,65664,4294901760,16887808,16936960,16789504,16838656,3,0
.long 5271552,5267456,5271552,41600,48,393216,73728,0,6717440,524416,14336,512,42112,131840,0,270344
.long 528512,0,65792,9494528,1071872,1076096,1080320,16998400,65792,4294901760,16949248,16801792,16850944,16900096,3,0
.long 5263360,5267456,5271552,62080,56,393216,77824,0,6799360,524480,21504,512,62592,131844,0,274440
.long 528576,128,65920,9555968,1072896,1077120,1081344,16999936,65920,4294901760,16814080,16863232,16912384,16961536,3,0
.long 5283840,5287936,5292032,655360,32,393232,128,1,5243904,544768,0,512,655872,135168,0,262160
.long 548864,2048,4096,8388608,1090944,1095168,1099392,18350080,4096,4294901760,18399232,18448384,18497536,18350080,771,0
.long 5287936,5287936,5292032,675840,40,393232,4224,1,5325824,544832,7168,512,676352,135172,0,266256
.long 548928,2176,4224,8450048,1091968,1096192,1100416,18351616,4224,4294901760,18460672,18509824,18362368,18411520,771,0
.long 5292032,5287936,5292032,696320,48,393232,8320,1,5407744,544896,14336,512,696832,135680,0,270352
.long 548992,2048,4352,8511488,1092992,1097216,1101440,18546688,4352,4294901760,18522112,18374656,18423808,18472960,771,0
.long 5283840,5287936,5292032,716800,56,393232,12416,1,5489664,544960,21504,512,717312,135684,0,274448
.long 549056,2176,4480,8572928,1094016,1098240,1102464,18548224,4480,4294901760,18386944,18436096,18485248,18534400,771,0
.long 5304320,5308416,5312512,656000,64,393232,65664,0,6554624,544768,0,640,656512,135424,0,262168
.long 548864,2048,69632,9371648,1112064,1116288,1120512,18374656,69632,4294901760,18399232,18448384,18497536,18350080,3,0
.long 5308416,5308416,5312512,676480,72,393232,69760,0,6636544,544832,7168,640,676992,135428,0,266264
.long 548928,2176,69760,9433088,1113088,1117312,1121536,18376192,69760,4294901760,18460672,18509824,18362368,18411520,3,0
.long 5312512,5308416,5312512,696960,80,393232,73856,0,6718464,544896,14336,640,697472,135936,0,270360
.long 548992,2048,69888,9494528,1114112,1118336,1122560,18571264,69888,4294901760,18522112,18374656,18423808,18472960,3,0
.long 5304320,5308416,5312512,717440,88,393232,77952,0,6800384,544960,21504,640,717952,135940,0,274456
.long 549056,2176,70016,9555968,1115136,1119360,1123584,18572800,70016,4294901760,18386944,18436096,18485248,18534400,3,0
.long 5324800,5328896,5332992,1310720,64,393344,256,1,5244928,565248,0,640,1311232,139264,0,262272
.long 569344,4096,8192,8388608,1133184,1137408,1141632,19922944,8192,4294901760,19972096,20021248,20070400,19922944,771,0
.long 5328896,5328896,5332992,1331200,72,393344,4352,1,5326848,565312,7168,640,1331712,139268,0,266368
.long 569408,4224,8320,8450048,1134208,1138432,1142656,19924480,8320,4294901760,20033536,20082688,19935232,19984384,771,0
.long 5332992,5328896,5332992,1351680,80,393344,8448,1,5408768,565376,14336,640,1352192,139776,0,270464
.long 569472,4096,8448,8511488,1135232,1139456,1143680,20119552,8448,4294901760,20094976,19947520,19996672,20045824,771,0
.long 5324800,5328896,5332992,1372160,88,393344,12544,1,5490688,565440,21504,640,1372672,139780,0,274560
.long 569536,4224,8576,8572928,1136256,1140480,1144704,20121088,8576,4294901760,19959808,20008960,20058112,20107264,771,0
.long 5345280,5349376,5353472,1311360,96,393344,65792,0,6555648,565248,0,768,1311872,139520,0,262280
.long 569344,4096,73728,9371648,1154304,1158528,1162752,19947520,73728,4294901760,19972096,20021248,20070400,19922944,3,0
.long 5349376,5349376,5353472,1331840,104,393344,69888,0,6637568,565312,7168,768,1332352,139524,0,266376
.long 569408,4224,73856,9433088,1155328,1159552,1163776,19949056,73856,4294901760,20033536,20082688,19935232,19984384,3,0
.long 5353472,5349376,5353472,1352320,112,393344,73984,0,6719488,565376,14336,768,1352832,140032,0,270472
.long 569472,4096,73984,9494528,1156352,1160576,1164800,20144128,73984,4294901760,20094976,19947520,19996672,20045824,3,0
.long 5345280,5349376,5353472,1372800,120,393344,78080,0,6801408,565440,21504,768,1373312,140036,0,274568
.long 569536,4224,74112,9555968,1157376,1161600,1165824,20145664,74112,4294901760,19959808,20008960,20058112,20107264,3,0
.long 5365760,5369856,5373952,1966080,96,393360,384,1,5245952,585728,0,768,1966592,143360,0,262288
.long 589824,6144,12288,8388608,1175424,1179648,1183872,21495808,12288,4294901760,21544960,21594112,21643264,21495808,771,0
.long 5369856,5369856,5373952,1986560,104,393360,4480,1,5327872,585792,7168,768,1987072,143364,0,266384
.long 589888,6272,12416,8450048,1176448,1180672,1184896,21497344,12416,4294901760,21606400,21655552,21508096,21557248,771,0
.long 5373952,5369856,5373952,2007040,112,393360,8576,1,5409792,585856,14336,768,2007552,143872,0,270480
.long 589952,6144,12544,8511488,1177472,1181696,1185920,21692416,12544,4294901760,21667840,21520384,21569536,21618688,771,0
.long 5365760,5369856,5373952,2027520,120,393360,12672,1,5491712,585920,21504,768,2028032,143876,0,274576
.long 590016,6272,12672,8572928,1178496,1182720,1186944,21693952,12672,4294901760,21532672,21581824,21630976,21680128,771,0
.long 5386240,5390336,5394432,1966720,24,393616,65920,0,6556672,585728,0,896,1967232,143616,0,262296
.long 589824,6144,77824,9371648,1196544,1200768,1204992,21520384,77824,4294901760,21544960,21594112,21643264,21495808,3,0
.long 5390336,5390336,5394432,1987200,56,393616,70016,0,6638592,585792,7168,896,1987712,143620,0,266392
.long 589888,6272,77952,9433088,1197568,1201792,1206016,21521920,77952,4294901760,21606400,21655552,21508096,21557248,3,0
.long 5394432,5390336,5394432,2007680,88,393616,74112,0,6720512,585856,14336,896,2008192,144128,0,270488
.long 589952,6144,78080,9494528,1198592,1202816,1207040,21716992,78080,4294901760,21667840,21520384,21569536,21618688,3,0
.long 5386240,5390336,5394432,2028160,120,393616,78208,0,6802432,585920,21504,896,2028672,144132,0,274584
.long 590016,6272,78208,9555968,1199616,1203840,1208064,21718528,78208,4294901760,21532672,21581824,21630976,21680128,3,0
.long 5255168,5259264,83918848,128,32,393216,16384,1,5570560,524288,0,512,544,131080,0,262148
.long 528384,0,16384,8634368,1061376,1065600,83886080,16780288,0,4294901760,16826368,16875520,16924672,16777216,771,0
.long 5259264,5259264,83918848,20608,40,393216,20480,1,5652480,524352,7168,512,21024,131084,0,266244
.long 528448,128,16512,8695808,1062400,1066624,83886080,16781824,128,4294901760,16887808,16936960,16789504,16838656,771,0
.long 83918848,5259264,83918848,41088,48,393216,24576,1,5734400,524416,14336,512,41504,131592,0,270340
.long 528512,0,16640,8757248,1063424,1067648,83886080,16976896,256,4294901760,16949248,16801792,16850944,16900096,771,0
.long 5255168,5259264,83918848,61568,56,393216,28672,1,5816320,524480,21504,512,61984,131596,0,274436
.long 528576,128,16768,8818688,1064448,1068672,83886080,16978432,384,4294901760,16814080,16863232,16912384,16961536,771,0
.long 5275648,5279744,83922944,768,64,393216,81920,0,6881280,524288,0,640,1184,131336,0,262156
.long 528384,0,81920,9617408,1082496,1086720,83886080,16804864,65536,4294901760,16826368,16875520,16924672,16777216,3,0
.long 5279744,5279744,83922944,21248,72,393216,86016,0,6963200,524352,7168,640,21664,131340,0,266252
.long 528448,128,82048,9678848,1083520,1087744,83886080,16806400,65664,4294901760,16887808,16936960,16789504,16838656,3,0
.long 83922944,5279744,83922944,41728,80,393216,90112,0,7045120,524416,14336,640,42144,131848,0,270348
.long 528512,0,82176,9740288,1084544,1088768,83886080,17001472,65792,4294901760,16949248,16801792,16850944,16900096,3,0
.long 5275648,5279744,83922944,62208,88,393216,94208,0,7127040,524480,21504,640,62624,131852,0,274444
.long 528576,128,82304,9801728,1085568,1089792,83886080,17003008,65920,4294901760,16814080,16863232,16912384,16961536,3,0
.long 5296128,5300224,83927040,655488,64,393232,16512,1,5571584,544768,0,640,655904,135176,0,262164
.long 548864,2048,20480,8634368,1103616,1107840,83886080,18353152,4096,4294901760,18399232,18448384,18497536,18350080,771,0
.long 5300224,5300224,83927040,675968,72,393232,20608,1,5653504,544832,7168,640,676384,135180,0,266260
.long 548928,2176,20608,8695808,1104640,1108864,83886080,18354688,4224,4294901760,18460672,18509824,18362368,18411520,771,0
.long 83927040,5300224,83927040,696448,80,393232,24704,1,5735424,544896,14336,640,696864,135688,0,270356
.long 548992,2048,20736,8757248,1105664,1109888,83886080,18549760,4352,4294901760,18522112,18374656,18423808,18472960,771,0
.long 5296128,5300224,83927040,716928,88,393232,28800,1,5817344,544960,21504,640,717344,135692,0,274452
.long 549056,2176,20864,8818688,1106688,1110912,83886080,18551296,4480,4294901760,18386944,18436096,18485248,18534400,771,0
.long 5316608,5320704,83931136,656128,96,393232,82048,0,6882304,544768,0,768,656544,135432,0,262172
.long 548864,2048,86016,9617408,1124736,1128960,83886080,18377728,69632,4294901760,18399232,18448384,18497536,18350080,3,0
.long 5320704,5320704,83931136,676608,104,393232,86144,0,6964224,544832,7168,768,677024,135436,0,266268
.long 548928,2176,86144,9678848,1125760,1129984,83886080,18379264,69760,4294901760,18460672,18509824,18362368,18411520,3,0
.long 83931136,5320704,83931136,697088,112,393232,90240,0,7046144,544896,14336,768,697504,135944,0,270364
.long 548992,2048,86272,9740288,1126784,1131008,83886080,18574336,69888,4294901760,18522112,18374656,18423808,18472960,3,0
.long 5316608,5320704,83931136,717568,120,393232,94336,0,7128064,544960,21504,768,717984,135948,0,274460
.long 549056,2176,86400,9801728,1127808,1132032,83886080,18575872,70016,4294901760,18386944,18436096,18485248,18534400,3,0
.long 5337088,5341184,83935232,1310848,96,393344,16640,1,5572608,565248,0,768,1311264,139272,0,262276
.long 569344,4096,24576,8634368,1145856,1150080,83886080,19926016,8192,4294901760,19972096,20021248,20070400,19922944,771,0
.long 5341184,5341184,83935232,1331328,104,393344,20736,1,5654528,565312,7168,768,1331744,139276,0,266372
.long 569408,4224,24704,8695808,1146880,1151104,83886080,19927552,8320,4294901760,20033536,20082688,19935232,19984384,771,0
.long 83935232,5341184,83935232,1351808,112,393344,24832,1,5736448,565376,14336,768,1352224,139784,0,270468
.long 569472,4096,24832,8757248,1147904,1152128,83886080,20122624,8448,4294901760,20094976,19947520,19996672,20045824,771,0
.long 5337088,5341184,83935232,1372288,120,393344,28928,1,5818368,565440,21504,768,1372704,139788,0,274564
.long 569536,4224,24960,8818688,1148928,1153152,83886080,20124160,8576,4294901760,19959808,20008960,20058112,20107264,771,0
.long 5357568,5361664,83939328,1311488,24,393600,82176,0,6883328,565248,0,896,1311904,139528,0,262284
.long 569344,4096,90112,9617408,1166976,1171200,83886080,19950592,73728,4294901760,19972096,20021248,20070400,19922944,3,0
.long 5361664,5361664,83939328,1331968,56,393600,86272,0,6965248,565312,7168,896,1332384,139532,0,266380
.long 569408,4224,90240,9678848,1168000,1172224,83886080,19952128,73856,4294901760,20033536,20082688,19935232,19984384,3,0
.long 83939328,5361664,83939328,1352448,88,393600,90368,0,7047168,565376,14336,896,1352864,140040,0,270476
.long 569472,4096,90368,9740288,1169024,1173248,83886080,20147200,73984,4294901760,20094976,19947520,19996672,20045824,3,0
.long 5357568,5361664,83939328,1372928,120,393600,94464,0,7129088,565440,21504,896,1373344,140044,0,274572
.long 569536,4224,90496,9801728,1170048,1174272,83886080,20148736,74112,4294901760,19959808,20008960,20058112,20107264,3,0
.long 5378048,5382144,83943424,1966208,24,393616,16768,1,5573632,585728,0,896,1966624,143368,0,262292
.long 589824,6144,28672,8634368,1188096,1192320,83886080,21498880,12288,4294901760,21544960,21594112,21643264,21495808,771,0
.long 5382144,5382144,83943424,1986688,56,393616,20864,1,5655552,585792,7168,896,1987104,143372,0,266388
.long 589888,6272,28800,8695808,1189120,1193344,83886080,21500416,12416,4294901760,21606400,21655552,21508096,21557248,771,0
.long 83943424,5382144,83943424,2007168,88,393616,24960,1,5737472,585856,14336,896,2007584,143880,0,270484
.long 589952,6144,28928,8757248,1190144,1194368,83886080,21695488,12544,4294901760,21667840,21520384,21569536,21618688,771,0
.long 5378048,5382144,83943424,2027648,120,393616,29056,1,5819392,585920,21504,896,2028064,143884,0,274580
.long 590016,6272,29056,8818688,1191168,1195392,83886080,21697024,12672,4294901760,21532672,21581824,21630976,21680128,771,0
.long 5398528,5402624,83947520,1966848,128,393360,82304,0,6884352,585728,0,1024,1967264,143624,0,262300
.long 589824,6144,94208,9617408,1209216,1213440,83886080,21523456,77824,4294901760,21544960,21594112,21643264,21495808,3,0
.long 5402624,5402624,83947520,1987328,136,393360,86400,0,6966272,585792,7168,1024,1987744,143628,0,266396
.long 589888,6272,94336,9678848,1210240,1214464,83886080,21524992,77952,4294901760,21606400,21655552,21508096,21557248,3,0
.long 83947520,5402624,83947520,2007808,144,393360,90496,0,7048192,585856,14336,1024,2008224,144136,0,270492
.long 589952,6144,94464,9740288,1211264,1215488,83886080,21720064,78080,4294901760,21667840,21520384,21569536,21618688,3,0
.long 5398528,5402624,83947520,2028288,152,393360,94592,0,7130112,585920,21504,1024,2028704,144140,0,274588
.long 590016,6272,94592,9801728,1212288,1216512,83886080,21721600,78208,4294901760,21532672,21581824,21630976,21680128,3,0
.long 5406720,5410816,5414912,256,64,393216,32768,1,5898240,524288,0,640,576,131088,0,262400
.long 528384,8192,32768,8880128,1217664,1221888,1226112,16783360,0,4294901760,16826368,16875520,16924672,16777216,771,0
.long 5410816,5410816,5414912,20736,72,393216,36864,1,5980160,524352,7168,640,21056,131092,0,266496
.long 528448,8320,32896,8941568,1218688,1222912,1227136,16784896,128,4294901760,16887808,16936960,16789504,16838656,771,0
.long 5414912,5410816,5414912,41216,80,393216,40960,1,6062080,524416,14336,640,41536,131600,0,270592
.long 528512,8192,33024,9003008,1219712,1223936,1228160,16979968,256,4294901760,16949248,16801792,16850944,16900096,771,0
.long 5406720,5410816,5414912,61696,88,393216,45056,1,6144000,524480,21504,640,62016,131604,0,274688
.long 528576,8320,33152,9064448,1220736,1224960,1229184,16981504,384,4294901760,16814080,16863232,16912384,16961536,771,0
.long 5427200,5431296,5435392,896,96,393216,98304,0,7208960,524288,0,768,1216,131344,0,262408
.long 528384,8192,98304,9863168,1238784,1243008,1247232,16807936,65536,4294901760,16826368,16875520,16924672,16777216,3,0
.long 5431296,5431296,5435392,21376,104,393216,102400,0,7290880,524352,7168,768,21696,131348,0,266504
.long 528448,8320,98432,9924608,1239808,1244032,1248256,16809472,65664,4294901760,16887808,16936960,16789504,16838656,3,0
.long 5435392,5431296,5435392,41856,112,393216,106496,0,7372800,524416,14336,768,42176,131856,0,270600
.long 528512,8192,98560,9986048,1240832,1245056,1249280,17004544,65792,4294901760,16949248,16801792,16850944,16900096,3,0
.long 5427200,5431296,5435392,62336,120,393216,110592,0,7454720,524480,21504,768,62656,131860,0,274696
.long 528576,8320,98688,10047488,1241856,1246080,1250304,17006080,65920,4294901760,16814080,16863232,16912384,16961536,3,0
.long 5447680,5451776,5455872,655616,96,393232,32896,1,5899264,544768,0,768,655936,135184,0,262416
.long 548864,10240,36864,8880128,1259904,1264128,1268352,18356224,4096,4294901760,18399232,18448384,18497536,18350080,771,0
.long 5451776,5451776,5455872,676096,104,393232,36992,1,5981184,544832,7168,768,676416,135188,0,266512
.long 548928,10368,36992,8941568,1260928,1265152,1269376,18357760,4224,4294901760,18460672,18509824,18362368,18411520,771,0
.long 5455872,5451776,5455872,696576,112,393232,41088,1,6063104,544896,14336,768,696896,135696,0,270608
.long 548992,10240,37120,9003008,1261952,1266176,1270400,18552832,4352,4294901760,18522112,18374656,18423808,18472960,771,0
.long 5447680,5451776,5455872,717056,120,393232,45184,1,6145024,544960,21504,768,717376,135700,0,274704
.long 549056,10368,37248,9064448,1262976,1267200,1271424,18554368,4480,4294901760,18386944,18436096,18485248,18534400,771,0
.long 5468160,5472256,5476352,656256,24,393488,98432,0,7209984,544768,0,896,656576,135440,0,262424
.long 548864,10240,102400,9863168,1281024,1285248,1289472,18380800,69632,4294901760,18399232,18448384,18497536,18350080,3,0
.long 5472256,5472256,5476352,676736,56,393488,102528,0,7291904,544832,7168,896,677056,135444,0,266520
.long 548928,10368,102528,9924608,1282048,1286272,1290496,18382336,69760,4294901760,18460672,18509824,18362368,18411520,3,0
.long 5476352,5472256,5476352,697216,88,393488,106624,0,7373824,544896,14336,896,697536,135952,0,270616
.long 548992,10240,102656,9986048,1283072,1287296,1291520,18577408,69888,4294901760,18522112,18374656,18423808,18472960,3,0
.long 5468160,5472256,5476352,717696,120,393488,110720,0,7455744,544960,21504,896,718016,135956,0,274712
.long 549056,10368,102784,10047488,1284096,1288320,1292544,18578944,70016,4294901760,18386944,18436096,18485248,18534400,3,0
.long 5488640,5492736,5496832,1310976,24,393600,33024,1,5900288,565248,0,896,1311296,139280,0,262528
.long 569344,12288,40960,8880128,1302144,1306368,1310592,19929088,8192,4294901760,19972096,20021248,20070400,19922944,771,0
.long 5492736,5492736,5496832,1331456,56,393600,37120,1,5982208,565312,7168,896,1331776,139284,0,266624
.long 569408,12416,41088,8941568,1303168,1307392,1311616,19930624,8320,4294901760,20033536,20082688,19935232,19984384,771,0
.long 5496832,5492736,5496832,1351936,88,393600,41216,1,6064128,565376,14336,896,1352256,139792,0,270720
.long 569472,12288,41216,9003008,1304192,1308416,1312640,20125696,8448,4294901760,20094976,19947520,19996672,20045824,771,0
.long 5488640,5492736,5496832,1372416,120,393600,45312,1,6146048,565440,21504,896,1372736,139796,0,274816
.long 569536,12416,41344,9064448,1305216,1309440,1313664,20127232,8576,4294901760,19959808,20008960,20058112,20107264,771,0
.long 5509120,5513216,5517312,1311616,128,393344,98560,0,7211008,565248,0,1024,1311936,139536,0,262536
.long 569344,12544,106496,9863168,2134272,2138496,2142720,19953664,73728,4294901760,19972096,20021248,20070400,19922944,3,0
.long 5513216,5513216,5517312,1332096,136,393344,102656,0,7292928,565312,7168,1024,1332416,139540,0,266632
.long 569408,12672,106624,9924608,2135296,2139520,2143744,19955200,73856,4294901760,20033536,20082688,19935232,19984384,3,0
.long 5517312,5513216,5517312,1352576,144,393344,106752,0,7374848,565376,14336,1024,1352896,140048,0,270728
.long 569472,12544,106752,9986048,2136320,2140544,2144768,20150272,73984,4294901760,20094976,19947520,19996672,20045824,3,0
.long 5509120,5513216,5517312,1373056,152,393344,110848,0,7456768,565440,21504,1024,1373376,140052,0,274824
.long 569536,12672,106880,10047488,2137344,2141568,2145792,20151808,74112,4294901760,19959808,20008960,20058112,20107264,3,0
.long 5529600,5533696,5537792,1966336,128,393360,33152,1,5901312,585728,0,1024,1966656,143376,0,262544
.long 589824,14592,45056,8880128,2155392,2159616,2163840,21501952,12288,4294901760,21544960,21594112,21643264,21495808,771,0
.long 5533696,5533696,5537792,1986816,136,393360,37248,1,5983232,585792,7168,1024,1987136,143380,0,266640
.long 589888,14720,45184,8941568,2156416,2160640,2164864,21503488,12416,4294901760,21606400,21655552,21508096,21557248,771,0
.long 5537792,5533696,5537792,2007296,144,393360,41344,1,6065152,585856,14336,1024,2007616,143888,0,270736
.long 589952,14592,45312,9003008,2157440,2161664,2165888,21698560,12544,4294901760,21667840,21520384,21569536,21618688,771,0
.long 5529600,5533696,5537792,2027776,152,393360,45440,1,6147072,585920,21504,1024,2028096,143892,0,274832
.long 590016,14720,45440,9064448,2158464,2162688,2166912,21700096,12672,4294901760,21532672,21581824,21630976,21680128,771,0
.long 5550080,5554176,5558272,1966976,160,393360,98688,0,7212032,585728,0,1152,1967296,143632,0,262552
.long 589824,14592,110592,9863168,2176512,2180736,2184960,21526528,77824,4294901760,21544960,21594112,21643264,21495808,3,0
.long 5554176,5554176,5558272,1987456,168,393360,102784,0,7293952,585792,7168,1152,1987776,143636,0,266648
.long 589888,14720,110720,9924608,2177536,2181760,2185984,21528064,77952,4294901760,21606400,21655552,21508096,21557248,3,0
.long 5558272,5554176,5558272,2007936,176,393360,106880,0,7375872,585856,14336,1152,2008256,144144,0,270744
.long 589952,14592,110848,9986048,2178560,2182784,2187008,21723136,78080,4294901760,21667840,21520384,21569536,21618688,3,0
.long 5550080,5554176,5558272,2028416,184,393360,110976,0,7457792,585920,21504,1152,2028736,144148,0,274840
.long 590016,14720,110976,10047488,2179584,2183808,2188032,21724672,78208,4294901760,21532672,21581824,21630976,21680128,3,0
.long 5419008,5423104,83984384,384,96,393216,49152,1,6225920,524288,0,768,608,131096,0,262404
.long 528384,8192,49152,9125888,1230336,1234560,83886080,16786432,0,4294901760,16826368,16875520,16924672,16777216,771,0
.long 5423104,5423104,83984384,20864,104,393216,53248,1,6307840,524352,7168,768,21088,131100,0,266500
.long 528448,8320,49280,9187328,1231360,1235584,83886080,16787968,128,4294901760,16887808,16936960,16789504,16838656,771,0
.long 83984384,5423104,83984384,41344,112,393216,57344,1,6389760,524416,14336,768,41568,131608,0,270596
.long 528512,8192,49408,9248768,1232384,1236608,83886080,16983040,256,4294901760,16949248,16801792,16850944,16900096,771,0
.long 5419008,5423104,83984384,61824,120,393216,61440,1,6471680,524480,21504,768,62048,131612,0,274692
.long 528576,8320,49536,9310208,1233408,1237632,83886080,16984576,384,4294901760,16814080,16863232,16912384,16961536,771,0
.long 5439488,5443584,83988480,1024,24,393472,114688,1,7536640,524288,0,896,1248,131352,0,262412
.long 528384,8192,114688,10108928,1251456,1255680,83886080,16811008,65536,4294901760,16826368,16875520,16924672,16777216,771,0
.long 5443584,5443584,83988480,21504,56,393472,118784,1,7618560,524352,7168,896,21728,131356,0,266508
.long 528448,8320,114816,10170368,1252480,1256704,83886080,16812544,65664,4294901760,16887808,16936960,16789504,16838656,771,0
.long 83988480,5443584,83988480,41984,88,393472,122880,1,7700480,524416,14336,896,42208,131864,0,270604
.long 528512,8192,114944,10231808,1253504,1257728,83886080,17007616,65792,4294901760,16949248,16801792,16850944,16900096,771,0
.long 5439488,5443584,83988480,62464,120,393472,126976,1,7782400,524480,21504,896,62688,131868,0,274700
.long 528576,8320,115072,10293248,1254528,1258752,83886080,17009152,65920,4294901760,16814080,16863232,16912384,16961536,771,0
.long 5459968,5464064,83992576,655744,24,393488,49280,1,6226944,544768,0,896,655968,135192,0,262420
.long 548864,10240,53248,9125888,1272576,1276800,83886080,18359296,4096,4294901760,18399232,18448384,18497536,18350080,771,0
.long 5464064,5464064,83992576,676224,56,393488,53376,1,6308864,544832,7168,896,676448,135196,0,266516
.long 548928,10368,53376,9187328,1273600,1277824,83886080,18360832,4224,4294901760,18460672,18509824,18362368,18411520,771,0
.long 83992576,5464064,83992576,696704,88,393488,57472,1,6390784,544896,14336,896,696928,135704,0,270612
.long 548992,10240,53504,9248768,1274624,1278848,83886080,18555904,4352,4294901760,18522112,18374656,18423808,18472960,771,0
.long 5459968,5464064,83992576,717184,120,393488,61568,1,6472704,544960,21504,896,717408,135708,0,274708
.long 549056,10368,53632,9310208,1275648,1279872,83886080,18557440,4480,4294901760,18386944,18436096,18485248,18534400,771,0
.long 5480448,5484544,83996672,656384,128,393232,114816,1,7537664,544768,0,1024,656608,135448,0,262428
.long 548864,10240,118784,10108928,1293696,1297920,83886080,18383872,69632,4294901760,18399232,18448384,18497536,18350080,771,0
.long 5484544,5484544,83996672,676864,136,393232,118912,1,7619584,544832,7168,1024,677088,135452,0,266524
.long 548928,10368,118912,10170368,1294720,1298944,83886080,18385408,69760,4294901760,18460672,18509824,18362368,18411520,771,0
.long 83996672,5484544,83996672,697344,144,393232,123008,1,7701504,544896,14336,1024,697568,135960,0,270620
.long 548992,10240,119040,10231808,1295744,1299968,83886080,18580480,69888,4294901760,18522112,18374656,18423808,18472960,771,0
.long 5480448,5484544,83996672,717824,152,393232,127104,1,7783424,544960,21504,1024,718048,135964,0,274716
.long 549056,10368,119168,10293248,1296768,1300992,83886080,18582016,70016,4294901760,18386944,18436096,18485248,18534400,771,0
.long 5500928,5505024,84000768,1311104,128,393344,49408,1,6227968,565248,0,1024,1311328,139288,0,262532
.long 569344,12288,57344,9125888,1314816,2130048,83886080,19932160,8192,4294901760,19972096,20021248,20070400,19922944,771,0
.long 5505024,5505024,84000768,1331584,136,393344,53504,1,6309888,565312,7168,1024,1331808,139292,0,266628
.long 569408,12416,57472,9187328,1315840,2131072,83886080,19933696,8320,4294901760,20033536,20082688,19935232,19984384,771,0
.long 84000768,5505024,84000768,1352064,144,393344,57600,1,6391808,565376,14336,1024,1352288,139800,0,270724
.long 569472,12544,57600,9248768,1316864,2132096,83886080,20128768,8448,4294901760,20094976,19947520,19996672,20045824,771,0
.long 5500928,5505024,84000768,1372544,152,393344,61696,1,6473728,565440,21504,1024,1372768,139804,0,274820
.long 569536,12672,57728,9310208,1317888,2133120,83886080,20130304,8576,4294901760,19959808,20008960,20058112,20107264,771,0
.long 5521408,5525504,84004864,1311744,160,393344,114944,1,7538688,565248,0,1152,1311968,139544,0,262540
.long 569344,12544,122880,10108928,2146944,2151168,83886080,19956736,73728,4294901760,19972096,20021248,20070400,19922944,771,0
.long 5525504,5525504,84004864,1332224,168,393344,119040,1,7620608,565312,7168,1152,1332448,139548,0,266636
.long 569408,12672,123008,10170368,2147968,2152192,83886080,19958272,73856,4294901760,20033536,20082688,19935232,19984384,771,0
.long 84004864,5525504,84004864,1352704,176,393344,123136,1,7702528,565376,14336,1152,1352928,140056,0,270732
.long 569472,12544,123136,10231808,2148992,2153216,83886080,20153344,73984,4294901760,20094976,19947520,19996672,20045824,771,0
.long 5521408,5525504,84004864,1373184,184,393344,127232,1,7784448,565440,21504,1152,1373408,140060,0,274828
.long 569536,12672,123264,10293248,2150016,2154240,83886080,20154880,74112,4294901760,19959808,20008960,20058112,20107264,771,0
.long 5541888,5545984,84008960,1966464,160,393360,49536,1,6228992,585728,0,1152,1966688,143384,0,262548
.long 589824,14592,61440,9125888,2168064,2172288,83886080,21505024,12288,4294901760,21544960,21594112,21643264,21495808,771,0
.long 5545984,5545984,84008960,1986944,168,393360,53632,1,6310912,585792,7168,1152,1987168,143388,0,266644
.long 589888,14720,61568,9187328,2169088,2173312,83886080,21506560,12416,4294901760,21606400,21655552,21508096,21557248,771,0
.long 84008960,5545984,84008960,2007424,176,393360,57728,1,6392832,585856,14336,1152,2007648,143896,0,270740
.long 589952,14592,61696,9248768,2170112,2174336,83886080,21701632,12544,4294901760,21667840,21520384,21569536,21618688,771,0
.long 5541888,5545984,84008960,2027904,184,393360,61824,1,6474752,585920,21504,1152,2028128,143900,0,274836
.long 590016,14720,61824,9310208,2171136,2175360,83886080,21703168,12672,4294901760,21532672,21581824,21630976,21680128,771,0
.long 5562368,5566464,84013056,1967104,192,393360,115072,1,7539712,585728,0,0,1967328,143640,0,262556
.long 589824,14592,126976,10108928,2189184,2193408,83886080,21529600,77824,4294901760,21544960,21594112,21643264,21495808,771,0
.long 5566464,5566464,84013056,1987584,200,393360,119168,1,7621632,585792,7168,0,1987808,143644,0,266652
.long 589888,14720,127104,10170368,2190208,2194432,83886080,21531136,77952,4294901760,21606400,21655552,21508096,21557248,771,0
.long 84013056,5566464,84013056,2008064,208,393360,123264,1,7703552,585856,14336,0,2008288,144152,0,270748
.long 589952,14592,127232,10231808,2191232,2195456,83886080,21726208,78080,4294901760,21667840,21520384,21569536,21618688,771,0
.long 5562368,5566464,84013056,2028544,216,393360,127360,1,7785472,585920,21504,0,2028768,144156,0,274844
.long 590016,14720,127360,10293248,2192256,2196480,83886080,21727744,78208,4294901760,21532672,21581824,21630976,21680128,771,0
.long 5570560,5574656,5578752,81920,128,393216,4,1,5243008,524544,0,1024,82432,131200,0,278528
.long 528640,16384,0,8388608,1319040,1323264,1327488,16789504,512,4294901760,17022976,17072128,17121280,16973824,771,0
.long 5574656,5574656,5578752,102400,136,393216,4100,1,5324928,524608,7168,1024,102912,131204,0,282624
.long 528704,16512,128,8450048,1320064,1324288,1328512,16791040,640,4294901760,17084416,17133568,16986112,17035264,771,0
.long 5578752,5574656,5578752,122880,144,393216,8196,1,5406848,524672,14336,1024,123392,131712,0,286720
.long 528768,16384,256,8511488,1321088,1325312,1329536,16986112,768,4294901760,17145856,16998400,17047552,17096704,771,0
.long 5570560,5574656,5578752,143360,152,393216,12292,1,5488768,524736,21504,1024,143872,131716,0,290816
.long 528832,16512,384,8572928,1322112,1326336,1330560,16987648,896,4294901760,17010688,17059840,17108992,17158144,771,0
.long 5591040,5595136,5599232,82560,160,393216,65540,0,6553728,524544,0,1152,83072,131456,0,278536
.long 528640,16384,65536,9371648,1340160,1344384,1348608,16814080,66048,4294901760,17022976,17072128,17121280,16973824,3,0
.long 5595136,5595136,5599232,103040,168,393216,69636,0,6635648,524608,7168,1152,103552,131460,0,282632
.long 528704,16512,65664,9433088,1341184,1345408,1349632,16815616,66176,4294901760,17084416,17133568,16986112,17035264,3,0
.long 5599232,5595136,5599232,123520,176,393216,73732,0,6717568,524672,14336,1152,124032,131968,0,286728
.long 528768,16384,65792,9494528,1342208,1346432,1350656,17010688,66304,4294901760,17145856,16998400,17047552,17096704,3,0
.long 5591040,5595136,5599232,144000,184,393216,77828,0,6799488,524736,21504,1152,144512,131972,0,290824
.long 528832,16512,65920,9555968,1343232,1347456,1351680,17012224,66432,4294901760,17010688,17059840,17108992,17158144,3,0
.long 5611520,5615616,5619712,737280,160,393232,132,1,5244032,545024,0,1152,737792,135296,0,278544
.long 549120,18432,4096,8388608,1361280,1365504,1369728,18362368,4608,4294901760,18595840,18644992,18694144,18546688,771,0
.long 5615616,5615616,5619712,757760,168,393232,4228,1,5325952,545088,7168,1152,758272,135300,0,282640
.long 549184,18560,4224,8450048,1362304,1366528,1370752,18363904,4736,4294901760,18657280,18706432,18558976,18608128,771,0
.long 5619712,5615616,5619712,778240,176,393232,8324,1,5407872,545152,14336,1152,778752,135808,0,286736
.long 549248,18432,4352,8511488,1363328,1367552,1371776,18558976,4864,4294901760,18718720,18571264,18620416,18669568,771,0
.long 5611520,5615616,5619712,798720,184,393232,12420,1,5489792,545216,21504,1152,799232,135812,0,290832
.long 549312,18560,4480,8572928,1364352,1368576,1372800,18560512,4992,4294901760,18583552,18632704,18681856,18731008,771,0
.long 5632000,5636096,5640192,737920,192,393232,65668,0,6554752,545024,0,0,738432,135552,0,278552
.long 549120,18432,69632,9371648,1382400,1386624,1390848,18386944,70144,4294901760,18595840,18644992,18694144,18546688,3,0
.long 5636096,5636096,5640192,758400,200,393232,69764,0,6636672,545088,7168,0,758912,135556,0,282648
.long 549184,18560,69760,9433088,1383424,1387648,1391872,18388480,70272,4294901760,18657280,18706432,18558976,18608128,3,0
.long 5640192,5636096,5640192,778880,208,393232,73860,0,6718592,545152,14336,0,779392,136064,0,286744
.long 549248,18432,69888,9494528,1384448,1388672,1392896,18583552,70400,4294901760,18718720,18571264,18620416,18669568,3,0
.long 5632000,5636096,5640192,799360,216,393232,77956,0,6800512,545216,21504,0,799872,136068,0,290840
.long 549312,18560,70016,9555968,1385472,1389696,1393920,18585088,70528,4294901760,18583552,18632704,18681856,18731008,3,0
.long 5652480,5656576,5660672,1392640,192,393344,260,1,5245056,565504,0,0,1393152,139392,0,278656
.long 569600,20480,8192,8388608,1403520,1407744,1411968,19935232,8704,4294901760,20168704,20217856,20267008,20119552,771,0
.long 5656576,5656576,5660672,1413120,200,393344,4356,1,5326976,565568,7168,0,1413632,139396,0,282752
.long 569664,20608,8320,8450048,1404544,1408768,1412992,19936768,8832,4294901760,20230144,20279296,20131840,20180992,771,0
.long 5660672,5656576,5660672,1433600,208,393344,8452,1,5408896,565632,14336,0,1434112,139904,0,286848
.long 569728,20480,8448,8511488,1405568,1409792,1414016,20131840,8960,4294901760,20291584,20144128,20193280,20242432,771,0
.long 5652480,5656576,5660672,1454080,216,393344,12548,1,5490816,565696,21504,0,1454592,139908,0,290944
.long 569792,20608,8576,8572928,1406592,1410816,1415040,20133376,9088,4294901760,20156416,20205568,20254720,20303872,771,0
.long 5672960,5677056,5681152,1393280,224,393344,65796,0,6555776,565504,0,128,1393792,139648,0,278664
.long 569600,20480,73728,9371648,1424640,1428864,1433088,19959808,74240,4294901760,20168704,20217856,20267008,20119552,3,0
.long 5677056,5677056,5681152,1413760,232,393344,69892,0,6637696,565568,7168,128,1414272,139652,0,282760
.long 569664,20608,73856,9433088,1425664,1429888,1434112,19961344,74368,4294901760,20230144,20279296,20131840,20180992,3,0
.long 5681152,5677056,5681152,1434240,240,393344,73988,0,6719616,565632,14336,128,1434752,140160,0,286856
.long 569728,20480,73984,9494528,1426688,1430912,1435136,20156416,74496,4294901760,20291584,20144128,20193280,20242432,3,0
.long 5672960,5677056,5681152,1454720,248,393344,78084,0,6801536,565696,21504,128,1455232,140164,0,290952
.long 569792,20608,74112,9555968,1427712,1431936,1436160,20157952,74624,4294901760,20156416,20205568,20254720,20303872,3,0
.long 5693440,5697536,5701632,2048000,224,393360,388,1,5246080,585984,0,128,2048512,143488,0,278672
.long 590080,22528,12288,8388608,1445760,1449984,1454208,21508096,12800,4294901760,21741568,21790720,21839872,21692416,771,0
.long 5697536,5697536,5701632,2068480,232,393360,4484,1,5328000,586048,7168,128,2068992,143492,0,282768
.long 590144,22656,12416,8450048,1446784,1451008,1455232,21509632,12928,4294901760,21803008,21852160,21704704,21753856,771,0
.long 5701632,5697536,5701632,2088960,240,393360,8580,1,5409920,586112,14336,128,2089472,144000,0,286864
.long 590208,22528,12544,8511488,1447808,1452032,1456256,21704704,13056,4294901760,21864448,21716992,21766144,21815296,771,0
.long 5693440,5697536,5701632,2109440,248,393360,12676,1,5491840,586176,21504,128,2109952,144004,0,290960
.long 590272,22656,12672,8572928,1448832,1453056,1457280,21706240,13184,4294901760,21729280,21778432,21827584,21876736,771,0
.long 5713920,5718016,5722112,2048640,152,393616,65924,0,6556800,585984,0,256,2049152,143744,0,278680
.long 590080,22528,77824,9371648,1466880,1471104,1475328,21532672,78336,4294901760,21741568,21790720,21839872,21692416,3,0
.long 5718016,5718016,5722112,2069120,184,393616,70020,0,6638720,586048,7168,256,2069632,143748,0,282776
.long 590144,22656,77952,9433088,1467904,1472128,1476352,21534208,78464,4294901760,21803008,21852160,21704704,21753856,3,0
.long 5722112,5718016,5722112,2089600,216,393616,74116,0,6720640,586112,14336,256,2090112,144256,0,286872
.long 590208,22528,78080,9494528,1468928,1473152,1477376,21729280,78592,4294901760,21864448,21716992,21766144,21815296,3,0
.long 5713920,5718016,5722112,2110080,248,393616,78212,0,6802560,586176,21504,256,2110592,144260,0,290968
.long 590272,22656,78208,9555968,1469952,1474176,1478400,21730816,78720,4294901760,21729280,21778432,21827584,21876736,3,0
.long 5582848,5586944,84049920,82048,160,393216,16388,1,5570688,524544,0,1152,82464,131208,0,278532
.long 528640,16384,16384,8634368,1331712,1335936,83886080,16792576,512,4294901760,17022976,17072128,17121280,16973824,771,0
.long 5586944,5586944,84049920,102528,168,393216,20484,1,5652608,524608,7168,1152,102944,131212,0,282628
.long 528704,16512,16512,8695808,1332736,1336960,83886080,16794112,640,4294901760,17084416,17133568,16986112,17035264,771,0
.long 84049920,5586944,84049920,123008,176,393216,24580,1,5734528,524672,14336,1152,123424,131720,0,286724
.long 528768,16384,16640,8757248,1333760,1337984,83886080,16989184,768,4294901760,17145856,16998400,17047552,17096704,771,0
.long 5582848,5586944,84049920,143488,184,393216,28676,1,5816448,524736,21504,1152,143904,131724,0,290820
.long 528832,16512,16768,8818688,1334784,1339008,83886080,16990720,896,4294901760,17010688,17059840,17108992,17158144,771,0
.long 5603328,5607424,84054016,82688,192,393216,81924,0,6881408,524544,0,0,83104,131464,0,278540
.long 528640,16384,81920,9617408,1352832,1357056,83886080,16817152,66048,4294901760,17022976,17072128,17121280,16973824,3,0
.long 5607424,5607424,84054016,103168,200,393216,86020,0,6963328,524608,7168,0,103584,131468,0,282636
.long 528704,16512,82048,9678848,1353856,1358080,83886080,16818688,66176,4294901760,17084416,17133568,16986112,17035264,3,0
.long 84054016,5607424,84054016,123648,208,393216,90116,0,7045248,524672,14336,0,124064,131976,0,286732
.long 528768,16384,82176,9740288,1354880,1359104,83886080,17013760,66304,4294901760,17145856,16998400,17047552,17096704,3,0
.long 5603328,5607424,84054016,144128,216,393216,94212,0,7127168,524736,21504,0,144544,131980,0,290828
.long 528832,16512,82304,9801728,1355904,1360128,83886080,17015296,66432,4294901760,17010688,17059840,17108992,17158144,3,0
.long 5623808,5627904,84058112,737408,192,393232,16516,1,5571712,545024,0,0,737824,135304,0,278548
.long 549120,18432,20480,8634368,1373952,1378176,83886080,18365440,4608,4294901760,18595840,18644992,18694144,18546688,771,0
.long 5627904,5627904,84058112,757888,200,393232,20612,1,5653632,545088,7168,0,758304,135308,0,282644
.long 549184,18560,20608,8695808,1374976,1379200,83886080,18366976,4736,4294901760,18657280,18706432,18558976,18608128,771,0
.long 84058112,5627904,84058112,778368,208,393232,24708,1,5735552,545152,14336,0,778784,135816,0,286740
.long 549248,18432,20736,8757248,1376000,1380224,83886080,18562048,4864,4294901760,18718720,18571264,18620416,18669568,771,0
.long 5623808,5627904,84058112,798848,216,393232,28804,1,5817472,545216,21504,0,799264,135820,0,290836
.long 549312,18560,20864,8818688,1377024,1381248,83886080,18563584,4992,4294901760,18583552,18632704,18681856,18731008,771,0
.long 5644288,5648384,84062208,738048,224,393232,82052,0,6882432,545024,0,128,738464,135560,0,278556
.long 549120,18432,86016,9617408,1395072,1399296,83886080,18390016,70144,4294901760,18595840,18644992,18694144,18546688,3,0
.long 5648384,5648384,84062208,758528,232,393232,86148,0,6964352,545088,7168,128,758944,135564,0,282652
.long 549184,18560,86144,9678848,1396096,1400320,83886080,18391552,70272,4294901760,18657280,18706432,18558976,18608128,3,0
.long 84062208,5648384,84062208,779008,240,393232,90244,0,7046272,545152,14336,128,779424,136072,0,286748
.long 549248,18432,86272,9740288,1397120,1401344,83886080,18586624,70400,4294901760,18718720,18571264,18620416,18669568,3,0
.long 5644288,5648384,84062208,799488,248,393232,94340,0,7128192,545216,21504,128,799904,136076,0,290844
.long 549312,18560,86400,9801728,1398144,1402368,83886080,18588160,70528,4294901760,18583552,18632704,18681856,18731008,3,0
.long 5664768,5668864,84066304,1392768,224,393344,16644,1,5572736,565504,0,128,1393184,139400,0,278660
.long 569600,20480,24576,8634368,1416192,1420416,83886080,19938304,8704,4294901760,20168704,20217856,20267008,20119552,771,0
.long 5668864,5668864,84066304,1413248,232,393344,20740,1,5654656,565568,7168,128,1413664,139404,0,282756
.long 569664,20608,24704,8695808,1417216,1421440,83886080,19939840,8832,4294901760,20230144,20279296,20131840,20180992,771,0
.long 84066304,5668864,84066304,1433728,240,393344,24836,1,5736576,565632,14336,128,1434144,139912,0,286852
.long 569728,20480,24832,8757248,1418240,1422464,83886080,20134912,8960,4294901760,20291584,20144128,20193280,20242432,771,0
.long 5664768,5668864,84066304,1454208,248,393344,28932,1,5818496,565696,21504,128,1454624,139916,0,290948
.long 569792,20608,24960,8818688,1419264,1423488,83886080,20136448,9088,4294901760,20156416,20205568,20254720,20303872,771,0
.long 5685248,5689344,84070400,1393408,152,393600,82180,0,6883456,565504,0,256,1393824,139656,0,278668
.long 569600,20480,90112,9617408,1437312,1441536,83886080,19962880,74240,4294901760,20168704,20217856,20267008,20119552,3,0
.long 5689344,5689344,84070400,1413888,184,393600,86276,0,6965376,565568,7168,256,1414304,139660,0,282764
.long 569664,20608,90240,9678848,1438336,1442560,83886080,19964416,74368,4294901760,20230144,20279296,20131840,20180992,3,0
.long 84070400,5689344,84070400,1434368,216,393600,90372,0,7047296,565632,14336,256,1434784,140168,0,286860
.long 569728,20480,90368,9740288,1439360,1443584,83886080,20159488,74496,4294901760,20291584,20144128,20193280,20242432,3,0
.long 5685248,5689344,84070400,1454848,248,393600,94468,0,7129216,565696,21504,256,1455264,140172,0,290956
.long 569792,20608,90496,9801728,1440384,1444608,83886080,20161024,74624,4294901760,20156416,20205568,20254720,20303872,3,0
.long 5705728,5709824,84074496,2048128,152,393616,16772,1,5573760,585984,0,256,2048544,143496,0,278676
.long 590080,22528,28672,8634368,1458432,1462656,83886080,21511168,12800,4294901760,21741568,21790720,21839872,21692416,771,0
.long 5709824,5709824,84074496,2068608,184,393616,20868,1,5655680,586048,7168,256,2069024,143500,0,282772
.long 590144,22656,28800,8695808,1459456,1463680,83886080,21512704,12928,4294901760,21803008,21852160,21704704,21753856,771,0
.long 84074496,5709824,84074496,2089088,216,393616,24964,1,5737600,586112,14336,256,2089504,144008,0,286868
.long 590208,22528,28928,8757248,1460480,1464704,83886080,21707776,13056,4294901760,21864448,21716992,21766144,21815296,771,0
.long 5705728,5709824,84074496,2109568,248,393616,29060,1,5819520,586176,21504,256,2109984,144012,0,290964
.long 590272,22656,29056,8818688,1461504,1465728,83886080,21709312,13184,4294901760,21729280,21778432,21827584,21876736,771,0
.long 5726208,5730304,84078592,2048768,0,393360,82308,0,6884480,585984,0,384,2049184,143752,0,278684
.long 590080,22528,94208,9617408,1479552,1483776,83886080,21535744,78336,4294901760,21741568,21790720,21839872,21692416,3,0
.long 5730304,5730304,84078592,2069248,8,393360,86404,0,6966400,586048,7168,384,2069664,143756,0,282780
.long 590144,22656,94336,9678848,1480576,1484800,83886080,21537280,78464,4294901760,21803008,21852160,21704704,21753856,3,0
.long 84078592,5730304,84078592,2089728,16,393360,90500,0,7048320,586112,14336,384,2090144,144264,0,286876
.long 590208,22528,94464,9740288,1481600,1485824,83886080,21732352,78592,4294901760,21864448,21716992,21766144,21815296,3,0
.long 5726208,5730304,84078592,2110208,24,393360,94596,0,7130240,586176,21504,384,2110624,144268,0,290972
.long 590272,22656,94592,9801728,1482624,1486848,83886080,21733888,78720,4294901760,21729280,21778432,21827584,21876736,3,0
.long 5734400,5738496,5742592,82176,192,393216,32772,1,5898368,524544,0,0,82496,131216,0,278784
.long 528640,24576,32768,8880128,1488000,1492224,1496448,16795648,512,4294901760,17022976,17072128,17121280,16973824,771,0
.long 5738496,5738496,5742592,102656,200,393216,36868,1,5980288,524608,7168,0,102976,131220,0,282880
.long 528704,24704,32896,8941568,1489024,1493248,1497472,16797184,640,4294901760,17084416,17133568,16986112,17035264,771,0
.long 5742592,5738496,5742592,123136,208,393216,40964,1,6062208,524672,14336,0,123456,131728,0,286976
.long 528768,24576,33024,9003008,1490048,1494272,1498496,16992256,768,4294901760,17145856,16998400,17047552,17096704,771,0
.long 5734400,5738496,5742592,143616,216,393216,45060,1,6144128,524736,21504,0,143936,131732,0,291072
.long 528832,24704,33152,9064448,1491072,1495296,1499520,16993792,896,4294901760,17010688,17059840,17108992,17158144,771,0
.long 5754880,5758976,5763072,82816,224,393216,98308,0,7209088,524544,0,128,83136,131472,0,278792
.long 528640,24576,98304,9863168,1509120,1513344,1517568,16820224,66048,4294901760,17022976,17072128,17121280,16973824,3,0
.long 5758976,5758976,5763072,103296,232,393216,102404,0,7291008,524608,7168,128,103616,131476,0,282888
.long 528704,24704,98432,9924608,1510144,1514368,1518592,16821760,66176,4294901760,17084416,17133568,16986112,17035264,3,0
.long 5763072,5758976,5763072,123776,240,393216,106500,0,7372928,524672,14336,128,124096,131984,0,286984
.long 528768,24576,98560,9986048,1511168,1515392,1519616,17016832,66304,4294901760,17145856,16998400,17047552,17096704,3,0
.long 5754880,5758976,5763072,144256,248,393216,110596,0,7454848,524736,21504,128,144576,131988,0,291080
.long 528832,24704,98688,10047488,1512192,1516416,1520640,17018368,66432,4294901760,17010688,17059840,17108992,17158144,3,0
.long 5775360,5779456,5783552,737536,224,393232,32900,1,5899392,545024,0,128,737856,135312,0,278800
.long 549120,26624,36864,8880128,1530240,1534464,1538688,18368512,4608,4294901760,18595840,18644992,18694144,18546688,771,0
.long 5779456,5779456,5783552,758016,232,393232,36996,1,5981312,545088,7168,128,758336,135316,0,282896
.long 549184,26752,36992,8941568,1531264,1535488,1539712,18370048,4736,4294901760,18657280,18706432,18558976,18608128,771,0
.long 5783552,5779456,5783552,778496,240,393232,41092,1,6063232,545152,14336,128,778816,135824,0,286992
.long 549248,26624,37120,9003008,1532288,1536512,1540736,18565120,4864,4294901760,18718720,18571264,18620416,18669568,771,0
.long 5775360,5779456,5783552,798976,248,393232,45188,1,6145152,545216,21504,128,799296,135828,0,291088
.long 549312,26752,37248,9064448,1533312,1537536,1541760,18566656,4992,4294901760,18583552,18632704,18681856,18731008,771,0
.long 5795840,5799936,5804032,738176,152,393488,98436,0,7210112,545024,0,256,738496,135568,0,278808
.long 549120,26624,102400,9863168,1551360,1555584,1559808,18393088,70144,4294901760,18595840,18644992,18694144,18546688,3,0
.long 5799936,5799936,5804032,758656,184,393488,102532,0,7292032,545088,7168,256,758976,135572,0,282904
.long 549184,26752,102528,9924608,1552384,1556608,1560832,18394624,70272,4294901760,18657280,18706432,18558976,18608128,3,0
.long 5804032,5799936,5804032,779136,216,393488,106628,0,7373952,545152,14336,256,779456,136080,0,287000
.long 549248,26624,102656,9986048,1553408,1557632,1561856,18589696,70400,4294901760,18718720,18571264,18620416,18669568,3,0
.long 5795840,5799936,5804032,799616,248,393488,110724,0,7455872,545216,21504,256,799936,136084,0,291096
.long 549312,26752,102784,10047488,1554432,1558656,1562880,18591232,70528,4294901760,18583552,18632704,18681856,18731008,3,0
.long 5816320,5820416,5824512,1392896,152,393600,33028,1,5900416,565504,0,256,1393216,139408,0,278912
.long 569600,28672,40960,8880128,1572480,1576704,1580928,19941376,8704,4294901760,20168704,20217856,20267008,20119552,771,0
.long 5820416,5820416,5824512,1413376,184,393600,37124,1,5982336,565568,7168,256,1413696,139412,0,283008
.long 569664,28800,41088,8941568,1573504,1577728,1581952,19942912,8832,4294901760,20230144,20279296,20131840,20180992,771,0
.long 5824512,5820416,5824512,1433856,216,393600,41220,1,6064256,565632,14336,256,1434176,139920,0,287104
.long 569728,28672,41216,9003008,1574528,1578752,1582976,20137984,8960,4294901760,20291584,20144128,20193280,20242432,771,0
.long 5816320,5820416,5824512,1454336,248,393600,45316,1,6146176,565696,21504,256,1454656,139924,0,291200
.long 569792,28800,41344,9064448,1575552,1579776,1584000,20139520,9088,4294901760,20156416,20205568,20254720,20303872,771,0
.long 5836800,5840896,5844992,1393536,0,393344,98564,0,7211136,565504,0,384,1393856,139664,0,278920
.long 569600,28928,106496,9863168,2201856,2206080,2210304,19965952,74240,4294901760,20168704,20217856,20267008,20119552,3,0
.long 5840896,5840896,5844992,1414016,8,393344,102660,0,7293056,565568,7168,384,1414336,139668,0,283016
.long 569664,29056,106624,9924608,2202880,2207104,2211328,19967488,74368,4294901760,20230144,20279296,20131840,20180992,3,0
.long 5844992,5840896,5844992,1434496,16,393344,106756,0,7374976,565632,14336,384,1434816,140176,0,287112
.long 569728,28928,106752,9986048,2203904,2208128,2212352,20162560,74496,4294901760,20291584,20144128,20193280,20242432,3,0
.long 5836800,5840896,5844992,1454976,24,393344,110852,0,7456896,565696,21504,384,1455296,140180,0,291208
.long 569792,29056,106880,10047488,2204928,2209152,2213376,20164096,74624,4294901760,20156416,20205568,20254720,20303872,3,0
.long 5857280,5861376,5865472,2048256,0,393360,33156,1,5901440,585984,0,384,2048576,143504,0,278928
.long 590080,30976,45056,8880128,2222976,2227200,2231424,21514240,12800,4294901760,21741568,21790720,21839872,21692416,771,0
.long 5861376,5861376,5865472,2068736,8,393360,37252,1,5983360,586048,7168,384,2069056,143508,0,283024
.long 590144,31104,45184,8941568,2224000,2228224,2232448,21515776,12928,4294901760,21803008,21852160,21704704,21753856,771,0
.long 5865472,5861376,5865472,2089216,16,393360,41348,1,6065280,586112,14336,384,2089536,144016,0,287120
.long 590208,30976,45312,9003008,2225024,2229248,2233472,21710848,13056,4294901760,21864448,21716992,21766144,21815296,771,0
.long 5857280,5861376,5865472,2109696,24,393360,45444,1,6147200,586176,21504,384,2110016,144020,0,291216
.long 590272,31104,45440,9064448,2226048,2230272,2234496,21712384,13184,4294901760,21729280,21778432,21827584,21876736,771,0
.long 5877760,5881856,5885952,2048896,32,393360,98692,0,7212160,585984,0,512,2049216,143760,0,278936
.long 590080,30976,110592,9863168,2244096,2248320,2252544,21538816,78336,4294901760,21741568,21790720,21839872,21692416,3,0
.long 5881856,5881856,5885952,2069376,40,393360,102788,0,7294080,586048,7168,512,2069696,143764,0,283032
.long 590144,31104,110720,9924608,2245120,2249344,2253568,21540352,78464,4294901760,21803008,21852160,21704704,21753856,3,0
.long 5885952,5881856,5885952,2089856,48,393360,106884,0,7376000,586112,14336,512,2090176,144272,0,287128
.long 590208,30976,110848,9986048,2246144,2250368,2254592,21735424,78592,4294901760,21864448,21716992,21766144,21815296,3,0
.long 5877760,5881856,5885952,2110336,56,393360,110980,0,7457920,586176,21504,512,2110656,144276,0,291224
.long 590272,31104,110976,10047488,2247168,2251392,2255616,21736960,78720,4294901760,21729280,21778432,21827584,21876736,3,0
.long 5746688,5750784,84115456,82304,224,393216,49156,1,6226048,524544,0,128,82528,131224,0,278788
.long 528640,24576,49152,9125888,1500672,1504896,83886080,16798720,512,4294901760,17022976,17072128,17121280,16973824,771,0
.long 5750784,5750784,84115456,102784,232,393216,53252,1,6307968,524608,7168,128,103008,131228,0,282884
.long 528704,24704,49280,9187328,1501696,1505920,83886080,16800256,640,4294901760,17084416,17133568,16986112,17035264,771,0
.long 84115456,5750784,84115456,123264,240,393216,57348,1,6389888,524672,14336,128,123488,131736,0,286980
.long 528768,24576,49408,9248768,1502720,1506944,83886080,16995328,768,4294901760,17145856,16998400,17047552,17096704,771,0
.long 5746688,5750784,84115456,143744,248,393216,61444,1,6471808,524736,21504,128,143968,131740,0,291076
.long 528832,24704,49536,9310208,1503744,1507968,83886080,16996864,896,4294901760,17010688,17059840,17108992,17158144,771,0
.long 5767168,5771264,84119552,82944,152,393472,114692,1,7536768,524544,0,256,83168,131480,0,278796
.long 528640,24576,114688,10108928,1521792,1526016,83886080,16823296,66048,4294901760,17022976,17072128,17121280,16973824,771,0
.long 5771264,5771264,84119552,103424,184,393472,118788,1,7618688,524608,7168,256,103648,131484,0,282892
.long 528704,24704,114816,10170368,1522816,1527040,83886080,16824832,66176,4294901760,17084416,17133568,16986112,17035264,771,0
.long 84119552,5771264,84119552,123904,216,393472,122884,1,7700608,524672,14336,256,124128,131992,0,286988
.long 528768,24576,114944,10231808,1523840,1528064,83886080,17019904,66304,4294901760,17145856,16998400,17047552,17096704,771,0
.long 5767168,5771264,84119552,144384,248,393472,126980,1,7782528,524736,21504,256,144608,131996,0,291084
.long 528832,24704,115072,10293248,1524864,1529088,83886080,17021440,66432,4294901760,17010688,17059840,17108992,17158144,771,0
.long 5787648,5791744,84123648,737664,152,393488,49284,1,6227072,545024,0,256,737888,135320,0,278804
.long 549120,26624,53248,9125888,1542912,1547136,83886080,18371584,4608,4294901760,18595840,18644992,18694144,18546688,771,0
.long 5791744,5791744,84123648,758144,184,393488,53380,1,6308992,545088,7168,256,758368,135324,0,282900
.long 549184,26752,53376,9187328,1543936,1548160,83886080,18373120,4736,4294901760,18657280,18706432,18558976,18608128,771,0
.long 84123648,5791744,84123648,778624,216,393488,57476,1,6390912,545152,14336,256,778848,135832,0,286996
.long 549248,26624,53504,9248768,1544960,1549184,83886080,18568192,4864,4294901760,18718720,18571264,18620416,18669568,771,0
.long 5787648,5791744,84123648,799104,248,393488,61572,1,6472832,545216,21504,256,799328,135836,0,291092
.long 549312,26752,53632,9310208,1545984,1550208,83886080,18569728,4992,4294901760,18583552,18632704,18681856,18731008,771,0
.long 5808128,5812224,84127744,738304,0,393232,114820,1,7537792,545024,0,384,738528,135576,0,278812
.long 549120,26624,118784,10108928,1564032,1568256,83886080,18396160,70144,4294901760,18595840,18644992,18694144,18546688,771,0
.long 5812224,5812224,84127744,758784,8,393232,118916,1,7619712,545088,7168,384,759008,135580,0,282908
.long 549184,26752,118912,10170368,1565056,1569280,83886080,18397696,70272,4294901760,18657280,18706432,18558976,18608128,771,0
.long 84127744,5812224,84127744,779264,16,393232,123012,1,7701632,545152,14336,384,779488,136088,0,287004
.long 549248,26624,119040,10231808,1566080,1570304,83886080,18592768,70400,4294901760,18718720,18571264,18620416,18669568,771,0
.long 5808128,5812224,84127744,799744,24,393232,127108,1,7783552,545216,21504,384,799968,136092,0,291100
.long 549312,26752,119168,10293248,1567104,1571328,83886080,18594304,70528,4294901760,18583552,18632704,18681856,18731008,771,0
.long 5828608,5832704,84131840,1393024,0,393344,49412,1,6228096,565504,0,384,1393248,139416,0,278916
.long 569600,28672,57344,9125888,1585152,2197632,83886080,19944448,8704,4294901760,20168704,20217856,20267008,20119552,771,0
.long 5832704,5832704,84131840,1413504,8,393344,53508,1,6310016,565568,7168,384,1413728,139420,0,283012
.long 569664,28800,57472,9187328,1586176,2198656,83886080,19945984,8832,4294901760,20230144,20279296,20131840,20180992,771,0
.long 84131840,5832704,84131840,1433984,16,393344,57604,1,6391936,565632,14336,384,1434208,139928,0,287108
.long 569728,28928,57600,9248768,1587200,2199680,83886080,20141056,8960,4294901760,20291584,20144128,20193280,20242432,771,0
.long 5828608,5832704,84131840,1454464,24,393344,61700,1,6473856,565696,21504,384,1454688,139932,0,291204
.long 569792,29056,57728,9310208,1588224,2200704,83886080,20142592,9088,4294901760,20156416,20205568,20254720,20303872,771,0
.long 5849088,5853184,84135936,1393664,32,393344,114948,1,7538816,565504,0,512,1393888,139672,0,278924
.long 569600,28928,122880,10108928,2214528,2218752,83886080,19969024,74240,4294901760,20168704,20217856,20267008,20119552,771,0
.long 5853184,5853184,84135936,1414144,40,393344,119044,1,7620736,565568,7168,512,1414368,139676,0,283020
.long 569664,29056,123008,10170368,2215552,2219776,83886080,19970560,74368,4294901760,20230144,20279296,20131840,20180992,771,0
.long 84135936,5853184,84135936,1434624,48,393344,123140,1,7702656,565632,14336,512,1434848,140184,0,287116
.long 569728,28928,123136,10231808,2216576,2220800,83886080,20165632,74496,4294901760,20291584,20144128,20193280,20242432,771,0
.long 5849088,5853184,84135936,1455104,56,393344,127236,1,7784576,565696,21504,512,1455328,140188,0,291212
.long 569792,29056,123264,10293248,2217600,2221824,83886080,20167168,74624,4294901760,20156416,20205568,20254720,20303872,771,0
.long 5869568,5873664,84140032,2048384,32,393360,49540,1,6229120,585984,0,512,2048608,143512,0,278932
.long 590080,30976,61440,9125888,2235648,2239872,83886080,21517312,12800,4294901760,21741568,21790720,21839872,21692416,771,0
.long 5873664,5873664,84140032,2068864,40,393360,53636,1,6311040,586048,7168,512,2069088,143516,0,283028
.long 590144,31104,61568,9187328,2236672,2240896,83886080,21518848,12928,4294901760,21803008,21852160,21704704,21753856,771,0
.long 84140032,5873664,84140032,2089344,48,393360,57732,1,6392960,586112,14336,512,2089568,144024,0,287124
.long 590208,30976,61696,9248768,2237696,2241920,83886080,21713920,13056,4294901760,21864448,21716992,21766144,21815296,771,0
.long 5869568,5873664,84140032,2109824,56,393360,61828,1,6474880,586176,21504,512,2110048,144028,0,291220
.long 590272,31104,61824,9310208,2238720,2242944,83886080,21715456,13184,4294901760,21729280,21778432,21827584,21876736,771,0
.long 5890048,5894144,84144128,2049024,64,393360,115076,1,7539840,585984,0,640,2049248,143768,0,278940
.long 590080,30976,126976,10108928,2256768,2260992,83886080,21541888,78336,4294901760,21741568,21790720,21839872,21692416,771,0
.long 5894144,5894144,84144128,2069504,72,393360,119172,1,7621760,586048,7168,640,2069728,143772,0,283036
.long 590144,31104,127104,10170368,2257792,2262016,83886080,21543424,78464,4294901760,21803008,21852160,21704704,21753856,771,0
.long 84144128,5894144,84144128,2089984,80,393360,123268,1,7703680,586112,14336,640,2090208,144280,0,287132
.long 590208,30976,127232,10231808,2258816,2263040,83886080,21738496,78592,4294901760,21864448,21716992,21766144,21815296,771,0
.long 5890048,5894144,84144128,2110464,88,393360,127364,1,7785600,586176,21504,640,2110688,144284,0,291228
.long 590272,31104,127360,10293248,2259840,2264064,83886080,21740032,78720,4294901760,21729280,21778432,21827584,21876736,771,0
.long 5898240,5902336,5906432,163840,64,393220,8,1,5243136,529408,0,640,164352,132096,0,294912
.long 533504,32768,0,8388608,1589376,1593600,1597824,17170432,1024,4294901760,17219584,17268736,17317888,17170432,771,0
.long 5902336,5902336,5906432,184320,72,393220,4104,1,5325056,529472,7168,640,184832,132100,0,299008
.long 533568,32896,128,8450048,1590400,1594624,1598848,17171968,1152,4294901760,17281024,17330176,17182720,17231872,771,0
.long 5906432,5902336,5906432,204800,80,393220,8200,1,5406976,529536,14336,640,205312,132608,0,303104
.long 533632,32768,256,8511488,1591424,1595648,1599872,17367040,1280,4294901760,17342464,17195008,17244160,17293312,771,0
.long 5898240,5902336,5906432,225280,88,393220,12296,1,5488896,529600,21504,640,225792,132612,0,307200
.long 533696,32896,384,8572928,1592448,1596672,1600896,17368576,1408,4294901760,17207296,17256448,17305600,17354752,771,0
.long 5918720,5922816,5926912,164480,96,393220,65544,0,6553856,529408,0,768,164992,132352,0,294920
.long 533504,32768,65536,9371648,1610496,1614720,1618944,17195008,66560,4294901760,17219584,17268736,17317888,17170432,3,0
.long 5922816,5922816,5926912,184960,104,393220,69640,0,6635776,529472,7168,768,185472,132356,0,299016
.long 533568,32896,65664,9433088,1611520,1615744,1619968,17196544,66688,4294901760,17281024,17330176,17182720,17231872,3,0
.long 5926912,5922816,5926912,205440,112,393220,73736,0,6717696,529536,14336,768,205952,132864,0,303112
.long 533632,32768,65792,9494528,1612544,1616768,1620992,17391616,66816,4294901760,17342464,17195008,17244160,17293312,3,0
.long 5918720,5922816,5926912,225920,120,393220,77832,0,6799616,529600,21504,768,226432,132868,0,307208
.long 533696,32896,65920,9555968,1613568,1617792,1622016,17393152,66944,4294901760,17207296,17256448,17305600,17354752,3,0
.long 5939200,5943296,5947392,819200,96,393236,136,1,5244160,549888,0,768,819712,136192,0,294928
.long 553984,34816,4096,8388608,1631616,1635840,1640064,18743296,5120,4294901760,18792448,18841600,18890752,18743296,771,0
.long 5943296,5943296,5947392,839680,104,393236,4232,1,5326080,549952,7168,768,840192,136196,0,299024
.long 554048,34944,4224,8450048,1632640,1636864,1641088,18744832,5248,4294901760,18853888,18903040,18755584,18804736,771,0
.long 5947392,5943296,5947392,860160,112,393236,8328,1,5408000,550016,14336,768,860672,136704,0,303120
.long 554112,34816,4352,8511488,1633664,1637888,1642112,18939904,5376,4294901760,18915328,18767872,18817024,18866176,771,0
.long 5939200,5943296,5947392,880640,120,393236,12424,1,5489920,550080,21504,768,881152,136708,0,307216
.long 554176,34944,4480,8572928,1634688,1638912,1643136,18941440,5504,4294901760,18780160,18829312,18878464,18927616,771,0
.long 5959680,5963776,5967872,819840,24,393492,65672,0,6554880,549888,0,896,820352,136448,0,294936
.long 553984,34816,69632,9371648,1652736,1656960,1661184,18767872,70656,4294901760,18792448,18841600,18890752,18743296,3,0
.long 5963776,5963776,5967872,840320,56,393492,69768,0,6636800,549952,7168,896,840832,136452,0,299032
.long 554048,34944,69760,9433088,1653760,1657984,1662208,18769408,70784,4294901760,18853888,18903040,18755584,18804736,3,0
.long 5967872,5963776,5967872,860800,88,393492,73864,0,6718720,550016,14336,896,861312,136960,0,303128
.long 554112,34816,69888,9494528,1654784,1659008,1663232,18964480,70912,4294901760,18915328,18767872,18817024,18866176,3,0
.long 5959680,5963776,5967872,881280,120,393492,77960,0,6800640,550080,21504,896,881792,136964,0,307224
.long 554176,34944,70016,9555968,1655808,1660032,1664256,18966016,71040,4294901760,18780160,18829312,18878464,18927616,3,0
.long 5980160,5984256,5988352,1474560,24,393604,264,1,5245184,570368,0,896,1475072,140288,0,295040
.long 574464,36864,8192,8388608,1673856,1678080,1682304,20316160,9216,4294901760,20365312,20414464,20463616,20316160,771,0
.long 5984256,5984256,5988352,1495040,56,393604,4360,1,5327104,570432,7168,896,1495552,140292,0,299136
.long 574528,36992,8320,8450048,1674880,1679104,1683328,20317696,9344,4294901760,20426752,20475904,20328448,20377600,771,0
.long 5988352,5984256,5988352,1515520,88,393604,8456,1,5409024,570496,14336,896,1516032,140800,0,303232
.long 574592,36864,8448,8511488,1675904,1680128,1684352,20512768,9472,4294901760,20488192,20340736,20389888,20439040,771,0
.long 5980160,5984256,5988352,1536000,120,393604,12552,1,5490944,570560,21504,896,1536512,140804,0,307328
.long 574656,36992,8576,8572928,1676928,1681152,1685376,20514304,9600,4294901760,20353024,20402176,20451328,20500480,771,0
.long 6000640,6004736,6008832,1475200,128,393348,65800,0,6555904,570368,0,1024,1475712,140544,0,295048
.long 574464,36864,73728,9371648,1694976,1699200,1703424,20340736,74752,4294901760,20365312,20414464,20463616,20316160,3,0
.long 6004736,6004736,6008832,1495680,136,393348,69896,0,6637824,570432,7168,1024,1496192,140548,0,299144
.long 574528,36992,73856,9433088,1696000,1700224,1704448,20342272,74880,4294901760,20426752,20475904,20328448,20377600,3,0
.long 6008832,6004736,6008832,1516160,144,393348,73992,0,6719744,570496,14336,1024,1516672,141056,0,303240
.long 574592,36864,73984,9494528,1697024,1701248,1705472,20537344,75008,4294901760,20488192,20340736,20389888,20439040,3,0
.long 6000640,6004736,6008832,1536640,152,393348,78088,0,6801664,570560,21504,1024,1537152,141060,0,307336
.long 574656,36992,74112,9555968,1698048,1702272,1706496,20538880,75136,4294901760,20353024,20402176,20451328,20500480,3,0
.long 6021120,6025216,6029312,2129920,128,393364,392,1,5246208,590848,0,1024,2130432,144384,0,295056
.long 594944,38912,12288,8388608,1716096,1720320,1724544,21889024,13312,4294901760,21938176,21987328,22036480,21889024,771,0
.long 6025216,6025216,6029312,2150400,136,393364,4488,1,5328128,590912,7168,1024,2150912,144388,0,299152
.long 595008,39040,12416,8450048,1717120,1721344,1725568,21890560,13440,4294901760,21999616,22048768,21901312,21950464,771,0
.long 6029312,6025216,6029312,2170880,144,393364,8584,1,5410048,590976,14336,1024,2171392,144896,0,303248
.long 595072,38912,12544,8511488,1718144,1722368,1726592,22085632,13568,4294901760,22061056,21913600,21962752,22011904,771,0
.long 6021120,6025216,6029312,2191360,152,393364,12680,1,5491968,591040,21504,1024,2191872,144900,0,307344
.long 595136,39040,12672,8572928,1719168,1723392,1727616,22087168,13696,4294901760,21925888,21975040,22024192,22073344,771,0
.long 6041600,6045696,6049792,2130560,160,393364,65928,0,6556928,590848,0,1152,2131072,144640,0,295064
.long 594944,38912,77824,9371648,1737216,1741440,1745664,21913600,78848,4294901760,21938176,21987328,22036480,21889024,3,0
.long 6045696,6045696,6049792,2151040,168,393364,70024,0,6638848,590912,7168,1152,2151552,144644,0,299160
.long 595008,39040,77952,9433088,1738240,1742464,1746688,21915136,78976,4294901760,21999616,22048768,21901312,21950464,3,0
.long 6049792,6045696,6049792,2171520,176,393364,74120,0,6720768,590976,14336,1152,2172032,145152,0,303256
.long 595072,38912,78080,9494528,1739264,1743488,1747712,22110208,79104,4294901760,22061056,21913600,21962752,22011904,3,0
.long 6041600,6045696,6049792,2192000,184,393364,78216,0,6802688,591040,21504,1152,2192512,145156,0,307352
.long 595136,39040,78208,9555968,1740288,1744512,1748736,22111744,79232,4294901760,21925888,21975040,22024192,22073344,3,0
.long 5910528,5914624,84180992,163968,96,393220,16392,1,5570816,529408,0,768,164384,132104,0,294916
.long 533504,32768,16384,8634368,1602048,1606272,83886080,17173504,1024,4294901760,17219584,17268736,17317888,17170432,771,0
.long 5914624,5914624,84180992,184448,104,393220,20488,1,5652736,529472,7168,768,184864,132108,0,299012
.long 533568,32896,16512,8695808,1603072,1607296,83886080,17175040,1152,4294901760,17281024,17330176,17182720,17231872,771,0
.long 84180992,5914624,84180992,204928,112,393220,24584,1,5734656,529536,14336,768,205344,132616,0,303108
.long 533632,32768,16640,8757248,1604096,1608320,83886080,17370112,1280,4294901760,17342464,17195008,17244160,17293312,771,0
.long 5910528,5914624,84180992,225408,120,393220,28680,1,5816576,529600,21504,768,225824,132620,0,307204
.long 533696,32896,16768,8818688,1605120,1609344,83886080,17371648,1408,4294901760,17207296,17256448,17305600,17354752,771,0
.long 5931008,5935104,84185088,164608,24,393476,81928,0,6881536,529408,0,896,165024,132360,0,294924
.long 533504,32768,81920,9617408,1623168,1627392,83886080,17198080,66560,4294901760,17219584,17268736,17317888,17170432,3,0
.long 5935104,5935104,84185088,185088,56,393476,86024,0,6963456,529472,7168,896,185504,132364,0,299020
.long 533568,32896,82048,9678848,1624192,1628416,83886080,17199616,66688,4294901760,17281024,17330176,17182720,17231872,3,0
.long 84185088,5935104,84185088,205568,88,393476,90120,0,7045376,529536,14336,896,205984,132872,0,303116
.long 533632,32768,82176,9740288,1625216,1629440,83886080,17394688,66816,4294901760,17342464,17195008,17244160,17293312,3,0
.long 5931008,5935104,84185088,226048,120,393476,94216,0,7127296,529600,21504,896,226464,132876,0,307212
.long 533696,32896,82304,9801728,1626240,1630464,83886080,17396224,66944,4294901760,17207296,17256448,17305600,17354752,3,0
.long 5951488,5955584,84189184,819328,24,393492,16520,1,5571840,549888,0,896,819744,136200,0,294932
.long 553984,34816,20480,8634368,1644288,1648512,83886080,18746368,5120,4294901760,18792448,18841600,18890752,18743296,771,0
.long 5955584,5955584,84189184,839808,56,393492,20616,1,5653760,549952,7168,896,840224,136204,0,299028
.long 554048,34944,20608,8695808,1645312,1649536,83886080,18747904,5248,4294901760,18853888,18903040,18755584,18804736,771,0
.long 84189184,5955584,84189184,860288,88,393492,24712,1,5735680,550016,14336,896,860704,136712,0,303124
.long 554112,34816,20736,8757248,1646336,1650560,83886080,18942976,5376,4294901760,18915328,18767872,18817024,18866176,771,0
.long 5951488,5955584,84189184,880768,120,393492,28808,1,5817600,550080,21504,896,881184,136716,0,307220
.long 554176,34944,20864,8818688,1647360,1651584,83886080,18944512,5504,4294901760,18780160,18829312,18878464,18927616,771,0
.long 5971968,5976064,84193280,819968,128,393236,82056,0,6882560,549888,0,1024,820384,136456,0,294940
.long 553984,34816,86016,9617408,1665408,1669632,83886080,18770944,70656,4294901760,18792448,18841600,18890752,18743296,3,0
.long 5976064,5976064,84193280,840448,136,393236,86152,0,6964480,549952,7168,1024,840864,136460,0,299036
.long 554048,34944,86144,9678848,1666432,1670656,83886080,18772480,70784,4294901760,18853888,18903040,18755584,18804736,3,0
.long 84193280,5976064,84193280,860928,144,393236,90248,0,7046400,550016,14336,1024,861344,136968,0,303132
.long 554112,34816,86272,9740288,1667456,1671680,83886080,18967552,70912,4294901760,18915328,18767872,18817024,18866176,3,0
.long 5971968,5976064,84193280,881408,152,393236,94344,0,7128320,550080,21504,1024,881824,136972,0,307228
.long 554176,34944,86400,9801728,1668480,1672704,83886080,18969088,71040,4294901760,18780160,18829312,18878464,18927616,3,0
.long 5992448,5996544,84197376,1474688,128,393348,16648,1,5572864,570368,0,1024,1475104,140296,0,295044
.long 574464,36864,24576,8634368,1686528,1690752,83886080,20319232,9216,4294901760,20365312,20414464,20463616,20316160,771,0
.long 5996544,5996544,84197376,1495168,136,393348,20744,1,5654784,570432,7168,1024,1495584,140300,0,299140
.long 574528,36992,24704,8695808,1687552,1691776,83886080,20320768,9344,4294901760,20426752,20475904,20328448,20377600,771,0
.long 84197376,5996544,84197376,1515648,144,393348,24840,1,5736704,570496,14336,1024,1516064,140808,0,303236
.long 574592,36864,24832,8757248,1688576,1692800,83886080,20515840,9472,4294901760,20488192,20340736,20389888,20439040,771,0
.long 5992448,5996544,84197376,1536128,152,393348,28936,1,5818624,570560,21504,1024,1536544,140812,0,307332
.long 574656,36992,24960,8818688,1689600,1693824,83886080,20517376,9600,4294901760,20353024,20402176,20451328,20500480,771,0
.long 6012928,6017024,84201472,1475328,160,393348,82184,0,6883584,570368,0,1152,1475744,140552,0,295052
.long 574464,36864,90112,9617408,1707648,1711872,83886080,20343808,74752,4294901760,20365312,20414464,20463616,20316160,3,0
.long 6017024,6017024,84201472,1495808,168,393348,86280,0,6965504,570432,7168,1152,1496224,140556,0,299148
.long 574528,36992,90240,9678848,1708672,1712896,83886080,20345344,74880,4294901760,20426752,20475904,20328448,20377600,3,0
.long 84201472,6017024,84201472,1516288,176,393348,90376,0,7047424,570496,14336,1152,1516704,141064,0,303244
.long 574592,36864,90368,9740288,1709696,1713920,83886080,20540416,75008,4294901760,20488192,20340736,20389888,20439040,3,0
.long 6012928,6017024,84201472,1536768,184,393348,94472,0,7129344,570560,21504,1152,1537184,141068,0,307340
.long 574656,36992,90496,9801728,1710720,1714944,83886080,20541952,75136,4294901760,20353024,20402176,20451328,20500480,3,0
.long 6033408,6037504,84205568,2130048,160,393364,16776,1,5573888,590848,0,1152,2130464,144392,0,295060
.long 594944,38912,28672,8634368,1728768,1732992,83886080,21892096,13312,4294901760,21938176,21987328,22036480,21889024,771,0
.long 6037504,6037504,84205568,2150528,168,393364,20872,1,5655808,590912,7168,1152,2150944,144396,0,299156
.long 595008,39040,28800,8695808,1729792,1734016,83886080,21893632,13440,4294901760,21999616,22048768,21901312,21950464,771,0
.long 84205568,6037504,84205568,2171008,176,393364,24968,1,5737728,590976,14336,1152,2171424,144904,0,303252
.long 595072,38912,28928,8757248,1730816,1735040,83886080,22088704,13568,4294901760,22061056,21913600,21962752,22011904,771,0
.long 6033408,6037504,84205568,2191488,184,393364,29064,1,5819648,591040,21504,1152,2191904,144908,0,307348
.long 595136,39040,29056,8818688,1731840,1736064,83886080,22090240,13696,4294901760,21925888,21975040,22024192,22073344,771,0
.long 6053888,6057984,84209664,2130688,192,393364,82312,0,6884608,590848,0,0,2131104,144648,0,295068
.long 594944,38912,94208,9617408,1749888,1754112,83886080,21916672,78848,4294901760,21938176,21987328,22036480,21889024,3,0
.long 6057984,6057984,84209664,2151168,200,393364,86408,0,6966528,590912,7168,0,2151584,144652,0,299164
.long 595008,39040,94336,9678848,1750912,1755136,83886080,21918208,78976,4294901760,21999616,22048768,21901312,21950464,3,0
.long 84209664,6057984,84209664,2171648,208,393364,90504,0,7048448,590976,14336,0,2172064,145160,0,303260
.long 595072,38912,94464,9740288,1751936,1756160,83886080,22113280,79104,4294901760,22061056,21913600,21962752,22011904,3,0
.long 6053888,6057984,84209664,2192128,216,393364,94600,0,7130368,591040,21504,0,2192544,145164,0,307356
.long 595136,39040,94592,9801728,1752960,1757184,83886080,22114816,79232,4294901760,21925888,21975040,22024192,22073344,3,0
.long 6062080,6066176,6070272,164096,24,393476,32776,1,5898496,529408,0,896,164416,132112,0,295168
.long 533504,40960,32768,8880128,1758336,1762560,1766784,17176576,1024,4294901760,17219584,17268736,17317888,17170432,771,0
.long 6066176,6066176,6070272,184576,56,393476,36872,1,5980416,529472,7168,896,184896,132116,0,299264
.long 533568,41088,32896,8941568,1759360,1763584,1767808,17178112,1152,4294901760,17281024,17330176,17182720,17231872,771,0
.long 6070272,6066176,6070272,205056,88,393476,40968,1,6062336,529536,14336,896,205376,132624,0,303360
.long 533632,40960,33024,9003008,1760384,1764608,1768832,17373184,1280,4294901760,17342464,17195008,17244160,17293312,771,0
.long 6062080,6066176,6070272,225536,120,393476,45064,1,6144256,529600,21504,896,225856,132628,0,307456
.long 533696,41088,33152,9064448,1761408,1765632,1769856,17374720,1408,4294901760,17207296,17256448,17305600,17354752,771,0
.long 6082560,6086656,6090752,164736,128,393220,98312,0,7209216,529408,0,1024,165056,132368,0,295176
.long 533504,40960,98304,9863168,1779456,1783680,1787904,17201152,66560,4294901760,17219584,17268736,17317888,17170432,3,0
.long 6086656,6086656,6090752,185216,136,393220,102408,0,7291136,529472,7168,1024,185536,132372,0,299272
.long 533568,41088,98432,9924608,1780480,1784704,1788928,17202688,66688,4294901760,17281024,17330176,17182720,17231872,3,0
.long 6090752,6086656,6090752,205696,144,393220,106504,0,7373056,529536,14336,1024,206016,132880,0,303368
.long 533632,40960,98560,9986048,1781504,1785728,1789952,17397760,66816,4294901760,17342464,17195008,17244160,17293312,3,0
.long 6082560,6086656,6090752,226176,152,393220,110600,0,7454976,529600,21504,1024,226496,132884,0,307464
.long 533696,41088,98688,10047488,1782528,1786752,1790976,17399296,66944,4294901760,17207296,17256448,17305600,17354752,3,0
.long 6103040,6107136,6111232,819456,128,393236,32904,1,5899520,549888,0,1024,819776,136208,0,295184
.long 553984,43008,36864,8880128,1800576,1804800,1809024,18749440,5120,4294901760,18792448,18841600,18890752,18743296,771,0
.long 6107136,6107136,6111232,839936,136,393236,37000,1,5981440,549952,7168,1024,840256,136212,0,299280
.long 554048,43136,36992,8941568,1801600,1805824,1810048,18750976,5248,4294901760,18853888,18903040,18755584,18804736,771,0
.long 6111232,6107136,6111232,860416,144,393236,41096,1,6063360,550016,14336,1024,860736,136720,0,303376
.long 554112,43008,37120,9003008,1802624,1806848,1811072,18946048,5376,4294901760,18915328,18767872,18817024,18866176,771,0
.long 6103040,6107136,6111232,880896,152,393236,45192,1,6145280,550080,21504,1024,881216,136724,0,307472
.long 554176,43136,37248,9064448,1803648,1807872,1812096,18947584,5504,4294901760,18780160,18829312,18878464,18927616,771,0
.long 6123520,6127616,6131712,820096,160,393236,98440,0,7210240,549888,0,1152,820416,136464,0,295192
.long 553984,43008,102400,9863168,1821696,1825920,1830144,18774016,70656,4294901760,18792448,18841600,18890752,18743296,3,0
.long 6127616,6127616,6131712,840576,168,393236,102536,0,7292160,549952,7168,1152,840896,136468,0,299288
.long 554048,43136,102528,9924608,1822720,1826944,1831168,18775552,70784,4294901760,18853888,18903040,18755584,18804736,3,0
.long 6131712,6127616,6131712,861056,176,393236,106632,0,7374080,550016,14336,1152,861376,136976,0,303384
.long 554112,43008,102656,9986048,1823744,1827968,1832192,18970624,70912,4294901760,18915328,18767872,18817024,18866176,3,0
.long 6123520,6127616,6131712,881536,184,393236,110728,0,7456000,550080,21504,1152,881856,136980,0,307480
.long 554176,43136,102784,10047488,1824768,1828992,1833216,18972160,71040,4294901760,18780160,18829312,18878464,18927616,3,0
.long 6144000,6148096,6152192,1474816,160,393348,33032,1,5900544,570368,0,1152,1475136,140304,0,295296
.long 574464,45056,40960,8880128,1842816,1847040,1851264,20322304,9216,4294901760,20365312,20414464,20463616,20316160,771,0
.long 6148096,6148096,6152192,1495296,168,393348,37128,1,5982464,570432,7168,1152,1495616,140308,0,299392
.long 574528,45184,41088,8941568,1843840,1848064,1852288,20323840,9344,4294901760,20426752,20475904,20328448,20377600,771,0
.long 6152192,6148096,6152192,1515776,176,393348,41224,1,6064384,570496,14336,1152,1516096,140816,0,303488
.long 574592,45056,41216,9003008,1844864,1849088,1853312,20518912,9472,4294901760,20488192,20340736,20389888,20439040,771,0
.long 6144000,6148096,6152192,1536256,184,393348,45320,1,6146304,570560,21504,1152,1536576,140820,0,307584
.long 574656,45184,41344,9064448,1845888,1850112,1854336,20520448,9600,4294901760,20353024,20402176,20451328,20500480,771,0
.long 6164480,6168576,6172672,1475456,192,393348,98568,0,7211264,570368,0,0,1475776,140560,0,295304
.long 574464,45312,106496,9863168,2269440,2273664,2277888,20346880,74752,4294901760,20365312,20414464,20463616,20316160,3,0
.long 6168576,6168576,6172672,1495936,200,393348,102664,0,7293184,570432,7168,0,1496256,140564,0,299400
.long 574528,45440,106624,9924608,2270464,2274688,2278912,20348416,74880,4294901760,20426752,20475904,20328448,20377600,3,0
.long 6172672,6168576,6172672,1516416,208,393348,106760,0,7375104,570496,14336,0,1516736,141072,0,303496
.long 574592,45312,106752,9986048,2271488,2275712,2279936,20543488,75008,4294901760,20488192,20340736,20389888,20439040,3,0
.long 6164480,6168576,6172672,1536896,216,393348,110856,0,7457024,570560,21504,0,1537216,141076,0,307592
.long 574656,45440,106880,10047488,2272512,2276736,2280960,20545024,75136,4294901760,20353024,20402176,20451328,20500480,3,0
.long 6184960,6189056,6193152,2130176,192,393364,33160,1,5901568,590848,0,0,2130496,144400,0,295312
.long 594944,47360,45056,8880128,2290560,2294784,2299008,21895168,13312,4294901760,21938176,21987328,22036480,21889024,771,0
.long 6189056,6189056,6193152,2150656,200,393364,37256,1,5983488,590912,7168,0,2150976,144404,0,299408
.long 595008,47488,45184,8941568,2291584,2295808,2300032,21896704,13440,4294901760,21999616,22048768,21901312,21950464,771,0
.long 6193152,6189056,6193152,2171136,208,393364,41352,1,6065408,590976,14336,0,2171456,144912,0,303504
.long 595072,47360,45312,9003008,2292608,2296832,2301056,22091776,13568,4294901760,22061056,21913600,21962752,22011904,771,0
.long 6184960,6189056,6193152,2191616,216,393364,45448,1,6147328,591040,21504,0,2191936,144916,0,307600
.long 595136,47488,45440,9064448,2293632,2297856,2302080,22093312,13696,4294901760,21925888,21975040,22024192,22073344,771,0
.long 6205440,6209536,6213632,2130816,224,393364,98696,0,7212288,590848,0,128,2131136,144656,0,295320
.long 594944,47360,110592,9863168,2311680,2315904,2320128,21919744,78848,4294901760,21938176,21987328,22036480,21889024,3,0
.long 6209536,6209536,6213632,2151296,232,393364,102792,0,7294208,590912,7168,128,2151616,144660,0,299416
.long 595008,47488,110720,9924608,2312704,2316928,2321152,21921280,78976,4294901760,21999616,22048768,21901312,21950464,3,0
.long 6213632,6209536,6213632,2171776,240,393364,106888,0,7376128,590976,14336,128,2172096,145168,0,303512
.long 595072,47360,110848,9986048,2313728,2317952,2322176,22116352,79104,4294901760,22061056,21913600,21962752,22011904,3,0
.long 6205440,6209536,6213632,2192256,248,393364,110984,0,7458048,591040,21504,128,2192576,145172,0,307608
.long 595136,47488,110976,10047488,2314752,2318976,2323200,22117888,79232,4294901760,21925888,21975040,22024192,22073344,3,0
.long 6074368,6078464,84246528,164224,128,393220,49160,1,6226176,529408,0,1024,164448,132120,0,295172
.long 533504,40960,49152,9125888,1771008,1775232,83886080,17179648,1024,4294901760,17219584,17268736,17317888,17170432,771,0
.long 6078464,6078464,84246528,184704,136,393220,53256,1,6308096,529472,7168,1024,184928,132124,0,299268
.long 533568,41088,49280,9187328,1772032,1776256,83886080,17181184,1152,4294901760,17281024,17330176,17182720,17231872,771,0
.long 84246528,6078464,84246528,205184,144,393220,57352,1,6390016,529536,14336,1024,205408,132632,0,303364
.long 533632,40960,49408,9248768,1773056,1777280,83886080,17376256,1280,4294901760,17342464,17195008,17244160,17293312,771,0
.long 6074368,6078464,84246528,225664,152,393220,61448,1,6471936,529600,21504,1024,225888,132636,0,307460
.long 533696,41088,49536,9310208,1774080,1778304,83886080,17377792,1408,4294901760,17207296,17256448,17305600,17354752,771,0
.long 6094848,6098944,84250624,164864,160,393220,114696,1,7536896,529408,0,1152,165088,132376,0,295180
.long 533504,40960,114688,10108928,1792128,1796352,83886080,17204224,66560,4294901760,17219584,17268736,17317888,17170432,771,0
.long 6098944,6098944,84250624,185344,168,393220,118792,1,7618816,529472,7168,1152,185568,132380,0,299276
.long 533568,41088,114816,10170368,1793152,1797376,83886080,17205760,66688,4294901760,17281024,17330176,17182720,17231872,771,0
.long 84250624,6098944,84250624,205824,176,393220,122888,1,7700736,529536,14336,1152,206048,132888,0,303372
.long 533632,40960,114944,10231808,1794176,1798400,83886080,17400832,66816,4294901760,17342464,17195008,17244160,17293312,771,0
.long 6094848,6098944,84250624,226304,184,393220,126984,1,7782656,529600,21504,1152,226528,132892,0,307468
.long 533696,41088,115072,10293248,1795200,1799424,83886080,17402368,66944,4294901760,17207296,17256448,17305600,17354752,771,0
.long 6115328,6119424,84254720,819584,160,393236,49288,1,6227200,549888,0,1152,819808,136216,0,295188
.long 553984,43008,53248,9125888,1813248,1817472,83886080,18752512,5120,4294901760,18792448,18841600,18890752,18743296,771,0
.long 6119424,6119424,84254720,840064,168,393236,53384,1,6309120,549952,7168,1152,840288,136220,0,299284
.long 554048,43136,53376,9187328,1814272,1818496,83886080,18754048,5248,4294901760,18853888,18903040,18755584,18804736,771,0
.long 84254720,6119424,84254720,860544,176,393236,57480,1,6391040,550016,14336,1152,860768,136728,0,303380
.long 554112,43008,53504,9248768,1815296,1819520,83886080,18949120,5376,4294901760,18915328,18767872,18817024,18866176,771,0
.long 6115328,6119424,84254720,881024,184,393236,61576,1,6472960,550080,21504,1152,881248,136732,0,307476
.long 554176,43136,53632,9310208,1816320,1820544,83886080,18950656,5504,4294901760,18780160,18829312,18878464,18927616,771,0
.long 6135808,6139904,84258816,820224,192,393236,114824,1,7537920,549888,0,0,820448,136472,0,295196
.long 553984,43008,118784,10108928,1834368,1838592,83886080,18777088,70656,4294901760,18792448,18841600,18890752,18743296,771,0
.long 6139904,6139904,84258816,840704,200,393236,118920,1,7619840,549952,7168,0,840928,136476,0,299292
.long 554048,43136,118912,10170368,1835392,1839616,83886080,18778624,70784,4294901760,18853888,18903040,18755584,18804736,771,0
.long 84258816,6139904,84258816,861184,208,393236,123016,1,7701760,550016,14336,0,861408,136984,0,303388
.long 554112,43008,119040,10231808,1836416,1840640,83886080,18973696,70912,4294901760,18915328,18767872,18817024,18866176,771,0
.long 6135808,6139904,84258816,881664,216,393236,127112,1,7783680,550080,21504,0,881888,136988,0,307484
.long 554176,43136,119168,10293248,1837440,1841664,83886080,18975232,71040,4294901760,18780160,18829312,18878464,18927616,771,0
.long 6156288,6160384,84262912,1474944,192,393348,49416,1,6228224,570368,0,0,1475168,140312,0,295300
.long 574464,45056,57344,9125888,1855488,2265216,83886080,20325376,9216,4294901760,20365312,20414464,20463616,20316160,771,0
.long 6160384,6160384,84262912,1495424,200,393348,53512,1,6310144,570432,7168,0,1495648,140316,0,299396
.long 574528,45184,57472,9187328,1856512,2266240,83886080,20326912,9344,4294901760,20426752,20475904,20328448,20377600,771,0
.long 84262912,6160384,84262912,1515904,208,393348,57608,1,6392064,570496,14336,0,1516128,140824,0,303492
.long 574592,45312,57600,9248768,1857536,2267264,83886080,20521984,9472,4294901760,20488192,20340736,20389888,20439040,771,0
.long 6156288,6160384,84262912,1536384,216,393348,61704,1,6473984,570560,21504,0,1536608,140828,0,307588
.long 574656,45440,57728,9310208,1858560,2268288,83886080,20523520,9600,4294901760,20353024,20402176,20451328,20500480,771,0
.long 6176768,6180864,84267008,1475584,224,393348,114952,1,7538944,570368,0,128,1475808,140568,0,295308
.long 574464,45312,122880,10108928,2282112,2286336,83886080,20349952,74752,4294901760,20365312,20414464,20463616,20316160,771,0
.long 6180864,6180864,84267008,1496064,232,393348,119048,1,7620864,570432,7168,128,1496288,140572,0,299404
.long 574528,45440,123008,10170368,2283136,2287360,83886080,20351488,74880,4294901760,20426752,20475904,20328448,20377600,771,0
.long 84267008,6180864,84267008,1516544,240,393348,123144,1,7702784,570496,14336,128,1516768,141080,0,303500
.long 574592,45312,123136,10231808,2284160,2288384,83886080,20546560,75008,4294901760,20488192,20340736,20389888,20439040,771,0
.long 6176768,6180864,84267008,1537024,248,393348,127240,1,7784704,570560,21504,128,1537248,141084,0,307596
.long 574656,45440,123264,10293248,2285184,2289408,83886080,20548096,75136,4294901760,20353024,20402176,20451328,20500480,771,0
.long 6197248,6201344,84271104,2130304,224,393364,49544,1,6229248,590848,0,128,2130528,144408,0,295316
.long 594944,47360,61440,9125888,2303232,2307456,83886080,21898240,13312,4294901760,21938176,21987328,22036480,21889024,771,0
.long 6201344,6201344,84271104,2150784,232,393364,53640,1,6311168,590912,7168,128,2151008,144412,0,299412
.long 595008,47488,61568,9187328,2304256,2308480,83886080,21899776,13440,4294901760,21999616,22048768,21901312,21950464,771,0
.long 84271104,6201344,84271104,2171264,240,393364,57736,1,6393088,590976,14336,128,2171488,144920,0,303508
.long 595072,47360,61696,9248768,2305280,2309504,83886080,22094848,13568,4294901760,22061056,21913600,21962752,22011904,771,0
.long 6197248,6201344,84271104,2191744,248,393364,61832,1,6475008,591040,21504,128,2191968,144924,0,307604
.long 595136,47488,61824,9310208,2306304,2310528,83886080,22096384,13696,4294901760,21925888,21975040,22024192,22073344,771,0
.long 6217728,6221824,84275200,2130944,152,393620,115080,1,7539968,590848,0,256,2131168,144664,0,295324
.long 594944,47360,126976,10108928,2324352,2328576,83886080,21922816,78848,4294901760,21938176,21987328,22036480,21889024,771,0
.long 6221824,6221824,84275200,2151424,184,393620,119176,1,7621888,590912,7168,256,2151648,144668,0,299420
.long 595008,47488,127104,10170368,2325376,2329600,83886080,21924352,78976,4294901760,21999616,22048768,21901312,21950464,771,0
.long 84275200,6221824,84275200,2171904,216,393620,123272,1,7703808,590976,14336,256,2172128,145176,0,303516
.long 595072,47360,127232,10231808,2326400,2330624,83886080,22119424,79104,4294901760,22061056,21913600,21962752,22011904,771,0
.long 6217728,6221824,84275200,2192384,248,393620,127368,1,7785728,591040,21504,256,2192608,145180,0,307612
.long 595136,47488,127360,10293248,2327424,2331648,83886080,22120960,79232,4294901760,21925888,21975040,22024192,22073344,771,0
.long 6225920,6230016,6234112,245760,192,393220,12,1,5243264,529664,0,0,246272,132224,0,311296
.long 533760,49152,0,8388608,1859712,1863936,1868160,17182720,1536,4294901760,17416192,17465344,17514496,17367040,771,0
.long 6230016,6230016,6234112,266240,200,393220,4108,1,5325184,529728,7168,0,266752,132228,0,315392
.long 533824,49280,128,8450048,1860736,1864960,1869184,17184256,1664,4294901760,17477632,17526784,17379328,17428480,771,0
.long 6234112,6230016,6234112,286720,208,393220,8204,1,5407104,529792,14336,0,287232,132736,0,319488
.long 533888,49152,256,8511488,1861760,1865984,1870208,17379328,1792,4294901760,17539072,17391616,17440768,17489920,771,0
.long 6225920,6230016,6234112,307200,216,393220,12300,1,5489024,529856,21504,0,307712,132740,0,323584
.long 533952,49280,384,8572928,1862784,1867008,1871232,17380864,1920,4294901760,17403904,17453056,17502208,17551360,771,0
.long 6246400,6250496,6254592,246400,224,393220,65548,0,6553984,529664,0,128,246912,132480,0,311304
.long 533760,49152,65536,9371648,1880832,1885056,1889280,17207296,67072,4294901760,17416192,17465344,17514496,17367040,3,0
.long 6250496,6250496,6254592,266880,232,393220,69644,0,6635904,529728,7168,128,267392,132484,0,315400
.long 533824,49280,65664,9433088,1881856,1886080,1890304,17208832,67200,4294901760,17477632,17526784,17379328,17428480,3,0
.long 6254592,6250496,6254592,287360,240,393220,73740,0,6717824,529792,14336,128,287872,132992,0,319496
.long 533888,49152,65792,9494528,1882880,1887104,1891328,17403904,67328,4294901760,17539072,17391616,17440768,17489920,3,0
.long 6246400,6250496,6254592,307840,248,393220,77836,0,6799744,529856,21504,128,308352,132996,0,323592
.long 533952,49280,65920,9555968,1883904,1888128,1892352,17405440,67456,4294901760,17403904,17453056,17502208,17551360,3,0
.long 6266880,6270976,6275072,901120,224,393236,140,1,5244288,550144,0,128,901632,136320,0,311312
.long 554240,51200,4096,8388608,1901952,1906176,1910400,18755584,5632,4294901760,18989056,19038208,19087360,18939904,771,0
.long 6270976,6270976,6275072,921600,232,393236,4236,1,5326208,550208,7168,128,922112,136324,0,315408
.long 554304,51328,4224,8450048,1902976,1907200,1911424,18757120,5760,4294901760,19050496,19099648,18952192,19001344,771,0
.long 6275072,6270976,6275072,942080,240,393236,8332,1,5408128,550272,14336,128,942592,136832,0,319504
.long 554368,51200,4352,8511488,1904000,1908224,1912448,18952192,5888,4294901760,19111936,18964480,19013632,19062784,771,0
.long 6266880,6270976,6275072,962560,248,393236,12428,1,5490048,550336,21504,128,963072,136836,0,323600
.long 554432,51328,4480,8572928,1905024,1909248,1913472,18953728,6016,4294901760,18976768,19025920,19075072,19124224,771,0
.long 6287360,6291456,6295552,901760,152,393492,65676,0,6555008,550144,0,256,902272,136576,0,311320
.long 554240,51200,69632,9371648,1923072,1927296,1931520,18780160,71168,4294901760,18989056,19038208,19087360,18939904,3,0
.long 6291456,6291456,6295552,922240,184,393492,69772,0,6636928,550208,7168,256,922752,136580,0,315416
.long 554304,51328,69760,9433088,1924096,1928320,1932544,18781696,71296,4294901760,19050496,19099648,18952192,19001344,3,0
.long 6295552,6291456,6295552,942720,216,393492,73868,0,6718848,550272,14336,256,943232,137088,0,319512
.long 554368,51200,69888,9494528,1925120,1929344,1933568,18976768,71424,4294901760,19111936,18964480,19013632,19062784,3,0
.long 6287360,6291456,6295552,963200,248,393492,77964,0,6800768,550336,21504,256,963712,137092,0,323608
.long 554432,51328,70016,9555968,1926144,1930368,1934592,18978304,71552,4294901760,18976768,19025920,19075072,19124224,3,0
.long 6307840,6311936,6316032,1556480,152,393604,268,1,5245312,570624,0,256,1556992,140416,0,311424
.long 574720,53248,8192,8388608,1944192,1948416,1952640,20328448,9728,4294901760,20561920,20611072,20660224,20512768,771,0
.long 6311936,6311936,6316032,1576960,184,393604,4364,1,5327232,570688,7168,256,1577472,140420,0,315520
.long 574784,53376,8320,8450048,1945216,1949440,1953664,20329984,9856,4294901760,20623360,20672512,20525056,20574208,771,0
.long 6316032,6311936,6316032,1597440,216,393604,8460,1,5409152,570752,14336,256,1597952,140928,0,319616
.long 574848,53248,8448,8511488,1946240,1950464,1954688,20525056,9984,4294901760,20684800,20537344,20586496,20635648,771,0
.long 6307840,6311936,6316032,1617920,248,393604,12556,1,5491072,570816,21504,256,1618432,140932,0,323712
.long 574912,53376,8576,8572928,1947264,1951488,1955712,20526592,10112,4294901760,20549632,20598784,20647936,20697088,771,0
.long 6328320,6332416,6336512,1557120,0,393348,65804,0,6556032,570624,0,384,1557632,140672,0,311432
.long 574720,53248,73728,9371648,1965312,1969536,1973760,20353024,75264,4294901760,20561920,20611072,20660224,20512768,3,0
.long 6332416,6332416,6336512,1577600,8,393348,69900,0,6637952,570688,7168,384,1578112,140676,0,315528
.long 574784,53376,73856,9433088,1966336,1970560,1974784,20354560,75392,4294901760,20623360,20672512,20525056,20574208,3,0
.long 6336512,6332416,6336512,1598080,16,393348,73996,0,6719872,570752,14336,384,1598592,141184,0,319624
.long 574848,53248,73984,9494528,1967360,1971584,1975808,20549632,75520,4294901760,20684800,20537344,20586496,20635648,3,0
.long 6328320,6332416,6336512,1618560,24,393348,78092,0,6801792,570816,21504,384,1619072,141188,0,323720
.long 574912,53376,74112,9555968,1968384,1972608,1976832,20551168,75648,4294901760,20549632,20598784,20647936,20697088,3,0
.long 6348800,6352896,6356992,2211840,0,393364,396,1,5246336,591104,0,384,2212352,144512,0,311440
.long 595200,55296,12288,8388608,1986432,1990656,1994880,21901312,13824,4294901760,22134784,22183936,22233088,22085632,771,0
.long 6352896,6352896,6356992,2232320,8,393364,4492,1,5328256,591168,7168,384,2232832,144516,0,315536
.long 595264,55424,12416,8450048,1987456,1991680,1995904,21902848,13952,4294901760,22196224,22245376,22097920,22147072,771,0
.long 6356992,6352896,6356992,2252800,16,393364,8588,1,5410176,591232,14336,384,2253312,145024,0,319632
.long 595328,55296,12544,8511488,1988480,1992704,1996928,22097920,14080,4294901760,22257664,22110208,22159360,22208512,771,0
.long 6348800,6352896,6356992,2273280,24,393364,12684,1,5492096,591296,21504,384,2273792,145028,0,323728
.long 595392,55424,12672,8572928,1989504,1993728,1997952,22099456,14208,4294901760,22122496,22171648,22220800,22269952,771,0
.long 6369280,6373376,6377472,2212480,32,393364,65932,0,6557056,591104,0,512,2212992,144768,0,311448
.long 595200,55296,77824,9371648,2007552,2011776,2016000,21925888,79360,4294901760,22134784,22183936,22233088,22085632,3,0
.long 6373376,6373376,6377472,2232960,40,393364,70028,0,6638976,591168,7168,512,2233472,144772,0,315544
.long 595264,55424,77952,9433088,2008576,2012800,2017024,21927424,79488,4294901760,22196224,22245376,22097920,22147072,3,0
.long 6377472,6373376,6377472,2253440,48,393364,74124,0,6720896,591232,14336,512,2253952,145280,0,319640
.long 595328,55296,78080,9494528,2009600,2013824,2018048,22122496,79616,4294901760,22257664,22110208,22159360,22208512,3,0
.long 6369280,6373376,6377472,2273920,56,393364,78220,0,6802816,591296,21504,512,2274432,145284,0,323736
.long 595392,55424,78208,9555968,2010624,2014848,2019072,22124032,79744,4294901760,22122496,22171648,22220800,22269952,3,0
.long 6238208,6242304,84312064,245888,224,393220,16396,1,5570944,529664,0,128,246304,132232,0,311300
.long 533760,49152,16384,8634368,1872384,1876608,83886080,17185792,1536,4294901760,17416192,17465344,17514496,17367040,771,0
.long 6242304,6242304,84312064,266368,232,393220,20492,1,5652864,529728,7168,128,266784,132236,0,315396
.long 533824,49280,16512,8695808,1873408,1877632,83886080,17187328,1664,4294901760,17477632,17526784,17379328,17428480,771,0
.long 84312064,6242304,84312064,286848,240,393220,24588,1,5734784,529792,14336,128,287264,132744,0,319492
.long 533888,49152,16640,8757248,1874432,1878656,83886080,17382400,1792,4294901760,17539072,17391616,17440768,17489920,771,0
.long 6238208,6242304,84312064,307328,248,393220,28684,1,5816704,529856,21504,128,307744,132748,0,323588
.long 533952,49280,16768,8818688,1875456,1879680,83886080,17383936,1920,4294901760,17403904,17453056,17502208,17551360,771,0
.long 6258688,6262784,84316160,246528,152,393476,81932,0,6881664,529664,0,256,246944,132488,0,311308
.long 533760,49152,81920,9617408,1893504,1897728,83886080,17210368,67072,4294901760,17416192,17465344,17514496,17367040,3,0
.long 6262784,6262784,84316160,267008,184,393476,86028,0,6963584,529728,7168,256,267424,132492,0,315404
.long 533824,49280,82048,9678848,1894528,1898752,83886080,17211904,67200,4294901760,17477632,17526784,17379328,17428480,3,0
.long 84316160,6262784,84316160,287488,216,393476,90124,0,7045504,529792,14336,256,287904,133000,0,319500
.long 533888,49152,82176,9740288,1895552,1899776,83886080,17406976,67328,4294901760,17539072,17391616,17440768,17489920,3,0
.long 6258688,6262784,84316160,307968,248,393476,94220,0,7127424,529856,21504,256,308384,133004,0,323596
.long 533952,49280,82304,9801728,1896576,1900800,83886080,17408512,67456,4294901760,17403904,17453056,17502208,17551360,3,0
.long 6279168,6283264,84320256,901248,152,393492,16524,1,5571968,550144,0,256,901664,136328,0,311316
.long 554240,51200,20480,8634368,1914624,1918848,83886080,18758656,5632,4294901760,18989056,19038208,19087360,18939904,771,0
.long 6283264,6283264,84320256,921728,184,393492,20620,1,5653888,550208,7168,256,922144,136332,0,315412
.long 554304,51328,20608,8695808,1915648,1919872,83886080,18760192,5760,4294901760,19050496,19099648,18952192,19001344,771,0
.long 84320256,6283264,84320256,942208,216,393492,24716,1,5735808,550272,14336,256,942624,136840,0,319508
.long 554368,51200,20736,8757248,1916672,1920896,83886080,18955264,5888,4294901760,19111936,18964480,19013632,19062784,771,0
.long 6279168,6283264,84320256,962688,248,393492,28812,1,5817728,550336,21504,256,963104,136844,0,323604
.long 554432,51328,20864,8818688,1917696,1921920,83886080,18956800,6016,4294901760,18976768,19025920,19075072,19124224,771,0
.long 6299648,6303744,84324352,901888,0,393236,82060,0,6882688,550144,0,384,902304,136584,0,311324
.long 554240,51200,86016,9617408,1935744,1939968,83886080,18783232,71168,4294901760,18989056,19038208,19087360,18939904,3,0
.long 6303744,6303744,84324352,922368,8,393236,86156,0,6964608,550208,7168,384,922784,136588,0,315420
.long 554304,51328,86144,9678848,1936768,1940992,83886080,18784768,71296,4294901760,19050496,19099648,18952192,19001344,3,0
.long 84324352,6303744,84324352,942848,16,393236,90252,0,7046528,550272,14336,384,943264,137096,0,319516
.long 554368,51200,86272,9740288,1937792,1942016,83886080,18979840,71424,4294901760,19111936,18964480,19013632,19062784,3,0
.long 6299648,6303744,84324352,963328,24,393236,94348,0,7128448,550336,21504,384,963744,137100,0,323612
.long 554432,51328,86400,9801728,1938816,1943040,83886080,18981376,71552,4294901760,18976768,19025920,19075072,19124224,3,0
.long 6320128,6324224,84328448,1556608,0,393348,16652,1,5572992,570624,0,384,1557024,140424,0,311428
.long 574720,53248,24576,8634368,1956864,1961088,83886080,20331520,9728,4294901760,20561920,20611072,20660224,20512768,771,0
.long 6324224,6324224,84328448,1577088,8,393348,20748,1,5654912,570688,7168,384,1577504,140428,0,315524
.long 574784,53376,24704,8695808,1957888,1962112,83886080,20333056,9856,4294901760,20623360,20672512,20525056,20574208,771,0
.long 84328448,6324224,84328448,1597568,16,393348,24844,1,5736832,570752,14336,384,1597984,140936,0,319620
.long 574848,53248,24832,8757248,1958912,1963136,83886080,20528128,9984,4294901760,20684800,20537344,20586496,20635648,771,0
.long 6320128,6324224,84328448,1618048,24,393348,28940,1,5818752,570816,21504,384,1618464,140940,0,323716
.long 574912,53376,24960,8818688,1959936,1964160,83886080,20529664,10112,4294901760,20549632,20598784,20647936,20697088,771,0
.long 6340608,6344704,84332544,1557248,32,393348,82188,0,6883712,570624,0,512,1557664,140680,0,311436
.long 574720,53248,90112,9617408,1977984,1982208,83886080,20356096,75264,4294901760,20561920,20611072,20660224,20512768,3,0
.long 6344704,6344704,84332544,1577728,40,393348,86284,0,6965632,570688,7168,512,1578144,140684,0,315532
.long 574784,53376,90240,9678848,1979008,1983232,83886080,20357632,75392,4294901760,20623360,20672512,20525056,20574208,3,0
.long 84332544,6344704,84332544,1598208,48,393348,90380,0,7047552,570752,14336,512,1598624,141192,0,319628
.long 574848,53248,90368,9740288,1980032,1984256,83886080,20552704,75520,4294901760,20684800,20537344,20586496,20635648,3,0
.long 6340608,6344704,84332544,1618688,56,393348,94476,0,7129472,570816,21504,512,1619104,141196,0,323724
.long 574912,53376,90496,9801728,1981056,1985280,83886080,20554240,75648,4294901760,20549632,20598784,20647936,20697088,3,0
.long 6361088,6365184,84336640,2211968,32,393364,16780,1,5574016,591104,0,512,2212384,144520,0,311444
.long 595200,55296,28672,8634368,1999104,2003328,83886080,21904384,13824,4294901760,22134784,22183936,22233088,22085632,771,0
.long 6365184,6365184,84336640,2232448,40,393364,20876,1,5655936,591168,7168,512,2232864,144524,0,315540
.long 595264,55424,28800,8695808,2000128,2004352,83886080,21905920,13952,4294901760,22196224,22245376,22097920,22147072,771,0
.long 84336640,6365184,84336640,2252928,48,393364,24972,1,5737856,591232,14336,512,2253344,145032,0,319636
.long 595328,55296,28928,8757248,2001152,2005376,83886080,22100992,14080,4294901760,22257664,22110208,22159360,22208512,771,0
.long 6361088,6365184,84336640,2273408,56,393364,29068,1,5819776,591296,21504,512,2273824,145036,0,323732
.long 595392,55424,29056,8818688,2002176,2006400,83886080,22102528,14208,4294901760,22122496,22171648,22220800,22269952,771,0
.long 6381568,6385664,84340736,2212608,64,393364,82316,0,6884736,591104,0,640,2213024,144776,0,311452
.long 595200,55296,94208,9617408,2020224,2024448,83886080,21928960,79360,4294901760,22134784,22183936,22233088,22085632,3,0
.long 6385664,6385664,84340736,2233088,72,393364,86412,0,6966656,591168,7168,640,2233504,144780,0,315548
.long 595264,55424,94336,9678848,2021248,2025472,83886080,21930496,79488,4294901760,22196224,22245376,22097920,22147072,3,0
.long 84340736,6385664,84340736,2253568,80,393364,90508,0,7048576,591232,14336,640,2253984,145288,0,319644
.long 595328,55296,94464,9740288,2022272,2026496,83886080,22125568,79616,4294901760,22257664,22110208,22159360,22208512,3,0
.long 6381568,6385664,84340736,2274048,88,393364,94604,0,7130496,591296,21504,640,2274464,145292,0,323740
.long 595392,55424,94592,9801728,2023296,2027520,83886080,22127104,79744,4294901760,22122496,22171648,22220800,22269952,3,0
.long 6389760,6393856,6397952,246016,152,393476,32780,1,5898624,529664,0,256,246336,132240,0,311552
.long 533760,57344,32768,8880128,2028672,2032896,2037120,17188864,1536,4294901760,17416192,17465344,17514496,17367040,771,0
.long 6393856,6393856,6397952,266496,184,393476,36876,1,5980544,529728,7168,256,266816,132244,0,315648
.long 533824,57472,32896,8941568,2029696,2033920,2038144,17190400,1664,4294901760,17477632,17526784,17379328,17428480,771,0
.long 6397952,6393856,6397952,286976,216,393476,40972,1,6062464,529792,14336,256,287296,132752,0,319744
.long 533888,57344,33024,9003008,2030720,2034944,2039168,17385472,1792,4294901760,17539072,17391616,17440768,17489920,771,0
.long 6389760,6393856,6397952,307456,248,393476,45068,1,6144384,529856,21504,256,307776,132756,0,323840
.long 533952,57472,33152,9064448,2031744,2035968,2040192,17387008,1920,4294901760,17403904,17453056,17502208,17551360,771,0
.long 6410240,6414336,6418432,246656,0,393220,98316,0,7209344,529664,0,384,246976,132496,0,311560
.long 533760,57344,98304,9863168,2049792,2054016,2058240,17213440,67072,4294901760,17416192,17465344,17514496,17367040,3,0
.long 6414336,6414336,6418432,267136,8,393220,102412,0,7291264,529728,7168,384,267456,132500,0,315656
.long 533824,57472,98432,9924608,2050816,2055040,2059264,17214976,67200,4294901760,17477632,17526784,17379328,17428480,3,0
.long 6418432,6414336,6418432,287616,16,393220,106508,0,7373184,529792,14336,384,287936,133008,0,319752
.long 533888,57344,98560,9986048,2051840,2056064,2060288,17410048,67328,4294901760,17539072,17391616,17440768,17489920,3,0
.long 6410240,6414336,6418432,308096,24,393220,110604,0,7455104,529856,21504,384,308416,133012,0,323848
.long 533952,57472,98688,10047488,2052864,2057088,2061312,17411584,67456,4294901760,17403904,17453056,17502208,17551360,3,0
.long 6430720,6434816,6438912,901376,0,393236,32908,1,5899648,550144,0,384,901696,136336,0,311568
.long 554240,59392,36864,8880128,2070912,2075136,2079360,18761728,5632,4294901760,18989056,19038208,19087360,18939904,771,0
.long 6434816,6434816,6438912,921856,8,393236,37004,1,5981568,550208,7168,384,922176,136340,0,315664
.long 554304,59520,36992,8941568,2071936,2076160,2080384,18763264,5760,4294901760,19050496,19099648,18952192,19001344,771,0
.long 6438912,6434816,6438912,942336,16,393236,41100,1,6063488,550272,14336,384,942656,136848,0,319760
.long 554368,59392,37120,9003008,2072960,2077184,2081408,18958336,5888,4294901760,19111936,18964480,19013632,19062784,771,0
.long 6430720,6434816,6438912,962816,24,393236,45196,1,6145408,550336,21504,384,963136,136852,0,323856
.long 554432,59520,37248,9064448,2073984,2078208,2082432,18959872,6016,4294901760,18976768,19025920,19075072,19124224,771,0
.long 6451200,6455296,6459392,902016,32,393236,98444,0,7210368,550144,0,512,902336,136592,0,311576
.long 554240,59392,102400,9863168,2092032,2096256,2100480,18786304,71168,4294901760,18989056,19038208,19087360,18939904,3,0
.long 6455296,6455296,6459392,922496,40,393236,102540,0,7292288,550208,7168,512,922816,136596,0,315672
.long 554304,59520,102528,9924608,2093056,2097280,2101504,18787840,71296,4294901760,19050496,19099648,18952192,19001344,3,0
.long 6459392,6455296,6459392,942976,48,393236,106636,0,7374208,550272,14336,512,943296,137104,0,319768
.long 554368,59392,102656,9986048,2094080,2098304,2102528,18982912,71424,4294901760,19111936,18964480,19013632,19062784,3,0
.long 6451200,6455296,6459392,963456,56,393236,110732,0,7456128,550336,21504,512,963776,137108,0,323864
.long 554432,59520,102784,10047488,2095104,2099328,2103552,18984448,71552,4294901760,18976768,19025920,19075072,19124224,3,0
.long 6471680,6475776,6479872,1556736,32,393348,33036,1,5900672,570624,0,512,1557056,140432,0,311680
.long 574720,61440,40960,8880128,2113152,2117376,2121600,20334592,9728,4294901760,20561920,20611072,20660224,20512768,771,0
.long 6475776,6475776,6479872,1577216,40,393348,37132,1,5982592,570688,7168,512,1577536,140436,0,315776
.long 574784,61568,41088,8941568,2114176,2118400,2122624,20336128,9856,4294901760,20623360,20672512,20525056,20574208,771,0
.long 6479872,6475776,6479872,1597696,48,393348,41228,1,6064512,570752,14336,512,1598016,140944,0,319872
.long 574848,61440,41216,9003008,2115200,2119424,2123648,20531200,9984,4294901760,20684800,20537344,20586496,20635648,771,0
.long 6471680,6475776,6479872,1618176,56,393348,45324,1,6146432,570816,21504,512,1618496,140948,0,323968
.long 574912,61568,41344,9064448,2116224,2120448,2124672,20532736,10112,4294901760,20549632,20598784,20647936,20697088,771,0
.long 6492160,6496256,6500352,1557376,64,393348,98572,0,7211392,570624,0,640,1557696,140688,0,311688
.long 574720,61696,106496,9863168,2337024,2341248,2345472,20359168,75264,4294901760,20561920,20611072,20660224,20512768,3,0
.long 6496256,6496256,6500352,1577856,72,393348,102668,0,7293312,570688,7168,640,1578176,140692,0,315784
.long 574784,61824,106624,9924608,2338048,2342272,2346496,20360704,75392,4294901760,20623360,20672512,20525056,20574208,3,0
.long 6500352,6496256,6500352,1598336,80,393348,106764,0,7375232,570752,14336,640,1598656,141200,0,319880
.long 574848,61696,106752,9986048,2339072,2343296,2347520,20555776,75520,4294901760,20684800,20537344,20586496,20635648,3,0
.long 6492160,6496256,6500352,1618816,88,393348,110860,0,7457152,570816,21504,640,1619136,141204,0,323976
.long 574912,61824,106880,10047488,2340096,2344320,2348544,20557312,75648,4294901760,20549632,20598784,20647936,20697088,3,0
.long 6512640,6516736,6520832,2212096,64,393364,33164,1,5901696,591104,0,640,2212416,144528,0,311696
.long 595200,63744,45056,8880128,2358144,2362368,2366592,21907456,13824,4294901760,22134784,22183936,22233088,22085632,771,0
.long 6516736,6516736,6520832,2232576,72,393364,37260,1,5983616,591168,7168,640,2232896,144532,0,315792
.long 595264,63872,45184,8941568,2359168,2363392,2367616,21908992,13952,4294901760,22196224,22245376,22097920,22147072,771,0
.long 6520832,6516736,6520832,2253056,80,393364,41356,1,6065536,591232,14336,640,2253376,145040,0,319888
.long 595328,63744,45312,9003008,2360192,2364416,2368640,22104064,14080,4294901760,22257664,22110208,22159360,22208512,771,0
.long 6512640,6516736,6520832,2273536,88,393364,45452,1,6147456,591296,21504,640,2273856,145044,0,323984
.long 595392,63872,45440,9064448,2361216,2365440,2369664,22105600,14208,4294901760,22122496,22171648,22220800,22269952,771,0
.long 6533120,6537216,6541312,2212736,96,393364,98700,0,7212416,591104,0,768,2213056,144784,0,311704
.long 595200,63744,110592,9863168,2379264,2383488,2387712,21932032,79360,4294901760,22134784,22183936,22233088,22085632,3,0
.long 6537216,6537216,6541312,2233216,104,393364,102796,0,7294336,591168,7168,768,2233536,144788,0,315800
.long 595264,63872,110720,9924608,2380288,2384512,2388736,21933568,79488,4294901760,22196224,22245376,22097920,22147072,3,0
.long 6541312,6537216,6541312,2253696,112,393364,106892,0,7376256,591232,14336,768,2254016,145296,0,319896
.long 595328,63744,110848,9986048,2381312,2385536,2389760,22128640,79616,4294901760,22257664,22110208,22159360,22208512,3,0
.long 6533120,6537216,6541312,2274176,120,393364,110988,0,7458176,591296,21504,768,2274496,145300,0,323992
.long 595392,63872,110976,10047488,2382336,2386560,2390784,22130176,79744,4294901760,22122496,22171648,22220800,22269952,3,0
.long 6402048,6406144,84377600,246144,0,393220,49164,1,6226304,529664,0,384,246368,132248,0,311556
.long 533760,57344,49152,9125888,2041344,2045568,83886080,17191936,1536,4294901760,17416192,17465344,17514496,17367040,771,0
.long 6406144,6406144,84377600,266624,8,393220,53260,1,6308224,529728,7168,384,266848,132252,0,315652
.long 533824,57472,49280,9187328,2042368,2046592,83886080,17193472,1664,4294901760,17477632,17526784,17379328,17428480,771,0
.long 84377600,6406144,84377600,287104,16,393220,57356,1,6390144,529792,14336,384,287328,132760,0,319748
.long 533888,57344,49408,9248768,2043392,2047616,83886080,17388544,1792,4294901760,17539072,17391616,17440768,17489920,771,0
.long 6402048,6406144,84377600,307584,24,393220,61452,1,6472064,529856,21504,384,307808,132764,0,323844
.long 533952,57472,49536,9310208,2044416,2048640,83886080,17390080,1920,4294901760,17403904,17453056,17502208,17551360,771,0
.long 6422528,6426624,84381696,246784,32,393220,114700,1,7537024,529664,0,512,247008,132504,0,311564
.long 533760,57344,114688,10108928,2062464,2066688,83886080,17216512,67072,4294901760,17416192,17465344,17514496,17367040,771,0
.long 6426624,6426624,84381696,267264,40,393220,118796,1,7618944,529728,7168,512,267488,132508,0,315660
.long 533824,57472,114816,10170368,2063488,2067712,83886080,17218048,67200,4294901760,17477632,17526784,17379328,17428480,771,0
.long 84381696,6426624,84381696,287744,48,393220,122892,1,7700864,529792,14336,512,287968,133016,0,319756
.long 533888,57344,114944,10231808,2064512,2068736,83886080,17413120,67328,4294901760,17539072,17391616,17440768,17489920,771,0
.long 6422528,6426624,84381696,308224,56,393220,126988,1,7782784,529856,21504,512,308448,133020,0,323852
.long 533952,57472,115072,10293248,2065536,2069760,83886080,17414656,67456,4294901760,17403904,17453056,17502208,17551360,771,0
.long 6443008,6447104,84385792,901504,32,393236,49292,1,6227328,550144,0,512,901728,136344,0,311572
.long 554240,59392,53248,9125888,2083584,2087808,83886080,18764800,5632,4294901760,18989056,19038208,19087360,18939904,771,0
.long 6447104,6447104,84385792,921984,40,393236,53388,1,6309248,550208,7168,512,922208,136348,0,315668
.long 554304,59520,53376,9187328,2084608,2088832,83886080,18766336,5760,4294901760,19050496,19099648,18952192,19001344,771,0
.long 84385792,6447104,84385792,942464,48,393236,57484,1,6391168,550272,14336,512,942688,136856,0,319764
.long 554368,59392,53504,9248768,2085632,2089856,83886080,18961408,5888,4294901760,19111936,18964480,19013632,19062784,771,0
.long 6443008,6447104,84385792,962944,56,393236,61580,1,6473088,550336,21504,512,963168,136860,0,323860
.long 554432,59520,53632,9310208,2086656,2090880,83886080,18962944,6016,4294901760,18976768,19025920,19075072,19124224,771,0
.long 6463488,6467584,84389888,902144,64,393236,114828,1,7538048,550144,0,640,902368,136600,0,311580
.long 554240,59392,118784,10108928,2104704,2108928,83886080,18789376,71168,4294901760,18989056,19038208,19087360,18939904,771,0
.long 6467584,6467584,84389888,922624,72,393236,118924,1,7619968,550208,7168,640,922848,136604,0,315676
.long 554304,59520,118912,10170368,2105728,2109952,83886080,18790912,71296,4294901760,19050496,19099648,18952192,19001344,771,0
.long 84389888,6467584,84389888,943104,80,393236,123020,1,7701888,550272,14336,640,943328,137112,0,319772
.long 554368,59392,119040,10231808,2106752,2110976,83886080,18985984,71424,4294901760,19111936,18964480,19013632,19062784,771,0
.long 6463488,6467584,84389888,963584,88,393236,127116,1,7783808,550336,21504,640,963808,137116,0,323868
.long 554432,59520,119168,10293248,2107776,2112000,83886080,18987520,71552,4294901760,18976768,19025920,19075072,19124224,771,0
.long 6483968,6488064,84393984,1556864,64,393348,49420,1,6228352,570624,0,640,1557088,140440,0,311684
.long 574720,61440,57344,9125888,2125824,2332800,83886080,20337664,9728,4294901760,20561920,20611072,20660224,20512768,771,0
.long 6488064,6488064,84393984,1577344,72,393348,53516,1,6310272,570688,7168,640,1577568,140444,0,315780
.long 574784,61568,57472,9187328,2126848,2333824,83886080,20339200,9856,4294901760,20623360,20672512,20525056,20574208,771,0
.long 84393984,6488064,84393984,1597824,80,393348,57612,1,6392192,570752,14336,640,1598048,140952,0,319876
.long 574848,61696,57600,9248768,2127872,2334848,83886080,20534272,9984,4294901760,20684800,20537344,20586496,20635648,771,0
.long 6483968,6488064,84393984,1618304,88,393348,61708,1,6474112,570816,21504,640,1618528,140956,0,323972
.long 574912,61824,57728,9310208,2128896,2335872,83886080,20535808,10112,4294901760,20549632,20598784,20647936,20697088,771,0
.long 6504448,6508544,84398080,1557504,96,393348,114956,1,7539072,570624,0,768,1557728,140696,0,311692
.long 574720,61696,122880,10108928,2349696,2353920,83886080,20362240,75264,4294901760,20561920,20611072,20660224,20512768,771,0
.long 6508544,6508544,84398080,1577984,104,393348,119052,1,7620992,570688,7168,768,1578208,140700,0,315788
.long 574784,61824,123008,10170368,2350720,2354944,83886080,20363776,75392,4294901760,20623360,20672512,20525056,20574208,771,0
.long 84398080,6508544,84398080,1598464,112,393348,123148,1,7702912,570752,14336,768,1598688,141208,0,319884
.long 574848,61696,123136,10231808,2351744,2355968,83886080,20558848,75520,4294901760,20684800,20537344,20586496,20635648,771,0
.long 6504448,6508544,84398080,1618944,120,393348,127244,1,7784832,570816,21504,768,1619168,141212,0,323980
.long 574912,61824,123264,10293248,2352768,2356992,83886080,20560384,75648,4294901760,20549632,20598784,20647936,20697088,771,0
.long 6524928,6529024,84402176,2212224,96,393364,49548,1,6229376,591104,0,768,2212448,144536,0,311700
.long 595200,63744,61440,9125888,2370816,2375040,83886080,21910528,13824,4294901760,22134784,22183936,22233088,22085632,771,0
.long 6529024,6529024,84402176,2232704,104,393364,53644,1,6311296,591168,7168,768,2232928,144540,0,315796
.long 595264,63872,61568,9187328,2371840,2376064,83886080,21912064,13952,4294901760,22196224,22245376,22097920,22147072,771,0
.long 84402176,6529024,84402176,2253184,112,393364,57740,1,6393216,591232,14336,768,2253408,145048,0,319892
.long 595328,63744,61696,9248768,2372864,2377088,83886080,22107136,14080,4294901760,22257664,22110208,22159360,22208512,771,0
.long 6524928,6529024,84402176,2273664,120,393364,61836,1,6475136,591296,21504,768,2273888,145052,0,323988
.long 595392,63872,61824,9310208,2373888,2378112,83886080,22108672,14208,4294901760,22122496,22171648,22220800,22269952,771,0
.long 6545408,6549504,84406272,2212864,24,393620,115084,1,7540096,591104,0,896,2213088,144792,0,311708
.long 595200,63744,126976,10108928,2391936,2396160,83886080,21935104,79360,4294901760,22134784,22183936,22233088,22085632,771,0
.long 6549504,6549504,84406272,2233344,56,393620,119180,1,7622016,591168,7168,896,2233568,144796,0,315804
.long 595264,63872,127104,10170368,2392960,2397184,83886080,21936640,79488,4294901760,22196224,22245376,22097920,22147072,771,0
.long 84406272,6549504,84406272,2253824,88,393620,123276,1,7703936,591232,14336,896,2254048,145304,0,319900
.long 595328,63744,127232,10231808,2393984,2398208,83886080,22131712,79616,4294901760,22257664,22110208,22159360,22208512,771,0
.long 6545408,6549504,84406272,2274304,120,393620,127372,1,7785856,591296,21504,896,2274528,145308,0,323996
.long 595392,63872,127360,10293248,2395008,2399232,83886080,22133248,79744,4294901760,22122496,22171648,22220800,22269952,771,0
.long 6553600,6557696,6561792,327680,128,393224,16,1,5243392,534528,0,1024,328192,133120,0,327680
.long 538624,65536,2048,8388608,2400384,2404608,2408832,17563648,2048,4294901760,17612800,17661952,17711104,17563648,771,0
.long 6557696,6557696,6561792,348160,136,393224,4112,1,5325312,534592,7168,1024,348672,133124,0,331776
.long 538688,65664,2176,8450048,2401408,2405632,2409856,17565184,2176,4294901760,17674240,17723392,17575936,17625088,771,0
.long 6561792,6557696,6561792,368640,144,393224,8208,1,5407232,534656,14336,1024,369152,133632,0,335872
.long 538752,65536,2304,8511488,2402432,2406656,2410880,17760256,2304,4294901760,17735680,17588224,17637376,17686528,771,0
.long 6553600,6557696,6561792,389120,152,393224,12304,1,5489152,534720,21504,1024,389632,133636,0,339968
.long 538816,65664,2432,8572928,2403456,2407680,2411904,17761792,2432,4294901760,17600512,17649664,17698816,17747968,771,0
.long 6574080,6578176,6582272,328320,160,393224,65552,0,6554112,534528,0,1152,328832,133376,0,327688
.long 538624,65536,67584,9371648,2421504,2425728,2429952,17588224,67584,4294901760,17612800,17661952,17711104,17563648,3,0
.long 6578176,6578176,6582272,348800,168,393224,69648,0,6636032,534592,7168,1152,349312,133380,0,331784
.long 538688,65664,67712,9433088,2422528,2426752,2430976,17589760,67712,4294901760,17674240,17723392,17575936,17625088,3,0
.long 6582272,6578176,6582272,369280,176,393224,73744,0,6717952,534656,14336,1152,369792,133888,0,335880
.long 538752,65536,67840,9494528,2423552,2427776,2432000,17784832,67840,4294901760,17735680,17588224,17637376,17686528,3,0
.long 6574080,6578176,6582272,389760,184,393224,77840,0,6799872,534720,21504,1152,390272,133892,0,339976
.long 538816,65664,67968,9555968,2424576,2428800,2433024,17786368,67968,4294901760,17600512,17649664,17698816,17747968,3,0
.long 6594560,6598656,6602752,983040,160,393240,144,1,5244416,555008,0,1152,983552,137216,0,327696
.long 559104,67584,6144,8388608,2442624,2446848,2451072,19136512,6144,4294901760,19185664,19234816,19283968,19136512,771,0
.long 6598656,6598656,6602752,1003520,168,393240,4240,1,5326336,555072,7168,1152,1004032,137220,0,331792
.long 559168,67712,6272,8450048,2443648,2447872,2452096,19138048,6272,4294901760,19247104,19296256,19148800,19197952,771,0
.long 6602752,6598656,6602752,1024000,176,393240,8336,1,5408256,555136,14336,1152,1024512,137728,0,335888
.long 559232,67584,6400,8511488,2444672,2448896,2453120,19333120,6400,4294901760,19308544,19161088,19210240,19259392,771,0
.long 6594560,6598656,6602752,1044480,184,393240,12432,1,5490176,555200,21504,1152,1044992,137732,0,339984
.long 559296,67712,6528,8572928,2445696,2449920,2454144,19334656,6528,4294901760,19173376,19222528,19271680,19320832,771,0
.long 6615040,6619136,6623232,983680,192,393240,65680,0,6555136,555008,0,0,984192,137472,0,327704
.long 559104,67584,71680,9371648,2463744,2467968,2472192,19161088,71680,4294901760,19185664,19234816,19283968,19136512,3,0
.long 6619136,6619136,6623232,1004160,200,393240,69776,0,6637056,555072,7168,0,1004672,137476,0,331800
.long 559168,67712,71808,9433088,2464768,2468992,2473216,19162624,71808,4294901760,19247104,19296256,19148800,19197952,3,0
.long 6623232,6619136,6623232,1024640,208,393240,73872,0,6718976,555136,14336,0,1025152,137984,0,335896
.long 559232,67584,71936,9494528,2465792,2470016,2474240,19357696,71936,4294901760,19308544,19161088,19210240,19259392,3,0
.long 6615040,6619136,6623232,1045120,216,393240,77968,0,6800896,555200,21504,0,1045632,137988,0,339992
.long 559296,67712,72064,9555968,2466816,2471040,2475264,19359232,72064,4294901760,19173376,19222528,19271680,19320832,3,0
.long 6635520,6639616,6643712,1638400,192,393352,272,1,5245440,575488,0,0,1638912,141312,0,327808
.long 579584,69632,10240,8388608,2484864,2489088,2493312,20709376,10240,4294901760,20758528,20807680,20856832,20709376,771,0
.long 6639616,6639616,6643712,1658880,200,393352,4368,1,5327360,575552,7168,0,1659392,141316,0,331904
.long 579648,69760,10368,8450048,2485888,2490112,2494336,20710912,10368,4294901760,20819968,20869120,20721664,20770816,771,0
.long 6643712,6639616,6643712,1679360,208,393352,8464,1,5409280,575616,14336,0,1679872,141824,0,336000
.long 579712,69632,10496,8511488,2486912,2491136,2495360,20905984,10496,4294901760,20881408,20733952,20783104,20832256,771,0
.long 6635520,6639616,6643712,1699840,216,393352,12560,1,5491200,575680,21504,0,1700352,141828,0,340096
.long 579776,69760,10624,8572928,2487936,2492160,2496384,20907520,10624,4294901760,20746240,20795392,20844544,20893696,771,0
.long 6656000,6660096,6664192,1639040,224,393352,65808,0,6556160,575488,0,128,1639552,141568,0,327816
.long 579584,69632,75776,9371648,2505984,2510208,2514432,20733952,75776,4294901760,20758528,20807680,20856832,20709376,3,0
.long 6660096,6660096,6664192,1659520,232,393352,69904,0,6638080,575552,7168,128,1660032,141572,0,331912
.long 579648,69760,75904,9433088,2507008,2511232,2515456,20735488,75904,4294901760,20819968,20869120,20721664,20770816,3,0
.long 6664192,6660096,6664192,1680000,240,393352,74000,0,6720000,575616,14336,128,1680512,142080,0,336008
.long 579712,69632,76032,9494528,2508032,2512256,2516480,20930560,76032,4294901760,20881408,20733952,20783104,20832256,3,0
.long 6656000,6660096,6664192,1700480,248,393352,78096,0,6801920,575680,21504,128,1700992,142084,0,340104
.long 579776,69760,76160,9555968,2509056,2513280,2517504,20932096,76160,4294901760,20746240,20795392,20844544,20893696,3,0
.long 6676480,6680576,6684672,2293760,224,393368,400,1,5246464,595968,0,128,2294272,145408,0,327824
.long 600064,71680,14336,8388608,2527104,2531328,2535552,22282240,14336,4294901760,22331392,22380544,22429696,22282240,771,0
.long 6680576,6680576,6684672,2314240,232,393368,4496,1,5328384,596032,7168,128,2314752,145412,0,331920
.long 600128,71808,14464,8450048,2528128,2532352,2536576,22283776,14464,4294901760,22392832,22441984,22294528,22343680,771,0
.long 6684672,6680576,6684672,2334720,240,393368,8592,1,5410304,596096,14336,128,2335232,145920,0,336016
.long 600192,71680,14592,8511488,2529152,2533376,2537600,22478848,14592,4294901760,22454272,22306816,22355968,22405120,771,0
.long 6676480,6680576,6684672,2355200,248,393368,12688,1,5492224,596160,21504,128,2355712,145924,0,340112
.long 600256,71808,14720,8572928,2530176,2534400,2538624,22480384,14720,4294901760,22319104,22368256,22417408,22466560,771,0
.long 6696960,6701056,6705152,2294400,152,393624,65936,0,6557184,595968,0,256,2294912,145664,0,327832
.long 600064,71680,79872,9371648,2548224,2552448,2556672,22306816,79872,4294901760,22331392,22380544,22429696,22282240,3,0
.long 6701056,6701056,6705152,2314880,184,393624,70032,0,6639104,596032,7168,256,2315392,145668,0,331928
.long 600128,71808,80000,9433088,2549248,2553472,2557696,22308352,80000,4294901760,22392832,22441984,22294528,22343680,3,0
.long 6705152,6701056,6705152,2335360,216,393624,74128,0,6721024,596096,14336,256,2335872,146176,0,336024
.long 600192,71680,80128,9494528,2550272,2554496,2558720,22503424,80128,4294901760,22454272,22306816,22355968,22405120,3,0
.long 6696960,6701056,6705152,2355840,248,393624,78224,0,6802944,596160,21504,256,2356352,146180,0,340120
.long 600256,71808,80256,9555968,2551296,2555520,2559744,22504960,80256,4294901760,22319104,22368256,22417408,22466560,3,0
.long 6565888,6569984,84443136,327808,160,393224,16400,1,5571072,534528,0,1152,328224,133128,0,327684
.long 538624,65536,18432,8634368,2413056,2417280,83886080,17566720,2048,4294901760,17612800,17661952,17711104,17563648,771,0
.long 6569984,6569984,84443136,348288,168,393224,20496,1,5652992,534592,7168,1152,348704,133132,0,331780
.long 538688,65664,18560,8695808,2414080,2418304,83886080,17568256,2176,4294901760,17674240,17723392,17575936,17625088,771,0
.long 84443136,6569984,84443136,368768,176,393224,24592,1,5734912,534656,14336,1152,369184,133640,0,335876
.long 538752,65536,18688,8757248,2415104,2419328,83886080,17763328,2304,4294901760,17735680,17588224,17637376,17686528,771,0
.long 6565888,6569984,84443136,389248,184,393224,28688,1,5816832,534720,21504,1152,389664,133644,0,339972
.long 538816,65664,18816,8818688,2416128,2420352,83886080,17764864,2432,4294901760,17600512,17649664,17698816,17747968,771,0
.long 6586368,6590464,84447232,328448,192,393224,81936,0,6881792,534528,0,0,328864,133384,0,327692
.long 538624,65536,83968,9617408,2434176,2438400,83886080,17591296,67584,4294901760,17612800,17661952,17711104,17563648,3,0
.long 6590464,6590464,84447232,348928,200,393224,86032,0,6963712,534592,7168,0,349344,133388,0,331788
.long 538688,65664,84096,9678848,2435200,2439424,83886080,17592832,67712,4294901760,17674240,17723392,17575936,17625088,3,0
.long 84447232,6590464,84447232,369408,208,393224,90128,0,7045632,534656,14336,0,369824,133896,0,335884
.long 538752,65536,84224,9740288,2436224,2440448,83886080,17787904,67840,4294901760,17735680,17588224,17637376,17686528,3,0
.long 6586368,6590464,84447232,389888,216,393224,94224,0,7127552,534720,21504,0,390304,133900,0,339980
.long 538816,65664,84352,9801728,2437248,2441472,83886080,17789440,67968,4294901760,17600512,17649664,17698816,17747968,3,0
.long 6606848,6610944,84451328,983168,192,393240,16528,1,5572096,555008,0,0,983584,137224,0,327700
.long 559104,67584,22528,8634368,2455296,2459520,83886080,19139584,6144,4294901760,19185664,19234816,19283968,19136512,771,0
.long 6610944,6610944,84451328,1003648,200,393240,20624,1,5654016,555072,7168,0,1004064,137228,0,331796
.long 559168,67712,22656,8695808,2456320,2460544,83886080,19141120,6272,4294901760,19247104,19296256,19148800,19197952,771,0
.long 84451328,6610944,84451328,1024128,208,393240,24720,1,5735936,555136,14336,0,1024544,137736,0,335892
.long 559232,67584,22784,8757248,2457344,2461568,83886080,19336192,6400,4294901760,19308544,19161088,19210240,19259392,771,0
.long 6606848,6610944,84451328,1044608,216,393240,28816,1,5817856,555200,21504,0,1045024,137740,0,339988
.long 559296,67712,22912,8818688,2458368,2462592,83886080,19337728,6528,4294901760,19173376,19222528,19271680,19320832,771,0
.long 6627328,6631424,84455424,983808,224,393240,82064,0,6882816,555008,0,128,984224,137480,0,327708
.long 559104,67584,88064,9617408,2476416,2480640,83886080,19164160,71680,4294901760,19185664,19234816,19283968,19136512,3,0
.long 6631424,6631424,84455424,1004288,232,393240,86160,0,6964736,555072,7168,128,1004704,137484,0,331804
.long 559168,67712,88192,9678848,2477440,2481664,83886080,19165696,71808,4294901760,19247104,19296256,19148800,19197952,3,0
.long 84455424,6631424,84455424,1024768,240,393240,90256,0,7046656,555136,14336,128,1025184,137992,0,335900
.long 559232,67584,88320,9740288,2478464,2482688,83886080,19360768,71936,4294901760,19308544,19161088,19210240,19259392,3,0
.long 6627328,6631424,84455424,1045248,248,393240,94352,0,7128576,555200,21504,128,1045664,137996,0,339996
.long 559296,67712,88448,9801728,2479488,2483712,83886080,19362304,72064,4294901760,19173376,19222528,19271680,19320832,3,0
.long 6647808,6651904,84459520,1638528,224,393352,16656,1,5573120,575488,0,128,1638944,141320,0,327812
.long 579584,69632,26624,8634368,2497536,2501760,83886080,20712448,10240,4294901760,20758528,20807680,20856832,20709376,771,0
.long 6651904,6651904,84459520,1659008,232,393352,20752,1,5655040,575552,7168,128,1659424,141324,0,331908
.long 579648,69760,26752,8695808,2498560,2502784,83886080,20713984,10368,4294901760,20819968,20869120,20721664,20770816,771,0
.long 84459520,6651904,84459520,1679488,240,393352,24848,1,5736960,575616,14336,128,1679904,141832,0,336004
.long 579712,69632,26880,8757248,2499584,2503808,83886080,20909056,10496,4294901760,20881408,20733952,20783104,20832256,771,0
.long 6647808,6651904,84459520,1699968,248,393352,28944,1,5818880,575680,21504,128,1700384,141836,0,340100
.long 579776,69760,27008,8818688,2500608,2504832,83886080,20910592,10624,4294901760,20746240,20795392,20844544,20893696,771,0
.long 6668288,6672384,84463616,1639168,152,393608,82192,0,6883840,575488,0,256,1639584,141576,0,327820
.long 579584,69632,92160,9617408,2518656,2522880,83886080,20737024,75776,4294901760,20758528,20807680,20856832,20709376,3,0
.long 6672384,6672384,84463616,1659648,184,393608,86288,0,6965760,575552,7168,256,1660064,141580,0,331916
.long 579648,69760,92288,9678848,2519680,2523904,83886080,20738560,75904,4294901760,20819968,20869120,20721664,20770816,3,0
.long 84463616,6672384,84463616,1680128,216,393608,90384,0,7047680,575616,14336,256,1680544,142088,0,336012
.long 579712,69632,92416,9740288,2520704,2524928,83886080,20933632,76032,4294901760,20881408,20733952,20783104,20832256,3,0
.long 6668288,6672384,84463616,1700608,248,393608,94480,0,7129600,575680,21504,256,1701024,142092,0,340108
.long 579776,69760,92544,9801728,2521728,2525952,83886080,20935168,76160,4294901760,20746240,20795392,20844544,20893696,3,0
.long 6688768,6692864,84467712,2293888,152,393624,16784,1,5574144,595968,0,256,2294304,145416,0,327828
.long 600064,71680,30720,8634368,2539776,2544000,83886080,22285312,14336,4294901760,22331392,22380544,22429696,22282240,771,0
.long 6692864,6692864,84467712,2314368,184,393624,20880,1,5656064,596032,7168,256,2314784,145420,0,331924
.long 600128,71808,30848,8695808,2540800,2545024,83886080,22286848,14464,4294901760,22392832,22441984,22294528,22343680,771,0
.long 84467712,6692864,84467712,2334848,216,393624,24976,1,5737984,596096,14336,256,2335264,145928,0,336020
.long 600192,71680,30976,8757248,2541824,2546048,83886080,22481920,14592,4294901760,22454272,22306816,22355968,22405120,771,0
.long 6688768,6692864,84467712,2355328,248,393624,29072,1,5819904,596160,21504,256,2355744,145932,0,340116
.long 600256,71808,31104,8818688,2542848,2547072,83886080,22483456,14720,4294901760,22319104,22368256,22417408,22466560,771,0
.long 6709248,6713344,84471808,2294528,0,393368,82320,0,6884864,595968,0,384,2294944,145672,0,327836
.long 600064,71680,96256,9617408,2560896,2565120,83886080,22309888,79872,4294901760,22331392,22380544,22429696,22282240,3,0
.long 6713344,6713344,84471808,2315008,8,393368,86416,0,6966784,596032,7168,384,2315424,145676,0,331932
.long 600128,71808,96384,9678848,2561920,2566144,83886080,22311424,80000,4294901760,22392832,22441984,22294528,22343680,3,0
.long 84471808,6713344,84471808,2335488,16,393368,90512,0,7048704,596096,14336,384,2335904,146184,0,336028
.long 600192,71680,96512,9740288,2562944,2567168,83886080,22506496,80128,4294901760,22454272,22306816,22355968,22405120,3,0
.long 6709248,6713344,84471808,2355968,24,393368,94608,0,7130624,596160,21504,384,2356384,146188,0,340124
.long 600256,71808,96640,9801728,2563968,2568192,83886080,22508032,80256,4294901760,22319104,22368256,22417408,22466560,3,0
.long 6717440,6721536,6725632,327936,192,393224,32784,1,5898752,534528,0,0,328256,133136,0,327936
.long 538624,73728,34816,8880128,2569344,2573568,2577792,17569792,2048,4294901760,17612800,17661952,17711104,17563648,771,0
.long 6721536,6721536,6725632,348416,200,393224,36880,1,5980672,534592,7168,0,348736,133140,0,332032
.long 538688,73856,34944,8941568,2570368,2574592,2578816,17571328,2176,4294901760,17674240,17723392,17575936,17625088,771,0
.long 6725632,6721536,6725632,368896,208,393224,40976,1,6062592,534656,14336,0,369216,133648,0,336128
.long 538752,73728,35072,9003008,2571392,2575616,2579840,17766400,2304,4294901760,17735680,17588224,17637376,17686528,771,0
.long 6717440,6721536,6725632,389376,216,393224,45072,1,6144512,534720,21504,0,389696,133652,0,340224
.long 538816,73856,35200,9064448,2572416,2576640,2580864,17767936,2432,4294901760,17600512,17649664,17698816,17747968,771,0
.long 6737920,6742016,6746112,328576,224,393224,98320,0,7209472,534528,0,128,328896,133392,0,327944
.long 538624,73728,100352,9863168,2590464,2594688,2598912,17594368,67584,4294901760,17612800,17661952,17711104,17563648,3,0
.long 6742016,6742016,6746112,349056,232,393224,102416,0,7291392,534592,7168,128,349376,133396,0,332040
.long 538688,73856,100480,9924608,2591488,2595712,2599936,17595904,67712,4294901760,17674240,17723392,17575936,17625088,3,0
.long 6746112,6742016,6746112,369536,240,393224,106512,0,7373312,534656,14336,128,369856,133904,0,336136
.long 538752,73728,100608,9986048,2592512,2596736,2600960,17790976,67840,4294901760,17735680,17588224,17637376,17686528,3,0
.long 6737920,6742016,6746112,390016,248,393224,110608,0,7455232,534720,21504,128,390336,133908,0,340232
.long 538816,73856,100736,10047488,2593536,2597760,2601984,17792512,67968,4294901760,17600512,17649664,17698816,17747968,3,0
.long 6758400,6762496,6766592,983296,224,393240,32912,1,5899776,555008,0,128,983616,137232,0,327952
.long 559104,75776,38912,8880128,2611584,2615808,2620032,19142656,6144,4294901760,19185664,19234816,19283968,19136512,771,0
.long 6762496,6762496,6766592,1003776,232,393240,37008,1,5981696,555072,7168,128,1004096,137236,0,332048
.long 559168,75904,39040,8941568,2612608,2616832,2621056,19144192,6272,4294901760,19247104,19296256,19148800,19197952,771,0
.long 6766592,6762496,6766592,1024256,240,393240,41104,1,6063616,555136,14336,128,1024576,137744,0,336144
.long 559232,75776,39168,9003008,2613632,2617856,2622080,19339264,6400,4294901760,19308544,19161088,19210240,19259392,771,0
.long 6758400,6762496,6766592,1044736,248,393240,45200,1,6145536,555200,21504,128,1045056,137748,0,340240
.long 559296,75904,39296,9064448,2614656,2618880,2623104,19340800,6528,4294901760,19173376,19222528,19271680,19320832,771,0
.long 6778880,6782976,6787072,983936,152,393496,98448,0,7210496,555008,0,256,984256,137488,0,327960
.long 559104,75776,104448,9863168,2632704,2636928,2641152,19167232,71680,4294901760,19185664,19234816,19283968,19136512,3,0
.long 6782976,6782976,6787072,1004416,184,393496,102544,0,7292416,555072,7168,256,1004736,137492,0,332056
.long 559168,75904,104576,9924608,2633728,2637952,2642176,19168768,71808,4294901760,19247104,19296256,19148800,19197952,3,0
.long 6787072,6782976,6787072,1024896,216,393496,106640,0,7374336,555136,14336,256,1025216,138000,0,336152
.long 559232,75776,104704,9986048,2634752,2638976,2643200,19363840,71936,4294901760,19308544,19161088,19210240,19259392,3,0
.long 6778880,6782976,6787072,1045376,248,393496,110736,0,7456256,555200,21504,256,1045696,138004,0,340248
.long 559296,75904,104832,10047488,2635776,2640000,2644224,19365376,72064,4294901760,19173376,19222528,19271680,19320832,3,0
.long 6799360,6803456,6807552,1638656,152,393608,33040,1,5900800,575488,0,256,1638976,141328,0,328064
.long 579584,77824,43008,8880128,2653824,2658048,2662272,20715520,10240,4294901760,20758528,20807680,20856832,20709376,771,0
.long 6803456,6803456,6807552,1659136,184,393608,37136,1,5982720,575552,7168,256,1659456,141332,0,332160
.long 579648,77952,43136,8941568,2654848,2659072,2663296,20717056,10368,4294901760,20819968,20869120,20721664,20770816,771,0
.long 6807552,6803456,6807552,1679616,216,393608,41232,1,6064640,575616,14336,256,1679936,141840,0,336256
.long 579712,77824,43264,9003008,2655872,2660096,2664320,20912128,10496,4294901760,20881408,20733952,20783104,20832256,771,0
.long 6799360,6803456,6807552,1700096,248,393608,45328,1,6146560,575680,21504,256,1700416,141844,0,340352
.long 579776,77952,43392,9064448,2656896,2661120,2665344,20913664,10624,4294901760,20746240,20795392,20844544,20893696,771,0
.long 6819840,6823936,6828032,1639296,0,393352,98576,0,7211520,575488,0,384,1639616,141584,0,328072
.long 579584,78080,108544,9863168,3485952,3490176,3494400,20740096,75776,4294901760,20758528,20807680,20856832,20709376,3,0
.long 6823936,6823936,6828032,1659776,8,393352,102672,0,7293440,575552,7168,384,1660096,141588,0,332168
.long 579648,78208,108672,9924608,3486976,3491200,3495424,20741632,75904,4294901760,20819968,20869120,20721664,20770816,3,0
.long 6828032,6823936,6828032,1680256,16,393352,106768,0,7375360,575616,14336,384,1680576,142096,0,336264
.long 579712,78080,108800,9986048,3488000,3492224,3496448,20936704,76032,4294901760,20881408,20733952,20783104,20832256,3,0
.long 6819840,6823936,6828032,1700736,24,393352,110864,0,7457280,575680,21504,384,1701056,142100,0,340360
.long 579776,78208,108928,10047488,3489024,3493248,3497472,20938240,76160,4294901760,20746240,20795392,20844544,20893696,3,0
.long 6840320,6844416,6848512,2294016,0,393368,33168,1,5901824,595968,0,384,2294336,145424,0,328080
.long 600064,80128,47104,8880128,3507072,3511296,3515520,22288384,14336,4294901760,22331392,22380544,22429696,22282240,771,0
.long 6844416,6844416,6848512,2314496,8,393368,37264,1,5983744,596032,7168,384,2314816,145428,0,332176
.long 600128,80256,47232,8941568,3508096,3512320,3516544,22289920,14464,4294901760,22392832,22441984,22294528,22343680,771,0
.long 6848512,6844416,6848512,2334976,16,393368,41360,1,6065664,596096,14336,384,2335296,145936,0,336272
.long 600192,80128,47360,9003008,3509120,3513344,3517568,22484992,14592,4294901760,22454272,22306816,22355968,22405120,771,0
.long 6840320,6844416,6848512,2355456,24,393368,45456,1,6147584,596160,21504,384,2355776,145940,0,340368
.long 600256,80256,47488,9064448,3510144,3514368,3518592,22486528,14720,4294901760,22319104,22368256,22417408,22466560,771,0
.long 6860800,6864896,6868992,2294656,32,393368,98704,0,7212544,595968,0,512,2294976,145680,0,328088
.long 600064,80128,112640,9863168,3528192,3532416,3536640,22312960,79872,4294901760,22331392,22380544,22429696,22282240,3,0
.long 6864896,6864896,6868992,2315136,40,393368,102800,0,7294464,596032,7168,512,2315456,145684,0,332184
.long 600128,80256,112768,9924608,3529216,3533440,3537664,22314496,80000,4294901760,22392832,22441984,22294528,22343680,3,0
.long 6868992,6864896,6868992,2335616,48,393368,106896,0,7376384,596096,14336,512,2335936,146192,0,336280
.long 600192,80128,112896,9986048,3530240,3534464,3538688,22509568,80128,4294901760,22454272,22306816,22355968,22405120,3,0
.long 6860800,6864896,6868992,2356096,56,393368,110992,0,7458304,596160,21504,512,2356416,146196,0,340376
.long 600256,80256,113024,10047488,3531264,3535488,3539712,22511104,80256,4294901760,22319104,22368256,22417408,22466560,3,0
.long 6729728,6733824,84508672,328064,224,393224,49168,1,6226432,534528,0,128,328288,133144,0,327940
.long 538624,73728,51200,9125888,2582016,2586240,83886080,17572864,2048,4294901760,17612800,17661952,17711104,17563648,771,0
.long 6733824,6733824,84508672,348544,232,393224,53264,1,6308352,534592,7168,128,348768,133148,0,332036
.long 538688,73856,51328,9187328,2583040,2587264,83886080,17574400,2176,4294901760,17674240,17723392,17575936,17625088,771,0
.long 84508672,6733824,84508672,369024,240,393224,57360,1,6390272,534656,14336,128,369248,133656,0,336132
.long 538752,73728,51456,9248768,2584064,2588288,83886080,17769472,2304,4294901760,17735680,17588224,17637376,17686528,771,0
.long 6729728,6733824,84508672,389504,248,393224,61456,1,6472192,534720,21504,128,389728,133660,0,340228
.long 538816,73856,51584,9310208,2585088,2589312,83886080,17771008,2432,4294901760,17600512,17649664,17698816,17747968,771,0
.long 6750208,6754304,84512768,328704,152,393480,114704,1,7537152,534528,0,256,328928,133400,0,327948
.long 538624,73728,116736,10108928,2603136,2607360,83886080,17597440,67584,4294901760,17612800,17661952,17711104,17563648,771,0
.long 6754304,6754304,84512768,349184,184,393480,118800,1,7619072,534592,7168,256,349408,133404,0,332044
.long 538688,73856,116864,10170368,2604160,2608384,83886080,17598976,67712,4294901760,17674240,17723392,17575936,17625088,771,0
.long 84512768,6754304,84512768,369664,216,393480,122896,1,7700992,534656,14336,256,369888,133912,0,336140
.long 538752,73728,116992,10231808,2605184,2609408,83886080,17794048,67840,4294901760,17735680,17588224,17637376,17686528,771,0
.long 6750208,6754304,84512768,390144,248,393480,126992,1,7782912,534720,21504,256,390368,133916,0,340236
.long 538816,73856,117120,10293248,2606208,2610432,83886080,17795584,67968,4294901760,17600512,17649664,17698816,17747968,771,0
.long 6770688,6774784,84516864,983424,152,393496,49296,1,6227456,555008,0,256,983648,137240,0,327956
.long 559104,75776,55296,9125888,2624256,2628480,83886080,19145728,6144,4294901760,19185664,19234816,19283968,19136512,771,0
.long 6774784,6774784,84516864,1003904,184,393496,53392,1,6309376,555072,7168,256,1004128,137244,0,332052
.long 559168,75904,55424,9187328,2625280,2629504,83886080,19147264,6272,4294901760,19247104,19296256,19148800,19197952,771,0
.long 84516864,6774784,84516864,1024384,216,393496,57488,1,6391296,555136,14336,256,1024608,137752,0,336148
.long 559232,75776,55552,9248768,2626304,2630528,83886080,19342336,6400,4294901760,19308544,19161088,19210240,19259392,771,0
.long 6770688,6774784,84516864,1044864,248,393496,61584,1,6473216,555200,21504,256,1045088,137756,0,340244
.long 559296,75904,55680,9310208,2627328,2631552,83886080,19343872,6528,4294901760,19173376,19222528,19271680,19320832,771,0
.long 6791168,6795264,84520960,984064,0,393240,114832,1,7538176,555008,0,384,984288,137496,0,327964
.long 559104,75776,120832,10108928,2645376,2649600,83886080,19170304,71680,4294901760,19185664,19234816,19283968,19136512,771,0
.long 6795264,6795264,84520960,1004544,8,393240,118928,1,7620096,555072,7168,384,1004768,137500,0,332060
.long 559168,75904,120960,10170368,2646400,2650624,83886080,19171840,71808,4294901760,19247104,19296256,19148800,19197952,771,0
.long 84520960,6795264,84520960,1025024,16,393240,123024,1,7702016,555136,14336,384,1025248,138008,0,336156
.long 559232,75776,121088,10231808,2647424,2651648,83886080,19366912,71936,4294901760,19308544,19161088,19210240,19259392,771,0
.long 6791168,6795264,84520960,1045504,24,393240,127120,1,7783936,555200,21504,384,1045728,138012,0,340252
.long 559296,75904,121216,10293248,2648448,2652672,83886080,19368448,72064,4294901760,19173376,19222528,19271680,19320832,771,0
.long 6811648,6815744,84525056,1638784,0,393352,49424,1,6228480,575488,0,384,1639008,141336,0,328068
.long 579584,77824,59392,9125888,2666496,3481728,83886080,20718592,10240,4294901760,20758528,20807680,20856832,20709376,771,0
.long 6815744,6815744,84525056,1659264,8,393352,53520,1,6310400,575552,7168,384,1659488,141340,0,332164
.long 579648,77952,59520,9187328,2667520,3482752,83886080,20720128,10368,4294901760,20819968,20869120,20721664,20770816,771,0
.long 84525056,6815744,84525056,1679744,16,393352,57616,1,6392320,575616,14336,384,1679968,141848,0,336260
.long 579712,78080,59648,9248768,2668544,3483776,83886080,20915200,10496,4294901760,20881408,20733952,20783104,20832256,771,0
.long 6811648,6815744,84525056,1700224,24,393352,61712,1,6474240,575680,21504,384,1700448,141852,0,340356
.long 579776,78208,59776,9310208,2669568,3484800,83886080,20916736,10624,4294901760,20746240,20795392,20844544,20893696,771,0
.long 6832128,6836224,84529152,1639424,32,393352,114960,1,7539200,575488,0,512,1639648,141592,0,328076
.long 579584,78080,124928,10108928,3498624,3502848,83886080,20743168,75776,4294901760,20758528,20807680,20856832,20709376,771,0
.long 6836224,6836224,84529152,1659904,40,393352,119056,1,7621120,575552,7168,512,1660128,141596,0,332172
.long 579648,78208,125056,10170368,3499648,3503872,83886080,20744704,75904,4294901760,20819968,20869120,20721664,20770816,771,0
.long 84529152,6836224,84529152,1680384,48,393352,123152,1,7703040,575616,14336,512,1680608,142104,0,336268
.long 579712,78080,125184,10231808,3500672,3504896,83886080,20939776,76032,4294901760,20881408,20733952,20783104,20832256,771,0
.long 6832128,6836224,84529152,1700864,56,393352,127248,1,7784960,575680,21504,512,1701088,142108,0,340364
.long 579776,78208,125312,10293248,3501696,3505920,83886080,20941312,76160,4294901760,20746240,20795392,20844544,20893696,771,0
.long 6852608,6856704,84533248,2294144,32,393368,49552,1,6229504,595968,0,512,2294368,145432,0,328084
.long 600064,80128,63488,9125888,3519744,3523968,83886080,22291456,14336,4294901760,22331392,22380544,22429696,22282240,771,0
.long 6856704,6856704,84533248,2314624,40,393368,53648,1,6311424,596032,7168,512,2314848,145436,0,332180
.long 600128,80256,63616,9187328,3520768,3524992,83886080,22292992,14464,4294901760,22392832,22441984,22294528,22343680,771,0
.long 84533248,6856704,84533248,2335104,48,393368,57744,1,6393344,596096,14336,512,2335328,145944,0,336276
.long 600192,80128,63744,9248768,3521792,3526016,83886080,22488064,14592,4294901760,22454272,22306816,22355968,22405120,771,0
.long 6852608,6856704,84533248,2355584,56,393368,61840,1,6475264,596160,21504,512,2355808,145948,0,340372
.long 600256,80256,63872,9310208,3522816,3527040,83886080,22489600,14720,4294901760,22319104,22368256,22417408,22466560,771,0
.long 6873088,6877184,84537344,2294784,64,393368,115088,1,7540224,595968,0,640,2295008,145688,0,328092
.long 600064,80128,129024,10108928,3540864,3545088,83886080,22316032,79872,4294901760,22331392,22380544,22429696,22282240,771,0
.long 6877184,6877184,84537344,2315264,72,393368,119184,1,7622144,596032,7168,640,2315488,145692,0,332188
.long 600128,80256,129152,10170368,3541888,3546112,83886080,22317568,80000,4294901760,22392832,22441984,22294528,22343680,771,0
.long 84537344,6877184,84537344,2335744,80,393368,123280,1,7704064,596096,14336,640,2335968,146200,0,336284
.long 600192,80128,129280,10231808,3542912,3547136,83886080,22512640,80128,4294901760,22454272,22306816,22355968,22405120,771,0
.long 6873088,6877184,84537344,2356224,88,393368,127376,1,7785984,596160,21504,640,2356448,146204,0,340380
.long 600256,80256,129408,10293248,3543936,3548160,83886080,22514176,80256,4294901760,22319104,22368256,22417408,22466560,771,0
.long 6881280,6885376,6889472,409600,0,393224,20,1,5243520,534784,0,384,410112,133248,0,344064
.long 538880,81920,2048,8388608,2670720,2674944,2679168,17575936,2560,4294901760,17809408,17858560,17907712,17760256,771,0
.long 6885376,6885376,6889472,430080,8,393224,4116,1,5325440,534848,7168,384,430592,133252,0,348160
.long 538944,82048,2176,8450048,2671744,2675968,2680192,17577472,2688,4294901760,17870848,17920000,17772544,17821696,771,0
.long 6889472,6885376,6889472,450560,16,393224,8212,1,5407360,534912,14336,384,451072,133760,0,352256
.long 539008,81920,2304,8511488,2672768,2676992,2681216,17772544,2816,4294901760,17932288,17784832,17833984,17883136,771,0
.long 6881280,6885376,6889472,471040,24,393224,12308,1,5489280,534976,21504,384,471552,133764,0,356352
.long 539072,82048,2432,8572928,2673792,2678016,2682240,17774080,2944,4294901760,17797120,17846272,17895424,17944576,771,0
.long 6901760,6905856,6909952,410240,32,393224,65556,0,6554240,534784,0,512,410752,133504,0,344072
.long 538880,81920,67584,9371648,2691840,2696064,2700288,17600512,68096,4294901760,17809408,17858560,17907712,17760256,3,0
.long 6905856,6905856,6909952,430720,40,393224,69652,0,6636160,534848,7168,512,431232,133508,0,348168
.long 538944,82048,67712,9433088,2692864,2697088,2701312,17602048,68224,4294901760,17870848,17920000,17772544,17821696,3,0
.long 6909952,6905856,6909952,451200,48,393224,73748,0,6718080,534912,14336,512,451712,134016,0,352264
.long 539008,81920,67840,9494528,2693888,2698112,2702336,17797120,68352,4294901760,17932288,17784832,17833984,17883136,3,0
.long 6901760,6905856,6909952,471680,56,393224,77844,0,6800000,534976,21504,512,472192,134020,0,356360
.long 539072,82048,67968,9555968,2694912,2699136,2703360,17798656,68480,4294901760,17797120,17846272,17895424,17944576,3,0
.long 6922240,6926336,6930432,1064960,32,393240,148,1,5244544,555264,0,512,1065472,137344,0,344080
.long 559360,83968,6144,8388608,2712960,2717184,2721408,19148800,6656,4294901760,19382272,19431424,19480576,19333120,771,0
.long 6926336,6926336,6930432,1085440,40,393240,4244,1,5326464,555328,7168,512,1085952,137348,0,348176
.long 559424,84096,6272,8450048,2713984,2718208,2722432,19150336,6784,4294901760,19443712,19492864,19345408,19394560,771,0
.long 6930432,6926336,6930432,1105920,48,393240,8340,1,5408384,555392,14336,512,1106432,137856,0,352272
.long 559488,83968,6400,8511488,2715008,2719232,2723456,19345408,6912,4294901760,19505152,19357696,19406848,19456000,771,0
.long 6922240,6926336,6930432,1126400,56,393240,12436,1,5490304,555456,21504,512,1126912,137860,0,356368
.long 559552,84096,6528,8572928,2716032,2720256,2724480,19346944,7040,4294901760,19369984,19419136,19468288,19517440,771,0
.long 6942720,6946816,6950912,1065600,64,393240,65684,0,6555264,555264,0,640,1066112,137600,0,344088
.long 559360,83968,71680,9371648,2734080,2738304,2742528,19173376,72192,4294901760,19382272,19431424,19480576,19333120,3,0
.long 6946816,6946816,6950912,1086080,72,393240,69780,0,6637184,555328,7168,640,1086592,137604,0,348184
.long 559424,84096,71808,9433088,2735104,2739328,2743552,19174912,72320,4294901760,19443712,19492864,19345408,19394560,3,0
.long 6950912,6946816,6950912,1106560,80,393240,73876,0,6719104,555392,14336,640,1107072,138112,0,352280
.long 559488,83968,71936,9494528,2736128,2740352,2744576,19369984,72448,4294901760,19505152,19357696,19406848,19456000,3,0
.long 6942720,6946816,6950912,1127040,88,393240,77972,0,6801024,555456,21504,640,1127552,138116,0,356376
.long 559552,84096,72064,9555968,2737152,2741376,2745600,19371520,72576,4294901760,19369984,19419136,19468288,19517440,3,0
.long 6963200,6967296,6971392,1720320,64,393352,276,1,5245568,575744,0,640,1720832,141440,0,344192
.long 579840,86016,10240,8388608,2755200,2759424,2763648,20721664,10752,4294901760,20955136,21004288,21053440,20905984,771,0
.long 6967296,6967296,6971392,1740800,72,393352,4372,1,5327488,575808,7168,640,1741312,141444,0,348288
.long 579904,86144,10368,8450048,2756224,2760448,2764672,20723200,10880,4294901760,21016576,21065728,20918272,20967424,771,0
.long 6971392,6967296,6971392,1761280,80,393352,8468,1,5409408,575872,14336,640,1761792,141952,0,352384
.long 579968,86016,10496,8511488,2757248,2761472,2765696,20918272,11008,4294901760,21078016,20930560,20979712,21028864,771,0
.long 6963200,6967296,6971392,1781760,88,393352,12564,1,5491328,575936,21504,640,1782272,141956,0,356480
.long 580032,86144,10624,8572928,2758272,2762496,2766720,20919808,11136,4294901760,20942848,20992000,21041152,21090304,771,0
.long 6983680,6987776,6991872,1720960,96,393352,65812,0,6556288,575744,0,768,1721472,141696,0,344200
.long 579840,86016,75776,9371648,2776320,2780544,2784768,20746240,76288,4294901760,20955136,21004288,21053440,20905984,3,0
.long 6987776,6987776,6991872,1741440,104,393352,69908,0,6638208,575808,7168,768,1741952,141700,0,348296
.long 579904,86144,75904,9433088,2777344,2781568,2785792,20747776,76416,4294901760,21016576,21065728,20918272,20967424,3,0
.long 6991872,6987776,6991872,1761920,112,393352,74004,0,6720128,575872,14336,768,1762432,142208,0,352392
.long 579968,86016,76032,9494528,2778368,2782592,2786816,20942848,76544,4294901760,21078016,20930560,20979712,21028864,3,0
.long 6983680,6987776,6991872,1782400,120,393352,78100,0,6802048,575936,21504,768,1782912,142212,0,356488
.long 580032,86144,76160,9555968,2779392,2783616,2787840,20944384,76672,4294901760,20942848,20992000,21041152,21090304,3,0
.long 7004160,7008256,7012352,2375680,96,393368,404,1,5246592,596224,0,768,2376192,145536,0,344208
.long 600320,88064,14336,8388608,2797440,2801664,2805888,22294528,14848,4294901760,22528000,22577152,22626304,22478848,771,0
.long 7008256,7008256,7012352,2396160,104,393368,4500,1,5328512,596288,7168,768,2396672,145540,0,348304
.long 600384,88192,14464,8450048,2798464,2802688,2806912,22296064,14976,4294901760,22589440,22638592,22491136,22540288,771,0
.long 7012352,7008256,7012352,2416640,112,393368,8596,1,5410432,596352,14336,768,2417152,146048,0,352400
.long 600448,88064,14592,8511488,2799488,2803712,2807936,22491136,15104,4294901760,22650880,22503424,22552576,22601728,771,0
.long 7004160,7008256,7012352,2437120,120,393368,12692,1,5492352,596416,21504,768,2437632,146052,0,356496
.long 600512,88192,14720,8572928,2800512,2804736,2808960,22492672,15232,4294901760,22515712,22564864,22614016,22663168,771,0
.long 7024640,7028736,7032832,2376320,24,393624,65940,0,6557312,596224,0,896,2376832,145792,0,344216
.long 600320,88064,79872,9371648,2818560,2822784,2827008,22319104,80384,4294901760,22528000,22577152,22626304,22478848,3,0
.long 7028736,7028736,7032832,2396800,56,393624,70036,0,6639232,596288,7168,896,2397312,145796,0,348312
.long 600384,88192,80000,9433088,2819584,2823808,2828032,22320640,80512,4294901760,22589440,22638592,22491136,22540288,3,0
.long 7032832,7028736,7032832,2417280,88,393624,74132,0,6721152,596352,14336,896,2417792,146304,0,352408
.long 600448,88064,80128,9494528,2820608,2824832,2829056,22515712,80640,4294901760,22650880,22503424,22552576,22601728,3,0
.long 7024640,7028736,7032832,2437760,120,393624,78228,0,6803072,596416,21504,896,2438272,146308,0,356504
.long 600512,88192,80256,9555968,2821632,2825856,2830080,22517248,80768,4294901760,22515712,22564864,22614016,22663168,3,0
.long 6893568,6897664,84574208,409728,32,393224,16404,1,5571200,534784,0,512,410144,133256,0,344068
.long 538880,81920,18432,8634368,2683392,2687616,83886080,17579008,2560,4294901760,17809408,17858560,17907712,17760256,771,0
.long 6897664,6897664,84574208,430208,40,393224,20500,1,5653120,534848,7168,512,430624,133260,0,348164
.long 538944,82048,18560,8695808,2684416,2688640,83886080,17580544,2688,4294901760,17870848,17920000,17772544,17821696,771,0
.long 84574208,6897664,84574208,450688,48,393224,24596,1,5735040,534912,14336,512,451104,133768,0,352260
.long 539008,81920,18688,8757248,2685440,2689664,83886080,17775616,2816,4294901760,17932288,17784832,17833984,17883136,771,0
.long 6893568,6897664,84574208,471168,56,393224,28692,1,5816960,534976,21504,512,471584,133772,0,356356
.long 539072,82048,18816,8818688,2686464,2690688,83886080,17777152,2944,4294901760,17797120,17846272,17895424,17944576,771,0
.long 6914048,6918144,84578304,410368,64,393224,81940,0,6881920,534784,0,640,410784,133512,0,344076
.long 538880,81920,83968,9617408,2704512,2708736,83886080,17603584,68096,4294901760,17809408,17858560,17907712,17760256,3,0
.long 6918144,6918144,84578304,430848,72,393224,86036,0,6963840,534848,7168,640,431264,133516,0,348172
.long 538944,82048,84096,9678848,2705536,2709760,83886080,17605120,68224,4294901760,17870848,17920000,17772544,17821696,3,0
.long 84578304,6918144,84578304,451328,80,393224,90132,0,7045760,534912,14336,640,451744,134024,0,352268
.long 539008,81920,84224,9740288,2706560,2710784,83886080,17800192,68352,4294901760,17932288,17784832,17833984,17883136,3,0
.long 6914048,6918144,84578304,471808,88,393224,94228,0,7127680,534976,21504,640,472224,134028,0,356364
.long 539072,82048,84352,9801728,2707584,2711808,83886080,17801728,68480,4294901760,17797120,17846272,17895424,17944576,3,0
.long 6934528,6938624,84582400,1065088,64,393240,16532,1,5572224,555264,0,640,1065504,137352,0,344084
.long 559360,83968,22528,8634368,2725632,2729856,83886080,19151872,6656,4294901760,19382272,19431424,19480576,19333120,771,0
.long 6938624,6938624,84582400,1085568,72,393240,20628,1,5654144,555328,7168,640,1085984,137356,0,348180
.long 559424,84096,22656,8695808,2726656,2730880,83886080,19153408,6784,4294901760,19443712,19492864,19345408,19394560,771,0
.long 84582400,6938624,84582400,1106048,80,393240,24724,1,5736064,555392,14336,640,1106464,137864,0,352276
.long 559488,83968,22784,8757248,2727680,2731904,83886080,19348480,6912,4294901760,19505152,19357696,19406848,19456000,771,0
.long 6934528,6938624,84582400,1126528,88,393240,28820,1,5817984,555456,21504,640,1126944,137868,0,356372
.long 559552,84096,22912,8818688,2728704,2732928,83886080,19350016,7040,4294901760,19369984,19419136,19468288,19517440,771,0
.long 6955008,6959104,84586496,1065728,96,393240,82068,0,6882944,555264,0,768,1066144,137608,0,344092
.long 559360,83968,88064,9617408,2746752,2750976,83886080,19176448,72192,4294901760,19382272,19431424,19480576,19333120,3,0
.long 6959104,6959104,84586496,1086208,104,393240,86164,0,6964864,555328,7168,768,1086624,137612,0,348188
.long 559424,84096,88192,9678848,2747776,2752000,83886080,19177984,72320,4294901760,19443712,19492864,19345408,19394560,3,0
.long 84586496,6959104,84586496,1106688,112,393240,90260,0,7046784,555392,14336,768,1107104,138120,0,352284
.long 559488,83968,88320,9740288,2748800,2753024,83886080,19373056,72448,4294901760,19505152,19357696,19406848,19456000,3,0
.long 6955008,6959104,84586496,1127168,120,393240,94356,0,7128704,555456,21504,768,1127584,138124,0,356380
.long 559552,84096,88448,9801728,2749824,2754048,83886080,19374592,72576,4294901760,19369984,19419136,19468288,19517440,3,0
.long 6975488,6979584,84590592,1720448,96,393352,16660,1,5573248,575744,0,768,1720864,141448,0,344196
.long 579840,86016,26624,8634368,2767872,2772096,83886080,20724736,10752,4294901760,20955136,21004288,21053440,20905984,771,0
.long 6979584,6979584,84590592,1740928,104,393352,20756,1,5655168,575808,7168,768,1741344,141452,0,348292
.long 579904,86144,26752,8695808,2768896,2773120,83886080,20726272,10880,4294901760,21016576,21065728,20918272,20967424,771,0
.long 84590592,6979584,84590592,1761408,112,393352,24852,1,5737088,575872,14336,768,1761824,141960,0,352388
.long 579968,86016,26880,8757248,2769920,2774144,83886080,20921344,11008,4294901760,21078016,20930560,20979712,21028864,771,0
.long 6975488,6979584,84590592,1781888,120,393352,28948,1,5819008,575936,21504,768,1782304,141964,0,356484
.long 580032,86144,27008,8818688,2770944,2775168,83886080,20922880,11136,4294901760,20942848,20992000,21041152,21090304,771,0
.long 6995968,7000064,84594688,1721088,24,393608,82196,0,6883968,575744,0,896,1721504,141704,0,344204
.long 579840,86016,92160,9617408,2788992,2793216,83886080,20749312,76288,4294901760,20955136,21004288,21053440,20905984,3,0
.long 7000064,7000064,84594688,1741568,56,393608,86292,0,6965888,575808,7168,896,1741984,141708,0,348300
.long 579904,86144,92288,9678848,2790016,2794240,83886080,20750848,76416,4294901760,21016576,21065728,20918272,20967424,3,0
.long 84594688,7000064,84594688,1762048,88,393608,90388,0,7047808,575872,14336,896,1762464,142216,0,352396
.long 579968,86016,92416,9740288,2791040,2795264,83886080,20945920,76544,4294901760,21078016,20930560,20979712,21028864,3,0
.long 6995968,7000064,84594688,1782528,120,393608,94484,0,7129728,575936,21504,896,1782944,142220,0,356492
.long 580032,86144,92544,9801728,2792064,2796288,83886080,20947456,76672,4294901760,20942848,20992000,21041152,21090304,3,0
.long 7016448,7020544,84598784,2375808,24,393624,16788,1,5574272,596224,0,896,2376224,145544,0,344212
.long 600320,88064,30720,8634368,2810112,2814336,83886080,22297600,14848,4294901760,22528000,22577152,22626304,22478848,771,0
.long 7020544,7020544,84598784,2396288,56,393624,20884,1,5656192,596288,7168,896,2396704,145548,0,348308
.long 600384,88192,30848,8695808,2811136,2815360,83886080,22299136,14976,4294901760,22589440,22638592,22491136,22540288,771,0
.long 84598784,7020544,84598784,2416768,88,393624,24980,1,5738112,596352,14336,896,2417184,146056,0,352404
.long 600448,88064,30976,8757248,2812160,2816384,83886080,22494208,15104,4294901760,22650880,22503424,22552576,22601728,771,0
.long 7016448,7020544,84598784,2437248,120,393624,29076,1,5820032,596416,21504,896,2437664,146060,0,356500
.long 600512,88192,31104,8818688,2813184,2817408,83886080,22495744,15232,4294901760,22515712,22564864,22614016,22663168,771,0
.long 7036928,7041024,84602880,2376448,128,393368,82324,0,6884992,596224,0,1024,2376864,145800,0,344220
.long 600320,88064,96256,9617408,2831232,2835456,83886080,22322176,80384,4294901760,22528000,22577152,22626304,22478848,3,0
.long 7041024,7041024,84602880,2396928,136,393368,86420,0,6966912,596288,7168,1024,2397344,145804,0,348316
.long 600384,88192,96384,9678848,2832256,2836480,83886080,22323712,80512,4294901760,22589440,22638592,22491136,22540288,3,0
.long 84602880,7041024,84602880,2417408,144,393368,90516,0,7048832,596352,14336,1024,2417824,146312,0,352412
.long 600448,88064,96512,9740288,2833280,2837504,83886080,22518784,80640,4294901760,22650880,22503424,22552576,22601728,3,0
.long 7036928,7041024,84602880,2437888,152,393368,94612,0,7130752,596416,21504,1024,2438304,146316,0,356508
.long 600512,88192,96640,9801728,2834304,2838528,83886080,22520320,80768,4294901760,22515712,22564864,22614016,22663168,3,0
.long 7045120,7049216,7053312,409856,64,393224,32788,1,5898880,534784,0,640,410176,133264,0,344320
.long 538880,90112,34816,8880128,2839680,2843904,2848128,17582080,2560,4294901760,17809408,17858560,17907712,17760256,771,0
.long 7049216,7049216,7053312,430336,72,393224,36884,1,5980800,534848,7168,640,430656,133268,0,348416
.long 538944,90240,34944,8941568,2840704,2844928,2849152,17583616,2688,4294901760,17870848,17920000,17772544,17821696,771,0
.long 7053312,7049216,7053312,450816,80,393224,40980,1,6062720,534912,14336,640,451136,133776,0,352512
.long 539008,90112,35072,9003008,2841728,2845952,2850176,17778688,2816,4294901760,17932288,17784832,17833984,17883136,771,0
.long 7045120,7049216,7053312,471296,88,393224,45076,1,6144640,534976,21504,640,471616,133780,0,356608
.long 539072,90240,35200,9064448,2842752,2846976,2851200,17780224,2944,4294901760,17797120,17846272,17895424,17944576,771,0
.long 7065600,7069696,7073792,410496,96,393224,98324,0,7209600,534784,0,768,410816,133520,0,344328
.long 538880,90112,100352,9863168,2860800,2865024,2869248,17606656,68096,4294901760,17809408,17858560,17907712,17760256,3,0
.long 7069696,7069696,7073792,430976,104,393224,102420,0,7291520,534848,7168,768,431296,133524,0,348424
.long 538944,90240,100480,9924608,2861824,2866048,2870272,17608192,68224,4294901760,17870848,17920000,17772544,17821696,3,0
.long 7073792,7069696,7073792,451456,112,393224,106516,0,7373440,534912,14336,768,451776,134032,0,352520
.long 539008,90112,100608,9986048,2862848,2867072,2871296,17803264,68352,4294901760,17932288,17784832,17833984,17883136,3,0
.long 7065600,7069696,7073792,471936,120,393224,110612,0,7455360,534976,21504,768,472256,134036,0,356616
.long 539072,90240,100736,10047488,2863872,2868096,2872320,17804800,68480,4294901760,17797120,17846272,17895424,17944576,3,0
.long 7086080,7090176,7094272,1065216,96,393240,32916,1,5899904,555264,0,768,1065536,137360,0,344336
.long 559360,92160,38912,8880128,2881920,2886144,2890368,19154944,6656,4294901760,19382272,19431424,19480576,19333120,771,0
.long 7090176,7090176,7094272,1085696,104,393240,37012,1,5981824,555328,7168,768,1086016,137364,0,348432
.long 559424,92288,39040,8941568,2882944,2887168,2891392,19156480,6784,4294901760,19443712,19492864,19345408,19394560,771,0
.long 7094272,7090176,7094272,1106176,112,393240,41108,1,6063744,555392,14336,768,1106496,137872,0,352528
.long 559488,92160,39168,9003008,2883968,2888192,2892416,19351552,6912,4294901760,19505152,19357696,19406848,19456000,771,0
.long 7086080,7090176,7094272,1126656,120,393240,45204,1,6145664,555456,21504,768,1126976,137876,0,356624
.long 559552,92288,39296,9064448,2884992,2889216,2893440,19353088,7040,4294901760,19369984,19419136,19468288,19517440,771,0
.long 7106560,7110656,7114752,1065856,24,393496,98452,0,7210624,555264,0,896,1066176,137616,0,344344
.long 559360,92160,104448,9863168,2903040,2907264,2911488,19179520,72192,4294901760,19382272,19431424,19480576,19333120,3,0
.long 7110656,7110656,7114752,1086336,56,393496,102548,0,7292544,555328,7168,896,1086656,137620,0,348440
.long 559424,92288,104576,9924608,2904064,2908288,2912512,19181056,72320,4294901760,19443712,19492864,19345408,19394560,3,0
.long 7114752,7110656,7114752,1106816,88,393496,106644,0,7374464,555392,14336,896,1107136,138128,0,352536
.long 559488,92160,104704,9986048,2905088,2909312,2913536,19376128,72448,4294901760,19505152,19357696,19406848,19456000,3,0
.long 7106560,7110656,7114752,1127296,120,393496,110740,0,7456384,555456,21504,896,1127616,138132,0,356632
.long 559552,92288,104832,10047488,2906112,2910336,2914560,19377664,72576,4294901760,19369984,19419136,19468288,19517440,3,0
.long 7127040,7131136,7135232,1720576,24,393608,33044,1,5900928,575744,0,896,1720896,141456,0,344448
.long 579840,94208,43008,8880128,2924160,2928384,2932608,20727808,10752,4294901760,20955136,21004288,21053440,20905984,771,0
.long 7131136,7131136,7135232,1741056,56,393608,37140,1,5982848,575808,7168,896,1741376,141460,0,348544
.long 579904,94336,43136,8941568,2925184,2929408,2933632,20729344,10880,4294901760,21016576,21065728,20918272,20967424,771,0
.long 7135232,7131136,7135232,1761536,88,393608,41236,1,6064768,575872,14336,896,1761856,141968,0,352640
.long 579968,94208,43264,9003008,2926208,2930432,2934656,20924416,11008,4294901760,21078016,20930560,20979712,21028864,771,0
.long 7127040,7131136,7135232,1782016,120,393608,45332,1,6146688,575936,21504,896,1782336,141972,0,356736
.long 580032,94336,43392,9064448,2927232,2931456,2935680,20925952,11136,4294901760,20942848,20992000,21041152,21090304,771,0
.long 7147520,7151616,7155712,1721216,128,393352,98580,0,7211648,575744,0,1024,1721536,141712,0,344456
.long 579840,94464,108544,9863168,3553536,3557760,3561984,20752384,76288,4294901760,20955136,21004288,21053440,20905984,3,0
.long 7151616,7151616,7155712,1741696,136,393352,102676,0,7293568,575808,7168,1024,1742016,141716,0,348552
.long 579904,94592,108672,9924608,3554560,3558784,3563008,20753920,76416,4294901760,21016576,21065728,20918272,20967424,3,0
.long 7155712,7151616,7155712,1762176,144,393352,106772,0,7375488,575872,14336,1024,1762496,142224,0,352648
.long 579968,94464,108800,9986048,3555584,3559808,3564032,20948992,76544,4294901760,21078016,20930560,20979712,21028864,3,0
.long 7147520,7151616,7155712,1782656,152,393352,110868,0,7457408,575936,21504,1024,1782976,142228,0,356744
.long 580032,94592,108928,10047488,3556608,3560832,3565056,20950528,76672,4294901760,20942848,20992000,21041152,21090304,3,0
.long 7168000,7172096,7176192,2375936,128,393368,33172,1,5901952,596224,0,1024,2376256,145552,0,344464
.long 600320,96512,47104,8880128,3574656,3578880,3583104,22300672,14848,4294901760,22528000,22577152,22626304,22478848,771,0
.long 7172096,7172096,7176192,2396416,136,393368,37268,1,5983872,596288,7168,1024,2396736,145556,0,348560
.long 600384,96640,47232,8941568,3575680,3579904,3584128,22302208,14976,4294901760,22589440,22638592,22491136,22540288,771,0
.long 7176192,7172096,7176192,2416896,144,393368,41364,1,6065792,596352,14336,1024,2417216,146064,0,352656
.long 600448,96512,47360,9003008,3576704,3580928,3585152,22497280,15104,4294901760,22650880,22503424,22552576,22601728,771,0
.long 7168000,7172096,7176192,2437376,152,393368,45460,1,6147712,596416,21504,1024,2437696,146068,0,356752
.long 600512,96640,47488,9064448,3577728,3581952,3586176,22498816,15232,4294901760,22515712,22564864,22614016,22663168,771,0
.long 7188480,7192576,7196672,2376576,160,393368,98708,0,7212672,596224,0,1152,2376896,145808,0,344472
.long 600320,96512,112640,9863168,3595776,3600000,3604224,22325248,80384,4294901760,22528000,22577152,22626304,22478848,3,0
.long 7192576,7192576,7196672,2397056,168,393368,102804,0,7294592,596288,7168,1152,2397376,145812,0,348568
.long 600384,96640,112768,9924608,3596800,3601024,3605248,22326784,80512,4294901760,22589440,22638592,22491136,22540288,3,0
.long 7196672,7192576,7196672,2417536,176,393368,106900,0,7376512,596352,14336,1152,2417856,146320,0,352664
.long 600448,96512,112896,9986048,3597824,3602048,3606272,22521856,80640,4294901760,22650880,22503424,22552576,22601728,3,0
.long 7188480,7192576,7196672,2438016,184,393368,110996,0,7458432,596416,21504,1152,2438336,146324,0,356760
.long 600512,96640,113024,10047488,3598848,3603072,3607296,22523392,80768,4294901760,22515712,22564864,22614016,22663168,3,0
.long 7057408,7061504,84639744,409984,96,393224,49172,1,6226560,534784,0,768,410208,133272,0,344324
.long 538880,90112,51200,9125888,2852352,2856576,83886080,17585152,2560,4294901760,17809408,17858560,17907712,17760256,771,0
.long 7061504,7061504,84639744,430464,104,393224,53268,1,6308480,534848,7168,768,430688,133276,0,348420
.long 538944,90240,51328,9187328,2853376,2857600,83886080,17586688,2688,4294901760,17870848,17920000,17772544,17821696,771,0
.long 84639744,7061504,84639744,450944,112,393224,57364,1,6390400,534912,14336,768,451168,133784,0,352516
.long 539008,90112,51456,9248768,2854400,2858624,83886080,17781760,2816,4294901760,17932288,17784832,17833984,17883136,771,0
.long 7057408,7061504,84639744,471424,120,393224,61460,1,6472320,534976,21504,768,471648,133788,0,356612
.long 539072,90240,51584,9310208,2855424,2859648,83886080,17783296,2944,4294901760,17797120,17846272,17895424,17944576,771,0
.long 7077888,7081984,84643840,410624,24,393480,114708,1,7537280,534784,0,896,410848,133528,0,344332
.long 538880,90112,116736,10108928,2873472,2877696,83886080,17609728,68096,4294901760,17809408,17858560,17907712,17760256,771,0
.long 7081984,7081984,84643840,431104,56,393480,118804,1,7619200,534848,7168,896,431328,133532,0,348428
.long 538944,90240,116864,10170368,2874496,2878720,83886080,17611264,68224,4294901760,17870848,17920000,17772544,17821696,771,0
.long 84643840,7081984,84643840,451584,88,393480,122900,1,7701120,534912,14336,896,451808,134040,0,352524
.long 539008,90112,116992,10231808,2875520,2879744,83886080,17806336,68352,4294901760,17932288,17784832,17833984,17883136,771,0
.long 7077888,7081984,84643840,472064,120,393480,126996,1,7783040,534976,21504,896,472288,134044,0,356620
.long 539072,90240,117120,10293248,2876544,2880768,83886080,17807872,68480,4294901760,17797120,17846272,17895424,17944576,771,0
.long 7098368,7102464,84647936,1065344,24,393496,49300,1,6227584,555264,0,896,1065568,137368,0,344340
.long 559360,92160,55296,9125888,2894592,2898816,83886080,19158016,6656,4294901760,19382272,19431424,19480576,19333120,771,0
.long 7102464,7102464,84647936,1085824,56,393496,53396,1,6309504,555328,7168,896,1086048,137372,0,348436
.long 559424,92288,55424,9187328,2895616,2899840,83886080,19159552,6784,4294901760,19443712,19492864,19345408,19394560,771,0
.long 84647936,7102464,84647936,1106304,88,393496,57492,1,6391424,555392,14336,896,1106528,137880,0,352532
.long 559488,92160,55552,9248768,2896640,2900864,83886080,19354624,6912,4294901760,19505152,19357696,19406848,19456000,771,0
.long 7098368,7102464,84647936,1126784,120,393496,61588,1,6473344,555456,21504,896,1127008,137884,0,356628
.long 559552,92288,55680,9310208,2897664,2901888,83886080,19356160,7040,4294901760,19369984,19419136,19468288,19517440,771,0
.long 7118848,7122944,84652032,1065984,128,393240,114836,1,7538304,555264,0,1024,1066208,137624,0,344348
.long 559360,92160,120832,10108928,2915712,2919936,83886080,19182592,72192,4294901760,19382272,19431424,19480576,19333120,771,0
.long 7122944,7122944,84652032,1086464,136,393240,118932,1,7620224,555328,7168,1024,1086688,137628,0,348444
.long 559424,92288,120960,10170368,2916736,2920960,83886080,19184128,72320,4294901760,19443712,19492864,19345408,19394560,771,0
.long 84652032,7122944,84652032,1106944,144,393240,123028,1,7702144,555392,14336,1024,1107168,138136,0,352540
.long 559488,92160,121088,10231808,2917760,2921984,83886080,19379200,72448,4294901760,19505152,19357696,19406848,19456000,771,0
.long 7118848,7122944,84652032,1127424,152,393240,127124,1,7784064,555456,21504,1024,1127648,138140,0,356636
.long 559552,92288,121216,10293248,2918784,2923008,83886080,19380736,72576,4294901760,19369984,19419136,19468288,19517440,771,0
.long 7139328,7143424,84656128,1720704,128,393352,49428,1,6228608,575744,0,1024,1720928,141464,0,344452
.long 579840,94208,59392,9125888,2936832,3549312,83886080,20730880,10752,4294901760,20955136,21004288,21053440,20905984,771,0
.long 7143424,7143424,84656128,1741184,136,393352,53524,1,6310528,575808,7168,1024,1741408,141468,0,348548
.long 579904,94336,59520,9187328,2937856,3550336,83886080,20732416,10880,4294901760,21016576,21065728,20918272,20967424,771,0
.long 84656128,7143424,84656128,1761664,144,393352,57620,1,6392448,575872,14336,1024,1761888,141976,0,352644
.long 579968,94464,59648,9248768,2938880,3551360,83886080,20927488,11008,4294901760,21078016,20930560,20979712,21028864,771,0
.long 7139328,7143424,84656128,1782144,152,393352,61716,1,6474368,575936,21504,1024,1782368,141980,0,356740
.long 580032,94592,59776,9310208,2939904,3552384,83886080,20929024,11136,4294901760,20942848,20992000,21041152,21090304,771,0
.long 7159808,7163904,84660224,1721344,160,393352,114964,1,7539328,575744,0,1152,1721568,141720,0,344460
.long 579840,94464,124928,10108928,3566208,3570432,83886080,20755456,76288,4294901760,20955136,21004288,21053440,20905984,771,0
.long 7163904,7163904,84660224,1741824,168,393352,119060,1,7621248,575808,7168,1152,1742048,141724,0,348556
.long 579904,94592,125056,10170368,3567232,3571456,83886080,20756992,76416,4294901760,21016576,21065728,20918272,20967424,771,0
.long 84660224,7163904,84660224,1762304,176,393352,123156,1,7703168,575872,14336,1152,1762528,142232,0,352652
.long 579968,94464,125184,10231808,3568256,3572480,83886080,20952064,76544,4294901760,21078016,20930560,20979712,21028864,771,0
.long 7159808,7163904,84660224,1782784,184,393352,127252,1,7785088,575936,21504,1152,1783008,142236,0,356748
.long 580032,94592,125312,10293248,3569280,3573504,83886080,20953600,76672,4294901760,20942848,20992000,21041152,21090304,771,0
.long 7180288,7184384,84664320,2376064,160,393368,49556,1,6229632,596224,0,1152,2376288,145560,0,344468
.long 600320,96512,63488,9125888,3587328,3591552,83886080,22303744,14848,4294901760,22528000,22577152,22626304,22478848,771,0
.long 7184384,7184384,84664320,2396544,168,393368,53652,1,6311552,596288,7168,1152,2396768,145564,0,348564
.long 600384,96640,63616,9187328,3588352,3592576,83886080,22305280,14976,4294901760,22589440,22638592,22491136,22540288,771,0
.long 84664320,7184384,84664320,2417024,176,393368,57748,1,6393472,596352,14336,1152,2417248,146072,0,352660
.long 600448,96512,63744,9248768,3589376,3593600,83886080,22500352,15104,4294901760,22650880,22503424,22552576,22601728,771,0
.long 7180288,7184384,84664320,2437504,184,393368,61844,1,6475392,596416,21504,1152,2437728,146076,0,356756
.long 600512,96640,63872,9310208,3590400,3594624,83886080,22501888,15232,4294901760,22515712,22564864,22614016,22663168,771,0
.long 7200768,7204864,84668416,2376704,192,393368,115092,1,7540352,596224,0,0,2376928,145816,0,344476
.long 600320,96512,129024,10108928,3608448,3612672,83886080,22328320,80384,4294901760,22528000,22577152,22626304,22478848,771,0
.long 7204864,7204864,84668416,2397184,200,393368,119188,1,7622272,596288,7168,0,2397408,145820,0,348572
.long 600384,96640,129152,10170368,3609472,3613696,83886080,22329856,80512,4294901760,22589440,22638592,22491136,22540288,771,0
.long 84668416,7204864,84668416,2417664,208,393368,123284,1,7704192,596352,14336,0,2417888,146328,0,352668
.long 600448,96512,129280,10231808,3610496,3614720,83886080,22524928,80640,4294901760,22650880,22503424,22552576,22601728,771,0
.long 7200768,7204864,84668416,2438144,216,393368,127380,1,7786112,596416,21504,0,2438368,146332,0,356764
.long 600512,96640,129408,10293248,3611520,3615744,83886080,22526464,80768,4294901760,22515712,22564864,22614016,22663168,771,0
.long 7208960,7213056,7217152,491520,192,393228,24,1,5243648,539648,0,0,492032,134144,0,360448
.long 543744,98304,2048,8388608,2941056,2945280,2949504,17956864,3072,4294901760,18006016,18055168,18104320,17956864,771,0
.long 7213056,7213056,7217152,512000,200,393228,4120,1,5325568,539712,7168,0,512512,134148,0,364544
.long 543808,98432,2176,8450048,2942080,2946304,2950528,17958400,3200,4294901760,18067456,18116608,17969152,18018304,771,0
.long 7217152,7213056,7217152,532480,208,393228,8216,1,5407488,539776,14336,0,532992,134656,0,368640
.long 543872,98304,2304,8511488,2943104,2947328,2951552,18153472,3328,4294901760,18128896,17981440,18030592,18079744,771,0
.long 7208960,7213056,7217152,552960,216,393228,12312,1,5489408,539840,21504,0,553472,134660,0,372736
.long 543936,98432,2432,8572928,2944128,2948352,2952576,18155008,3456,4294901760,17993728,18042880,18092032,18141184,771,0
.long 7229440,7233536,7237632,492160,224,393228,65560,0,6554368,539648,0,128,492672,134400,0,360456
.long 543744,98304,67584,9371648,2962176,2966400,2970624,17981440,68608,4294901760,18006016,18055168,18104320,17956864,3,0
.long 7233536,7233536,7237632,512640,232,393228,69656,0,6636288,539712,7168,128,513152,134404,0,364552
.long 543808,98432,67712,9433088,2963200,2967424,2971648,17982976,68736,4294901760,18067456,18116608,17969152,18018304,3,0
.long 7237632,7233536,7237632,533120,240,393228,73752,0,6718208,539776,14336,128,533632,134912,0,368648
.long 543872,98304,67840,9494528,2964224,2968448,2972672,18178048,68864,4294901760,18128896,17981440,18030592,18079744,3,0
.long 7229440,7233536,7237632,553600,248,393228,77848,0,6800128,539840,21504,128,554112,134916,0,372744
.long 543936,98432,67968,9555968,2965248,2969472,2973696,18179584,68992,4294901760,17993728,18042880,18092032,18141184,3,0
.long 7249920,7254016,7258112,1146880,224,393244,152,1,5244672,560128,0,128,1147392,138240,0,360464
.long 564224,100352,6144,8388608,2983296,2987520,2991744,19529728,7168,4294901760,19578880,19628032,19677184,19529728,771,0
.long 7254016,7254016,7258112,1167360,232,393244,4248,1,5326592,560192,7168,128,1167872,138244,0,364560
.long 564288,100480,6272,8450048,2984320,2988544,2992768,19531264,7296,4294901760,19640320,19689472,19542016,19591168,771,0
.long 7258112,7254016,7258112,1187840,240,393244,8344,1,5408512,560256,14336,128,1188352,138752,0,368656
.long 564352,100352,6400,8511488,2985344,2989568,2993792,19726336,7424,4294901760,19701760,19554304,19603456,19652608,771,0
.long 7249920,7254016,7258112,1208320,248,393244,12440,1,5490432,560320,21504,128,1208832,138756,0,372752
.long 564416,100480,6528,8572928,2986368,2990592,2994816,19727872,7552,4294901760,19566592,19615744,19664896,19714048,771,0
.long 7270400,7274496,7278592,1147520,152,393500,65688,0,6555392,560128,0,256,1148032,138496,0,360472
.long 564224,100352,71680,9371648,3004416,3008640,3012864,19554304,72704,4294901760,19578880,19628032,19677184,19529728,3,0
.long 7274496,7274496,7278592,1168000,184,393500,69784,0,6637312,560192,7168,256,1168512,138500,0,364568
.long 564288,100480,71808,9433088,3005440,3009664,3013888,19555840,72832,4294901760,19640320,19689472,19542016,19591168,3,0
.long 7278592,7274496,7278592,1188480,216,393500,73880,0,6719232,560256,14336,256,1188992,139008,0,368664
.long 564352,100352,71936,9494528,3006464,3010688,3014912,19750912,72960,4294901760,19701760,19554304,19603456,19652608,3,0
.long 7270400,7274496,7278592,1208960,248,393500,77976,0,6801152,560320,21504,256,1209472,139012,0,372760
.long 564416,100480,72064,9555968,3007488,3011712,3015936,19752448,73088,4294901760,19566592,19615744,19664896,19714048,3,0
.long 7290880,7294976,7299072,1802240,152,393612,280,1,5245696,580608,0,256,1802752,142336,0,360576
.long 584704,102400,10240,8388608,3025536,3029760,3033984,21102592,11264,4294901760,21151744,21200896,21250048,21102592,771,0
.long 7294976,7294976,7299072,1822720,184,393612,4376,1,5327616,580672,7168,256,1823232,142340,0,364672
.long 584768,102528,10368,8450048,3026560,3030784,3035008,21104128,11392,4294901760,21213184,21262336,21114880,21164032,771,0
.long 7299072,7294976,7299072,1843200,216,393612,8472,1,5409536,580736,14336,256,1843712,142848,0,368768
.long 584832,102400,10496,8511488,3027584,3031808,3036032,21299200,11520,4294901760,21274624,21127168,21176320,21225472,771,0
.long 7290880,7294976,7299072,1863680,248,393612,12568,1,5491456,580800,21504,256,1864192,142852,0,372864
.long 584896,102528,10624,8572928,3028608,3032832,3037056,21300736,11648,4294901760,21139456,21188608,21237760,21286912,771,0
.long 7311360,7315456,7319552,1802880,0,393356,65816,0,6556416,580608,0,384,1803392,142592,0,360584
.long 584704,102400,75776,9371648,3046656,3050880,3055104,21127168,76800,4294901760,21151744,21200896,21250048,21102592,3,0
.long 7315456,7315456,7319552,1823360,8,393356,69912,0,6638336,580672,7168,384,1823872,142596,0,364680
.long 584768,102528,75904,9433088,3047680,3051904,3056128,21128704,76928,4294901760,21213184,21262336,21114880,21164032,3,0
.long 7319552,7315456,7319552,1843840,16,393356,74008,0,6720256,580736,14336,384,1844352,143104,0,368776
.long 584832,102400,76032,9494528,3048704,3052928,3057152,21323776,77056,4294901760,21274624,21127168,21176320,21225472,3,0
.long 7311360,7315456,7319552,1864320,24,393356,78104,0,6802176,580800,21504,384,1864832,143108,0,372872
.long 584896,102528,76160,9555968,3049728,3053952,3058176,21325312,77184,4294901760,21139456,21188608,21237760,21286912,3,0
.long 7331840,7335936,7340032,2457600,0,393372,408,1,5246720,601088,0,384,2458112,146432,0,360592
.long 605184,104448,14336,8388608,3067776,3072000,3076224,22675456,15360,4294901760,22724608,22773760,22822912,22675456,771,0
.long 7335936,7335936,7340032,2478080,8,393372,4504,1,5328640,601152,7168,384,2478592,146436,0,364688
.long 605248,104576,14464,8450048,3068800,3073024,3077248,22676992,15488,4294901760,22786048,22835200,22687744,22736896,771,0
.long 7340032,7335936,7340032,2498560,16,393372,8600,1,5410560,601216,14336,384,2499072,146944,0,368784
.long 605312,104448,14592,8511488,3069824,3074048,3078272,22872064,15616,4294901760,22847488,22700032,22749184,22798336,771,0
.long 7331840,7335936,7340032,2519040,24,393372,12696,1,5492480,601280,21504,384,2519552,146948,0,372880
.long 605376,104576,14720,8572928,3070848,3075072,3079296,22873600,15744,4294901760,22712320,22761472,22810624,22859776,771,0
.long 7352320,7356416,7360512,2458240,32,393372,65944,0,6557440,601088,0,512,2458752,146688,0,360600
.long 605184,104448,79872,9371648,3088896,3093120,3097344,22700032,80896,4294901760,22724608,22773760,22822912,22675456,3,0
.long 7356416,7356416,7360512,2478720,40,393372,70040,0,6639360,601152,7168,512,2479232,146692,0,364696
.long 605248,104576,80000,9433088,3089920,3094144,3098368,22701568,81024,4294901760,22786048,22835200,22687744,22736896,3,0
.long 7360512,7356416,7360512,2499200,48,393372,74136,0,6721280,601216,14336,512,2499712,147200,0,368792
.long 605312,104448,80128,9494528,3090944,3095168,3099392,22896640,81152,4294901760,22847488,22700032,22749184,22798336,3,0
.long 7352320,7356416,7360512,2519680,56,393372,78232,0,6803200,601280,21504,512,2520192,147204,0,372888
.long 605376,104576,80256,9555968,3091968,3096192,3100416,22898176,81280,4294901760,22712320,22761472,22810624,22859776,3,0
.long 7221248,7225344,84705280,491648,224,393228,16408,1,5571328,539648,0,128,492064,134152,0,360452
.long 543744,98304,18432,8634368,2953728,2957952,83886080,17959936,3072,4294901760,18006016,18055168,18104320,17956864,771,0
.long 7225344,7225344,84705280,512128,232,393228,20504,1,5653248,539712,7168,128,512544,134156,0,364548
.long 543808,98432,18560,8695808,2954752,2958976,83886080,17961472,3200,4294901760,18067456,18116608,17969152,18018304,771,0
.long 84705280,7225344,84705280,532608,240,393228,24600,1,5735168,539776,14336,128,533024,134664,0,368644
.long 543872,98304,18688,8757248,2955776,2960000,83886080,18156544,3328,4294901760,18128896,17981440,18030592,18079744,771,0
.long 7221248,7225344,84705280,553088,248,393228,28696,1,5817088,539840,21504,128,553504,134668,0,372740
.long 543936,98432,18816,8818688,2956800,2961024,83886080,18158080,3456,4294901760,17993728,18042880,18092032,18141184,771,0
.long 7241728,7245824,84709376,492288,152,393484,81944,0,6882048,539648,0,256,492704,134408,0,360460
.long 543744,98304,83968,9617408,2974848,2979072,83886080,17984512,68608,4294901760,18006016,18055168,18104320,17956864,3,0
.long 7245824,7245824,84709376,512768,184,393484,86040,0,6963968,539712,7168,256,513184,134412,0,364556
.long 543808,98432,84096,9678848,2975872,2980096,83886080,17986048,68736,4294901760,18067456,18116608,17969152,18018304,3,0
.long 84709376,7245824,84709376,533248,216,393484,90136,0,7045888,539776,14336,256,533664,134920,0,368652
.long 543872,98304,84224,9740288,2976896,2981120,83886080,18181120,68864,4294901760,18128896,17981440,18030592,18079744,3,0
.long 7241728,7245824,84709376,553728,248,393484,94232,0,7127808,539840,21504,256,554144,134924,0,372748
.long 543936,98432,84352,9801728,2977920,2982144,83886080,18182656,68992,4294901760,17993728,18042880,18092032,18141184,3,0
.long 7262208,7266304,84713472,1147008,152,393500,16536,1,5572352,560128,0,256,1147424,138248,0,360468
.long 564224,100352,22528,8634368,2995968,3000192,83886080,19532800,7168,4294901760,19578880,19628032,19677184,19529728,771,0
.long 7266304,7266304,84713472,1167488,184,393500,20632,1,5654272,560192,7168,256,1167904,138252,0,364564
.long 564288,100480,22656,8695808,2996992,3001216,83886080,19534336,7296,4294901760,19640320,19689472,19542016,19591168,771,0
.long 84713472,7266304,84713472,1187968,216,393500,24728,1,5736192,560256,14336,256,1188384,138760,0,368660
.long 564352,100352,22784,8757248,2998016,3002240,83886080,19729408,7424,4294901760,19701760,19554304,19603456,19652608,771,0
.long 7262208,7266304,84713472,1208448,248,393500,28824,1,5818112,560320,21504,256,1208864,138764,0,372756
.long 564416,100480,22912,8818688,2999040,3003264,83886080,19730944,7552,4294901760,19566592,19615744,19664896,19714048,771,0
.long 7282688,7286784,84717568,1147648,0,393244,82072,0,6883072,560128,0,384,1148064,138504,0,360476
.long 564224,100352,88064,9617408,3017088,3021312,83886080,19557376,72704,4294901760,19578880,19628032,19677184,19529728,3,0
.long 7286784,7286784,84717568,1168128,8,393244,86168,0,6964992,560192,7168,384,1168544,138508,0,364572
.long 564288,100480,88192,9678848,3018112,3022336,83886080,19558912,72832,4294901760,19640320,19689472,19542016,19591168,3,0
.long 84717568,7286784,84717568,1188608,16,393244,90264,0,7046912,560256,14336,384,1189024,139016,0,368668
.long 564352,100352,88320,9740288,3019136,3023360,83886080,19753984,72960,4294901760,19701760,19554304,19603456,19652608,3,0
.long 7282688,7286784,84717568,1209088,24,393244,94360,0,7128832,560320,21504,384,1209504,139020,0,372764
.long 564416,100480,88448,9801728,3020160,3024384,83886080,19755520,73088,4294901760,19566592,19615744,19664896,19714048,3,0
.long 7303168,7307264,84721664,1802368,0,393356,16664,1,5573376,580608,0,384,1802784,142344,0,360580
.long 584704,102400,26624,8634368,3038208,3042432,83886080,21105664,11264,4294901760,21151744,21200896,21250048,21102592,771,0
.long 7307264,7307264,84721664,1822848,8,393356,20760,1,5655296,580672,7168,384,1823264,142348,0,364676
.long 584768,102528,26752,8695808,3039232,3043456,83886080,21107200,11392,4294901760,21213184,21262336,21114880,21164032,771,0
.long 84721664,7307264,84721664,1843328,16,393356,24856,1,5737216,580736,14336,384,1843744,142856,0,368772
.long 584832,102400,26880,8757248,3040256,3044480,83886080,21302272,11520,4294901760,21274624,21127168,21176320,21225472,771,0
.long 7303168,7307264,84721664,1863808,24,393356,28952,1,5819136,580800,21504,384,1864224,142860,0,372868
.long 584896,102528,27008,8818688,3041280,3045504,83886080,21303808,11648,4294901760,21139456,21188608,21237760,21286912,771,0
.long 7323648,7327744,84725760,1803008,32,393356,82200,0,6884096,580608,0,512,1803424,142600,0,360588
.long 584704,102400,92160,9617408,3059328,3063552,83886080,21130240,76800,4294901760,21151744,21200896,21250048,21102592,3,0
.long 7327744,7327744,84725760,1823488,40,393356,86296,0,6966016,580672,7168,512,1823904,142604,0,364684
.long 584768,102528,92288,9678848,3060352,3064576,83886080,21131776,76928,4294901760,21213184,21262336,21114880,21164032,3,0
.long 84725760,7327744,84725760,1843968,48,393356,90392,0,7047936,580736,14336,512,1844384,143112,0,368780
.long 584832,102400,92416,9740288,3061376,3065600,83886080,21326848,77056,4294901760,21274624,21127168,21176320,21225472,3,0
.long 7323648,7327744,84725760,1864448,56,393356,94488,0,7129856,580800,21504,512,1864864,143116,0,372876
.long 584896,102528,92544,9801728,3062400,3066624,83886080,21328384,77184,4294901760,21139456,21188608,21237760,21286912,3,0
.long 7344128,7348224,84729856,2457728,32,393372,16792,1,5574400,601088,0,512,2458144,146440,0,360596
.long 605184,104448,30720,8634368,3080448,3084672,83886080,22678528,15360,4294901760,22724608,22773760,22822912,22675456,771,0
.long 7348224,7348224,84729856,2478208,40,393372,20888,1,5656320,601152,7168,512,2478624,146444,0,364692
.long 605248,104576,30848,8695808,3081472,3085696,83886080,22680064,15488,4294901760,22786048,22835200,22687744,22736896,771,0
.long 84729856,7348224,84729856,2498688,48,393372,24984,1,5738240,601216,14336,512,2499104,146952,0,368788
.long 605312,104448,30976,8757248,3082496,3086720,83886080,22875136,15616,4294901760,22847488,22700032,22749184,22798336,771,0
.long 7344128,7348224,84729856,2519168,56,393372,29080,1,5820160,601280,21504,512,2519584,146956,0,372884
.long 605376,104576,31104,8818688,3083520,3087744,83886080,22876672,15744,4294901760,22712320,22761472,22810624,22859776,771,0
.long 7364608,7368704,84733952,2458368,64,393372,82328,0,6885120,601088,0,640,2458784,146696,0,360604
.long 605184,104448,96256,9617408,3101568,3105792,83886080,22703104,80896,4294901760,22724608,22773760,22822912,22675456,3,0
.long 7368704,7368704,84733952,2478848,72,393372,86424,0,6967040,601152,7168,640,2479264,146700,0,364700
.long 605248,104576,96384,9678848,3102592,3106816,83886080,22704640,81024,4294901760,22786048,22835200,22687744,22736896,3,0
.long 84733952,7368704,84733952,2499328,80,393372,90520,0,7048960,601216,14336,640,2499744,147208,0,368796
.long 605312,104448,96512,9740288,3103616,3107840,83886080,22899712,81152,4294901760,22847488,22700032,22749184,22798336,3,0
.long 7364608,7368704,84733952,2519808,88,393372,94616,0,7130880,601280,21504,640,2520224,147212,0,372892
.long 605376,104576,96640,9801728,3104640,3108864,83886080,22901248,81280,4294901760,22712320,22761472,22810624,22859776,3,0
.long 7372800,7376896,7380992,491776,152,393484,32792,1,5899008,539648,0,256,492096,134160,0,360704
.long 543744,106496,34816,8880128,3110016,3114240,3118464,17963008,3072,4294901760,18006016,18055168,18104320,17956864,771,0
.long 7376896,7376896,7380992,512256,184,393484,36888,1,5980928,539712,7168,256,512576,134164,0,364800
.long 543808,106624,34944,8941568,3111040,3115264,3119488,17964544,3200,4294901760,18067456,18116608,17969152,18018304,771,0
.long 7380992,7376896,7380992,532736,216,393484,40984,1,6062848,539776,14336,256,533056,134672,0,368896
.long 543872,106496,35072,9003008,3112064,3116288,3120512,18159616,3328,4294901760,18128896,17981440,18030592,18079744,771,0
.long 7372800,7376896,7380992,553216,248,393484,45080,1,6144768,539840,21504,256,553536,134676,0,372992
.long 543936,106624,35200,9064448,3113088,3117312,3121536,18161152,3456,4294901760,17993728,18042880,18092032,18141184,771,0
.long 7393280,7397376,7401472,492416,0,393228,98328,0,7209728,539648,0,384,492736,134416,0,360712
.long 543744,106496,100352,9863168,3131136,3135360,3139584,17987584,68608,4294901760,18006016,18055168,18104320,17956864,3,0
.long 7397376,7397376,7401472,512896,8,393228,102424,0,7291648,539712,7168,384,513216,134420,0,364808
.long 543808,106624,100480,9924608,3132160,3136384,3140608,17989120,68736,4294901760,18067456,18116608,17969152,18018304,3,0
.long 7401472,7397376,7401472,533376,16,393228,106520,0,7373568,539776,14336,384,533696,134928,0,368904
.long 543872,106496,100608,9986048,3133184,3137408,3141632,18184192,68864,4294901760,18128896,17981440,18030592,18079744,3,0
.long 7393280,7397376,7401472,553856,24,393228,110616,0,7455488,539840,21504,384,554176,134932,0,373000
.long 543936,106624,100736,10047488,3134208,3138432,3142656,18185728,68992,4294901760,17993728,18042880,18092032,18141184,3,0
.long 7413760,7417856,7421952,1147136,0,393244,32920,1,5900032,560128,0,384,1147456,138256,0,360720
.long 564224,108544,38912,8880128,3152256,3156480,3160704,19535872,7168,4294901760,19578880,19628032,19677184,19529728,771,0
.long 7417856,7417856,7421952,1167616,8,393244,37016,1,5981952,560192,7168,384,1167936,138260,0,364816
.long 564288,108672,39040,8941568,3153280,3157504,3161728,19537408,7296,4294901760,19640320,19689472,19542016,19591168,771,0
.long 7421952,7417856,7421952,1188096,16,393244,41112,1,6063872,560256,14336,384,1188416,138768,0,368912
.long 564352,108544,39168,9003008,3154304,3158528,3162752,19732480,7424,4294901760,19701760,19554304,19603456,19652608,771,0
.long 7413760,7417856,7421952,1208576,24,393244,45208,1,6145792,560320,21504,384,1208896,138772,0,373008
.long 564416,108672,39296,9064448,3155328,3159552,3163776,19734016,7552,4294901760,19566592,19615744,19664896,19714048,771,0
.long 7434240,7438336,7442432,1147776,32,393244,98456,0,7210752,560128,0,512,1148096,138512,0,360728
.long 564224,108544,104448,9863168,3173376,3177600,3181824,19560448,72704,4294901760,19578880,19628032,19677184,19529728,3,0
.long 7438336,7438336,7442432,1168256,40,393244,102552,0,7292672,560192,7168,512,1168576,138516,0,364824
.long 564288,108672,104576,9924608,3174400,3178624,3182848,19561984,72832,4294901760,19640320,19689472,19542016,19591168,3,0
.long 7442432,7438336,7442432,1188736,48,393244,106648,0,7374592,560256,14336,512,1189056,139024,0,368920
.long 564352,108544,104704,9986048,3175424,3179648,3183872,19757056,72960,4294901760,19701760,19554304,19603456,19652608,3,0
.long 7434240,7438336,7442432,1209216,56,393244,110744,0,7456512,560320,21504,512,1209536,139028,0,373016
.long 564416,108672,104832,10047488,3176448,3180672,3184896,19758592,73088,4294901760,19566592,19615744,19664896,19714048,3,0
.long 7454720,7458816,7462912,1802496,32,393356,33048,1,5901056,580608,0,512,1802816,142352,0,360832
.long 584704,110592,43008,8880128,3194496,3198720,3202944,21108736,11264,4294901760,21151744,21200896,21250048,21102592,771,0
.long 7458816,7458816,7462912,1822976,40,393356,37144,1,5982976,580672,7168,512,1823296,142356,0,364928
.long 584768,110720,43136,8941568,3195520,3199744,3203968,21110272,11392,4294901760,21213184,21262336,21114880,21164032,771,0
.long 7462912,7458816,7462912,1843456,48,393356,41240,1,6064896,580736,14336,512,1843776,142864,0,369024
.long 584832,110592,43264,9003008,3196544,3200768,3204992,21305344,11520,4294901760,21274624,21127168,21176320,21225472,771,0
.long 7454720,7458816,7462912,1863936,56,393356,45336,1,6146816,580800,21504,512,1864256,142868,0,373120
.long 584896,110720,43392,9064448,3197568,3201792,3206016,21306880,11648,4294901760,21139456,21188608,21237760,21286912,771,0
.long 7475200,7479296,7483392,1803136,64,393356,98584,0,7211776,580608,0,640,1803456,142608,0,360840
.long 584704,110848,108544,9863168,3621120,3625344,3629568,21133312,76800,4294901760,21151744,21200896,21250048,21102592,3,0
.long 7479296,7479296,7483392,1823616,72,393356,102680,0,7293696,580672,7168,640,1823936,142612,0,364936
.long 584768,110976,108672,9924608,3622144,3626368,3630592,21134848,76928,4294901760,21213184,21262336,21114880,21164032,3,0
.long 7483392,7479296,7483392,1844096,80,393356,106776,0,7375616,580736,14336,640,1844416,143120,0,369032
.long 584832,110848,108800,9986048,3623168,3627392,3631616,21329920,77056,4294901760,21274624,21127168,21176320,21225472,3,0
.long 7475200,7479296,7483392,1864576,88,393356,110872,0,7457536,580800,21504,640,1864896,143124,0,373128
.long 584896,110976,108928,10047488,3624192,3628416,3632640,21331456,77184,4294901760,21139456,21188608,21237760,21286912,3,0
.long 7495680,7499776,7503872,2457856,64,393372,33176,1,5902080,601088,0,640,2458176,146448,0,360848
.long 605184,112896,47104,8880128,3642240,3646464,3650688,22681600,15360,4294901760,22724608,22773760,22822912,22675456,771,0
.long 7499776,7499776,7503872,2478336,72,393372,37272,1,5984000,601152,7168,640,2478656,146452,0,364944
.long 605248,113024,47232,8941568,3643264,3647488,3651712,22683136,15488,4294901760,22786048,22835200,22687744,22736896,771,0
.long 7503872,7499776,7503872,2498816,80,393372,41368,1,6065920,601216,14336,640,2499136,146960,0,369040
.long 605312,112896,47360,9003008,3644288,3648512,3652736,22878208,15616,4294901760,22847488,22700032,22749184,22798336,771,0
.long 7495680,7499776,7503872,2519296,88,393372,45464,1,6147840,601280,21504,640,2519616,146964,0,373136
.long 605376,113024,47488,9064448,3645312,3649536,3653760,22879744,15744,4294901760,22712320,22761472,22810624,22859776,771,0
.long 7516160,7520256,7524352,2458496,96,393372,98712,0,7212800,601088,0,768,2458816,146704,0,360856
.long 605184,112896,112640,9863168,3663360,3667584,3671808,22706176,80896,4294901760,22724608,22773760,22822912,22675456,3,0
.long 7520256,7520256,7524352,2478976,104,393372,102808,0,7294720,601152,7168,768,2479296,146708,0,364952
.long 605248,113024,112768,9924608,3664384,3668608,3672832,22707712,81024,4294901760,22786048,22835200,22687744,22736896,3,0
.long 7524352,7520256,7524352,2499456,112,393372,106904,0,7376640,601216,14336,768,2499776,147216,0,369048
.long 605312,112896,112896,9986048,3665408,3669632,3673856,22902784,81152,4294901760,22847488,22700032,22749184,22798336,3,0
.long 7516160,7520256,7524352,2519936,120,393372,111000,0,7458560,601280,21504,768,2520256,147220,0,373144
.long 605376,113024,113024,10047488,3666432,3670656,3674880,22904320,81280,4294901760,22712320,22761472,22810624,22859776,3,0
.long 7385088,7389184,84770816,491904,0,393228,49176,1,6226688,539648,0,384,492128,134168,0,360708
.long 543744,106496,51200,9125888,3122688,3126912,83886080,17966080,3072,4294901760,18006016,18055168,18104320,17956864,771,0
.long 7389184,7389184,84770816,512384,8,393228,53272,1,6308608,539712,7168,384,512608,134172,0,364804
.long 543808,106624,51328,9187328,3123712,3127936,83886080,17967616,3200,4294901760,18067456,18116608,17969152,18018304,771,0
.long 84770816,7389184,84770816,532864,16,393228,57368,1,6390528,539776,14336,384,533088,134680,0,368900
.long 543872,106496,51456,9248768,3124736,3128960,83886080,18162688,3328,4294901760,18128896,17981440,18030592,18079744,771,0
.long 7385088,7389184,84770816,553344,24,393228,61464,1,6472448,539840,21504,384,553568,134684,0,372996
.long 543936,106624,51584,9310208,3125760,3129984,83886080,18164224,3456,4294901760,17993728,18042880,18092032,18141184,771,0
.long 7405568,7409664,84774912,492544,32,393228,114712,1,7537408,539648,0,512,492768,134424,0,360716
.long 543744,106496,116736,10108928,3143808,3148032,83886080,17990656,68608,4294901760,18006016,18055168,18104320,17956864,771,0
.long 7409664,7409664,84774912,513024,40,393228,118808,1,7619328,539712,7168,512,513248,134428,0,364812
.long 543808,106624,116864,10170368,3144832,3149056,83886080,17992192,68736,4294901760,18067456,18116608,17969152,18018304,771,0
.long 84774912,7409664,84774912,533504,48,393228,122904,1,7701248,539776,14336,512,533728,134936,0,368908
.long 543872,106496,116992,10231808,3145856,3150080,83886080,18187264,68864,4294901760,18128896,17981440,18030592,18079744,771,0
.long 7405568,7409664,84774912,553984,56,393228,127000,1,7783168,539840,21504,512,554208,134940,0,373004
.long 543936,106624,117120,10293248,3146880,3151104,83886080,18188800,68992,4294901760,17993728,18042880,18092032,18141184,771,0
.long 7426048,7430144,84779008,1147264,32,393244,49304,1,6227712,560128,0,512,1147488,138264,0,360724
.long 564224,108544,55296,9125888,3164928,3169152,83886080,19538944,7168,4294901760,19578880,19628032,19677184,19529728,771,0
.long 7430144,7430144,84779008,1167744,40,393244,53400,1,6309632,560192,7168,512,1167968,138268,0,364820
.long 564288,108672,55424,9187328,3165952,3170176,83886080,19540480,7296,4294901760,19640320,19689472,19542016,19591168,771,0
.long 84779008,7430144,84779008,1188224,48,393244,57496,1,6391552,560256,14336,512,1188448,138776,0,368916
.long 564352,108544,55552,9248768,3166976,3171200,83886080,19735552,7424,4294901760,19701760,19554304,19603456,19652608,771,0
.long 7426048,7430144,84779008,1208704,56,393244,61592,1,6473472,560320,21504,512,1208928,138780,0,373012
.long 564416,108672,55680,9310208,3168000,3172224,83886080,19737088,7552,4294901760,19566592,19615744,19664896,19714048,771,0
.long 7446528,7450624,84783104,1147904,64,393244,114840,1,7538432,560128,0,640,1148128,138520,0,360732
.long 564224,108544,120832,10108928,3186048,3190272,83886080,19563520,72704,4294901760,19578880,19628032,19677184,19529728,771,0
.long 7450624,7450624,84783104,1168384,72,393244,118936,1,7620352,560192,7168,640,1168608,138524,0,364828
.long 564288,108672,120960,10170368,3187072,3191296,83886080,19565056,72832,4294901760,19640320,19689472,19542016,19591168,771,0
.long 84783104,7450624,84783104,1188864,80,393244,123032,1,7702272,560256,14336,640,1189088,139032,0,368924
.long 564352,108544,121088,10231808,3188096,3192320,83886080,19760128,72960,4294901760,19701760,19554304,19603456,19652608,771,0
.long 7446528,7450624,84783104,1209344,88,393244,127128,1,7784192,560320,21504,640,1209568,139036,0,373020
.long 564416,108672,121216,10293248,3189120,3193344,83886080,19761664,73088,4294901760,19566592,19615744,19664896,19714048,771,0
.long 7467008,7471104,84787200,1802624,64,393356,49432,1,6228736,580608,0,640,1802848,142360,0,360836
.long 584704,110592,59392,9125888,3207168,3616896,83886080,21111808,11264,4294901760,21151744,21200896,21250048,21102592,771,0
.long 7471104,7471104,84787200,1823104,72,393356,53528,1,6310656,580672,7168,640,1823328,142364,0,364932
.long 584768,110720,59520,9187328,3208192,3617920,83886080,21113344,11392,4294901760,21213184,21262336,21114880,21164032,771,0
.long 84787200,7471104,84787200,1843584,80,393356,57624,1,6392576,580736,14336,640,1843808,142872,0,369028
.long 584832,110848,59648,9248768,3209216,3618944,83886080,21308416,11520,4294901760,21274624,21127168,21176320,21225472,771,0
.long 7467008,7471104,84787200,1864064,88,393356,61720,1,6474496,580800,21504,640,1864288,142876,0,373124
.long 584896,110976,59776,9310208,3210240,3619968,83886080,21309952,11648,4294901760,21139456,21188608,21237760,21286912,771,0
.long 7487488,7491584,84791296,1803264,96,393356,114968,1,7539456,580608,0,768,1803488,142616,0,360844
.long 584704,110848,124928,10108928,3633792,3638016,83886080,21136384,76800,4294901760,21151744,21200896,21250048,21102592,771,0
.long 7491584,7491584,84791296,1823744,104,393356,119064,1,7621376,580672,7168,768,1823968,142620,0,364940
.long 584768,110976,125056,10170368,3634816,3639040,83886080,21137920,76928,4294901760,21213184,21262336,21114880,21164032,771,0
.long 84791296,7491584,84791296,1844224,112,393356,123160,1,7703296,580736,14336,768,1844448,143128,0,369036
.long 584832,110848,125184,10231808,3635840,3640064,83886080,21332992,77056,4294901760,21274624,21127168,21176320,21225472,771,0
.long 7487488,7491584,84791296,1864704,120,393356,127256,1,7785216,580800,21504,768,1864928,143132,0,373132
.long 584896,110976,125312,10293248,3636864,3641088,83886080,21334528,77184,4294901760,21139456,21188608,21237760,21286912,771,0
.long 7507968,7512064,84795392,2457984,96,393372,49560,1,6229760,601088,0,768,2458208,146456,0,360852
.long 605184,112896,63488,9125888,3654912,3659136,83886080,22684672,15360,4294901760,22724608,22773760,22822912,22675456,771,0
.long 7512064,7512064,84795392,2478464,104,393372,53656,1,6311680,601152,7168,768,2478688,146460,0,364948
.long 605248,113024,63616,9187328,3655936,3660160,83886080,22686208,15488,4294901760,22786048,22835200,22687744,22736896,771,0
.long 84795392,7512064,84795392,2498944,112,393372,57752,1,6393600,601216,14336,768,2499168,146968,0,369044
.long 605312,112896,63744,9248768,3656960,3661184,83886080,22881280,15616,4294901760,22847488,22700032,22749184,22798336,771,0
.long 7507968,7512064,84795392,2519424,120,393372,61848,1,6475520,601280,21504,768,2519648,146972,0,373140
.long 605376,113024,63872,9310208,3657984,3662208,83886080,22882816,15744,4294901760,22712320,22761472,22810624,22859776,771,0
.long 7528448,7532544,84799488,2458624,24,393628,115096,1,7540480,601088,0,896,2458848,146712,0,360860
.long 605184,112896,129024,10108928,3676032,3680256,83886080,22709248,80896,4294901760,22724608,22773760,22822912,22675456,771,0
.long 7532544,7532544,84799488,2479104,56,393628,119192,1,7622400,601152,7168,896,2479328,146716,0,364956
.long 605248,113024,129152,10170368,3677056,3681280,83886080,22710784,81024,4294901760,22786048,22835200,22687744,22736896,771,0
.long 84799488,7532544,84799488,2499584,88,393628,123288,1,7704320,601216,14336,896,2499808,147224,0,369052
.long 605312,112896,129280,10231808,3678080,3682304,83886080,22905856,81152,4294901760,22847488,22700032,22749184,22798336,771,0
.long 7528448,7532544,84799488,2520064,120,393628,127384,1,7786240,601280,21504,896,2520288,147228,0,373148
.long 605376,113024,129408,10293248,3679104,3683328,83886080,22907392,81280,4294901760,22712320,22761472,22810624,22859776,771,0
.long 7536640,7540736,7544832,573440,64,393228,28,1,5243776,539904,0,640,573952,134272,0,376832
.long 544000,114688,2048,8388608,3211392,3215616,3219840,17969152,3584,4294901760,18202624,18251776,18300928,18153472,771,0
.long 7540736,7540736,7544832,593920,72,393228,4124,1,5325696,539968,7168,640,594432,134276,0,380928
.long 544064,114816,2176,8450048,3212416,3216640,3220864,17970688,3712,4294901760,18264064,18313216,18165760,18214912,771,0
.long 7544832,7540736,7544832,614400,80,393228,8220,1,5407616,540032,14336,640,614912,134784,0,385024
.long 544128,114688,2304,8511488,3213440,3217664,3221888,18165760,3840,4294901760,18325504,18178048,18227200,18276352,771,0
.long 7536640,7540736,7544832,634880,88,393228,12316,1,5489536,540096,21504,640,635392,134788,0,389120
.long 544192,114816,2432,8572928,3214464,3218688,3222912,18167296,3968,4294901760,18190336,18239488,18288640,18337792,771,0
.long 7557120,7561216,7565312,574080,96,393228,65564,0,6554496,539904,0,768,574592,134528,0,376840
.long 544000,114688,67584,9371648,3232512,3236736,3240960,17993728,69120,4294901760,18202624,18251776,18300928,18153472,3,0
.long 7561216,7561216,7565312,594560,104,393228,69660,0,6636416,539968,7168,768,595072,134532,0,380936
.long 544064,114816,67712,9433088,3233536,3237760,3241984,17995264,69248,4294901760,18264064,18313216,18165760,18214912,3,0
.long 7565312,7561216,7565312,615040,112,393228,73756,0,6718336,540032,14336,768,615552,135040,0,385032
.long 544128,114688,67840,9494528,3234560,3238784,3243008,18190336,69376,4294901760,18325504,18178048,18227200,18276352,3,0
.long 7557120,7561216,7565312,635520,120,393228,77852,0,6800256,540096,21504,768,636032,135044,0,389128
.long 544192,114816,67968,9555968,3235584,3239808,3244032,18191872,69504,4294901760,18190336,18239488,18288640,18337792,3,0
.long 7577600,7581696,7585792,1228800,96,393244,156,1,5244800,560384,0,768,1229312,138368,0,376848
.long 564480,116736,6144,8388608,3253632,3257856,3262080,19542016,7680,4294901760,19775488,19824640,19873792,19726336,771,0
.long 7581696,7581696,7585792,1249280,104,393244,4252,1,5326720,560448,7168,768,1249792,138372,0,380944
.long 564544,116864,6272,8450048,3254656,3258880,3263104,19543552,7808,4294901760,19836928,19886080,19738624,19787776,771,0
.long 7585792,7581696,7585792,1269760,112,393244,8348,1,5408640,560512,14336,768,1270272,138880,0,385040
.long 564608,116736,6400,8511488,3255680,3259904,3264128,19738624,7936,4294901760,19898368,19750912,19800064,19849216,771,0
.long 7577600,7581696,7585792,1290240,120,393244,12444,1,5490560,560576,21504,768,1290752,138884,0,389136
.long 564672,116864,6528,8572928,3256704,3260928,3265152,19740160,8064,4294901760,19763200,19812352,19861504,19910656,771,0
.long 7598080,7602176,7606272,1229440,24,393500,65692,0,6555520,560384,0,896,1229952,138624,0,376856
.long 564480,116736,71680,9371648,3274752,3278976,3283200,19566592,73216,4294901760,19775488,19824640,19873792,19726336,3,0
.long 7602176,7602176,7606272,1249920,56,393500,69788,0,6637440,560448,7168,896,1250432,138628,0,380952
.long 564544,116864,71808,9433088,3275776,3280000,3284224,19568128,73344,4294901760,19836928,19886080,19738624,19787776,3,0
.long 7606272,7602176,7606272,1270400,88,393500,73884,0,6719360,560512,14336,896,1270912,139136,0,385048
.long 564608,116736,71936,9494528,3276800,3281024,3285248,19763200,73472,4294901760,19898368,19750912,19800064,19849216,3,0
.long 7598080,7602176,7606272,1290880,120,393500,77980,0,6801280,560576,21504,896,1291392,139140,0,389144
.long 564672,116864,72064,9555968,3277824,3282048,3286272,19764736,73600,4294901760,19763200,19812352,19861504,19910656,3,0
.long 7618560,7622656,7626752,1884160,24,393612,284,1,5245824,580864,0,896,1884672,142464,0,376960
.long 584960,118784,10240,8388608,3295872,3300096,3304320,21114880,11776,4294901760,21348352,21397504,21446656,21299200,771,0
.long 7622656,7622656,7626752,1904640,56,393612,4380,1,5327744,580928,7168,896,1905152,142468,0,381056
.long 585024,118912,10368,8450048,3296896,3301120,3305344,21116416,11904,4294901760,21409792,21458944,21311488,21360640,771,0
.long 7626752,7622656,7626752,1925120,88,393612,8476,1,5409664,580992,14336,896,1925632,142976,0,385152
.long 585088,118784,10496,8511488,3297920,3302144,3306368,21311488,12032,4294901760,21471232,21323776,21372928,21422080,771,0
.long 7618560,7622656,7626752,1945600,120,393612,12572,1,5491584,581056,21504,896,1946112,142980,0,389248
.long 585152,118912,10624,8572928,3298944,3303168,3307392,21313024,12160,4294901760,21336064,21385216,21434368,21483520,771,0
.long 7639040,7643136,7647232,1884800,128,393356,65820,0,6556544,580864,0,1024,1885312,142720,0,376968
.long 584960,118784,75776,9371648,3316992,3321216,3325440,21139456,77312,4294901760,21348352,21397504,21446656,21299200,3,0
.long 7643136,7643136,7647232,1905280,136,393356,69916,0,6638464,580928,7168,1024,1905792,142724,0,381064
.long 585024,118912,75904,9433088,3318016,3322240,3326464,21140992,77440,4294901760,21409792,21458944,21311488,21360640,3,0
.long 7647232,7643136,7647232,1925760,144,393356,74012,0,6720384,580992,14336,1024,1926272,143232,0,385160
.long 585088,118784,76032,9494528,3319040,3323264,3327488,21336064,77568,4294901760,21471232,21323776,21372928,21422080,3,0
.long 7639040,7643136,7647232,1946240,152,393356,78108,0,6802304,581056,21504,1024,1946752,143236,0,389256
.long 585152,118912,76160,9555968,3320064,3324288,3328512,21337600,77696,4294901760,21336064,21385216,21434368,21483520,3,0
.long 7659520,7663616,7667712,2539520,128,393372,412,1,5246848,601344,0,1024,2540032,146560,0,376976
.long 605440,120832,14336,8388608,3338112,3342336,3346560,22687744,15872,4294901760,22921216,22970368,23019520,22872064,771,0
.long 7663616,7663616,7667712,2560000,136,393372,4508,1,5328768,601408,7168,1024,2560512,146564,0,381072
.long 605504,120960,14464,8450048,3339136,3343360,3347584,22689280,16000,4294901760,22982656,23031808,22884352,22933504,771,0
.long 7667712,7663616,7667712,2580480,144,393372,8604,1,5410688,601472,14336,1024,2580992,147072,0,385168
.long 605568,120832,14592,8511488,3340160,3344384,3348608,22884352,16128,4294901760,23044096,22896640,22945792,22994944,771,0
.long 7659520,7663616,7667712,2600960,152,393372,12700,1,5492608,601536,21504,1024,2601472,147076,0,389264
.long 605632,120960,14720,8572928,3341184,3345408,3349632,22885888,16256,4294901760,22908928,22958080,23007232,23056384,771,0
.long 7680000,7684096,7688192,2540160,160,393372,65948,0,6557568,601344,0,1152,2540672,146816,0,376984
.long 605440,120832,79872,9371648,3359232,3363456,3367680,22712320,81408,4294901760,22921216,22970368,23019520,22872064,3,0
.long 7684096,7684096,7688192,2560640,168,393372,70044,0,6639488,601408,7168,1152,2561152,146820,0,381080
.long 605504,120960,80000,9433088,3360256,3364480,3368704,22713856,81536,4294901760,22982656,23031808,22884352,22933504,3,0
.long 7688192,7684096,7688192,2581120,176,393372,74140,0,6721408,601472,14336,1152,2581632,147328,0,385176
.long 605568,120832,80128,9494528,3361280,3365504,3369728,22908928,81664,4294901760,23044096,22896640,22945792,22994944,3,0
.long 7680000,7684096,7688192,2601600,184,393372,78236,0,6803328,601536,21504,1152,2602112,147332,0,389272
.long 605632,120960,80256,9555968,3362304,3366528,3370752,22910464,81792,4294901760,22908928,22958080,23007232,23056384,3,0
.long 7548928,7553024,84836352,573568,96,393228,16412,1,5571456,539904,0,768,573984,134280,0,376836
.long 544000,114688,18432,8634368,3224064,3228288,83886080,17972224,3584,4294901760,18202624,18251776,18300928,18153472,771,0
.long 7553024,7553024,84836352,594048,104,393228,20508,1,5653376,539968,7168,768,594464,134284,0,380932
.long 544064,114816,18560,8695808,3225088,3229312,83886080,17973760,3712,4294901760,18264064,18313216,18165760,18214912,771,0
.long 84836352,7553024,84836352,614528,112,393228,24604,1,5735296,540032,14336,768,614944,134792,0,385028
.long 544128,114688,18688,8757248,3226112,3230336,83886080,18168832,3840,4294901760,18325504,18178048,18227200,18276352,771,0
.long 7548928,7553024,84836352,635008,120,393228,28700,1,5817216,540096,21504,768,635424,134796,0,389124
.long 544192,114816,18816,8818688,3227136,3231360,83886080,18170368,3968,4294901760,18190336,18239488,18288640,18337792,771,0
.long 7569408,7573504,84840448,574208,24,393484,81948,0,6882176,539904,0,896,574624,134536,0,376844
.long 544000,114688,83968,9617408,3245184,3249408,83886080,17996800,69120,4294901760,18202624,18251776,18300928,18153472,3,0
.long 7573504,7573504,84840448,594688,56,393484,86044,0,6964096,539968,7168,896,595104,134540,0,380940
.long 544064,114816,84096,9678848,3246208,3250432,83886080,17998336,69248,4294901760,18264064,18313216,18165760,18214912,3,0
.long 84840448,7573504,84840448,615168,88,393484,90140,0,7046016,540032,14336,896,615584,135048,0,385036
.long 544128,114688,84224,9740288,3247232,3251456,83886080,18193408,69376,4294901760,18325504,18178048,18227200,18276352,3,0
.long 7569408,7573504,84840448,635648,120,393484,94236,0,7127936,540096,21504,896,636064,135052,0,389132
.long 544192,114816,84352,9801728,3248256,3252480,83886080,18194944,69504,4294901760,18190336,18239488,18288640,18337792,3,0
.long 7589888,7593984,84844544,1228928,24,393500,16540,1,5572480,560384,0,896,1229344,138376,0,376852
.long 564480,116736,22528,8634368,3266304,3270528,83886080,19545088,7680,4294901760,19775488,19824640,19873792,19726336,771,0
.long 7593984,7593984,84844544,1249408,56,393500,20636,1,5654400,560448,7168,896,1249824,138380,0,380948
.long 564544,116864,22656,8695808,3267328,3271552,83886080,19546624,7808,4294901760,19836928,19886080,19738624,19787776,771,0
.long 84844544,7593984,84844544,1269888,88,393500,24732,1,5736320,560512,14336,896,1270304,138888,0,385044
.long 564608,116736,22784,8757248,3268352,3272576,83886080,19741696,7936,4294901760,19898368,19750912,19800064,19849216,771,0
.long 7589888,7593984,84844544,1290368,120,393500,28828,1,5818240,560576,21504,896,1290784,138892,0,389140
.long 564672,116864,22912,8818688,3269376,3273600,83886080,19743232,8064,4294901760,19763200,19812352,19861504,19910656,771,0
.long 7610368,7614464,84848640,1229568,128,393244,82076,0,6883200,560384,0,1024,1229984,138632,0,376860
.long 564480,116736,88064,9617408,3287424,3291648,83886080,19569664,73216,4294901760,19775488,19824640,19873792,19726336,3,0
.long 7614464,7614464,84848640,1250048,136,393244,86172,0,6965120,560448,7168,1024,1250464,138636,0,380956
.long 564544,116864,88192,9678848,3288448,3292672,83886080,19571200,73344,4294901760,19836928,19886080,19738624,19787776,3,0
.long 84848640,7614464,84848640,1270528,144,393244,90268,0,7047040,560512,14336,1024,1270944,139144,0,385052
.long 564608,116736,88320,9740288,3289472,3293696,83886080,19766272,73472,4294901760,19898368,19750912,19800064,19849216,3,0
.long 7610368,7614464,84848640,1291008,152,393244,94364,0,7128960,560576,21504,1024,1291424,139148,0,389148
.long 564672,116864,88448,9801728,3290496,3294720,83886080,19767808,73600,4294901760,19763200,19812352,19861504,19910656,3,0
.long 7630848,7634944,84852736,1884288,128,393356,16668,1,5573504,580864,0,1024,1884704,142472,0,376964
.long 584960,118784,26624,8634368,3308544,3312768,83886080,21117952,11776,4294901760,21348352,21397504,21446656,21299200,771,0
.long 7634944,7634944,84852736,1904768,136,393356,20764,1,5655424,580928,7168,1024,1905184,142476,0,381060
.long 585024,118912,26752,8695808,3309568,3313792,83886080,21119488,11904,4294901760,21409792,21458944,21311488,21360640,771,0
.long 84852736,7634944,84852736,1925248,144,393356,24860,1,5737344,580992,14336,1024,1925664,142984,0,385156
.long 585088,118784,26880,8757248,3310592,3314816,83886080,21314560,12032,4294901760,21471232,21323776,21372928,21422080,771,0
.long 7630848,7634944,84852736,1945728,152,393356,28956,1,5819264,581056,21504,1024,1946144,142988,0,389252
.long 585152,118912,27008,8818688,3311616,3315840,83886080,21316096,12160,4294901760,21336064,21385216,21434368,21483520,771,0
.long 7651328,7655424,84856832,1884928,160,393356,82204,0,6884224,580864,0,1152,1885344,142728,0,376972
.long 584960,118784,92160,9617408,3329664,3333888,83886080,21142528,77312,4294901760,21348352,21397504,21446656,21299200,3,0
.long 7655424,7655424,84856832,1905408,168,393356,86300,0,6966144,580928,7168,1152,1905824,142732,0,381068
.long 585024,118912,92288,9678848,3330688,3334912,83886080,21144064,77440,4294901760,21409792,21458944,21311488,21360640,3,0
.long 84856832,7655424,84856832,1925888,176,393356,90396,0,7048064,580992,14336,1152,1926304,143240,0,385164
.long 585088,118784,92416,9740288,3331712,3335936,83886080,21339136,77568,4294901760,21471232,21323776,21372928,21422080,3,0
.long 7651328,7655424,84856832,1946368,184,393356,94492,0,7129984,581056,21504,1152,1946784,143244,0,389260
.long 585152,118912,92544,9801728,3332736,3336960,83886080,21340672,77696,4294901760,21336064,21385216,21434368,21483520,3,0
.long 7671808,7675904,84860928,2539648,160,393372,16796,1,5574528,601344,0,1152,2540064,146568,0,376980
.long 605440,120832,30720,8634368,3350784,3355008,83886080,22690816,15872,4294901760,22921216,22970368,23019520,22872064,771,0
.long 7675904,7675904,84860928,2560128,168,393372,20892,1,5656448,601408,7168,1152,2560544,146572,0,381076
.long 605504,120960,30848,8695808,3351808,3356032,83886080,22692352,16000,4294901760,22982656,23031808,22884352,22933504,771,0
.long 84860928,7675904,84860928,2580608,176,393372,24988,1,5738368,601472,14336,1152,2581024,147080,0,385172
.long 605568,120832,30976,8757248,3352832,3357056,83886080,22887424,16128,4294901760,23044096,22896640,22945792,22994944,771,0
.long 7671808,7675904,84860928,2601088,184,393372,29084,1,5820288,601536,21504,1152,2601504,147084,0,389268
.long 605632,120960,31104,8818688,3353856,3358080,83886080,22888960,16256,4294901760,22908928,22958080,23007232,23056384,771,0
.long 7692288,7696384,84865024,2540288,192,393372,82332,0,6885248,601344,0,0,2540704,146824,0,376988
.long 605440,120832,96256,9617408,3371904,3376128,83886080,22715392,81408,4294901760,22921216,22970368,23019520,22872064,3,0
.long 7696384,7696384,84865024,2560768,200,393372,86428,0,6967168,601408,7168,0,2561184,146828,0,381084
.long 605504,120960,96384,9678848,3372928,3377152,83886080,22716928,81536,4294901760,22982656,23031808,22884352,22933504,3,0
.long 84865024,7696384,84865024,2581248,208,393372,90524,0,7049088,601472,14336,0,2581664,147336,0,385180
.long 605568,120832,96512,9740288,3373952,3378176,83886080,22912000,81664,4294901760,23044096,22896640,22945792,22994944,3,0
.long 7692288,7696384,84865024,2601728,216,393372,94620,0,7131008,601536,21504,0,2602144,147340,0,389276
.long 605632,120960,96640,9801728,3374976,3379200,83886080,22913536,81792,4294901760,22908928,22958080,23007232,23056384,3,0
.long 7700480,7704576,7708672,573696,24,393484,32796,1,5899136,539904,0,896,574016,134288,0,377088
.long 544000,122880,34816,8880128,3380352,3384576,3388800,17975296,3584,4294901760,18202624,18251776,18300928,18153472,771,0
.long 7704576,7704576,7708672,594176,56,393484,36892,1,5981056,539968,7168,896,594496,134292,0,381184
.long 544064,123008,34944,8941568,3381376,3385600,3389824,17976832,3712,4294901760,18264064,18313216,18165760,18214912,771,0
.long 7708672,7704576,7708672,614656,88,393484,40988,1,6062976,540032,14336,896,614976,134800,0,385280
.long 544128,122880,35072,9003008,3382400,3386624,3390848,18171904,3840,4294901760,18325504,18178048,18227200,18276352,771,0
.long 7700480,7704576,7708672,635136,120,393484,45084,1,6144896,540096,21504,896,635456,134804,0,389376
.long 544192,123008,35200,9064448,3383424,3387648,3391872,18173440,3968,4294901760,18190336,18239488,18288640,18337792,771,0
.long 7720960,7725056,7729152,574336,128,393228,98332,0,7209856,539904,0,1024,574656,134544,0,377096
.long 544000,122880,100352,9863168,3401472,3405696,3409920,17999872,69120,4294901760,18202624,18251776,18300928,18153472,3,0
.long 7725056,7725056,7729152,594816,136,393228,102428,0,7291776,539968,7168,1024,595136,134548,0,381192
.long 544064,123008,100480,9924608,3402496,3406720,3410944,18001408,69248,4294901760,18264064,18313216,18165760,18214912,3,0
.long 7729152,7725056,7729152,615296,144,393228,106524,0,7373696,540032,14336,1024,615616,135056,0,385288
.long 544128,122880,100608,9986048,3403520,3407744,3411968,18196480,69376,4294901760,18325504,18178048,18227200,18276352,3,0
.long 7720960,7725056,7729152,635776,152,393228,110620,0,7455616,540096,21504,1024,636096,135060,0,389384
.long 544192,123008,100736,10047488,3404544,3408768,3412992,18198016,69504,4294901760,18190336,18239488,18288640,18337792,3,0
.long 7741440,7745536,7749632,1229056,128,393244,32924,1,5900160,560384,0,1024,1229376,138384,0,377104
.long 564480,124928,38912,8880128,3422592,3426816,3431040,19548160,7680,4294901760,19775488,19824640,19873792,19726336,771,0
.long 7745536,7745536,7749632,1249536,136,393244,37020,1,5982080,560448,7168,1024,1249856,138388,0,381200
.long 564544,125056,39040,8941568,3423616,3427840,3432064,19549696,7808,4294901760,19836928,19886080,19738624,19787776,771,0
.long 7749632,7745536,7749632,1270016,144,393244,41116,1,6064000,560512,14336,1024,1270336,138896,0,385296
.long 564608,124928,39168,9003008,3424640,3428864,3433088,19744768,7936,4294901760,19898368,19750912,19800064,19849216,771,0
.long 7741440,7745536,7749632,1290496,152,393244,45212,1,6145920,560576,21504,1024,1290816,138900,0,389392
.long 564672,125056,39296,9064448,3425664,3429888,3434112,19746304,8064,4294901760,19763200,19812352,19861504,19910656,771,0
.long 7761920,7766016,7770112,1229696,160,393244,98460,0,7210880,560384,0,1152,1230016,138640,0,377112
.long 564480,124928,104448,9863168,3443712,3447936,3452160,19572736,73216,4294901760,19775488,19824640,19873792,19726336,3,0
.long 7766016,7766016,7770112,1250176,168,393244,102556,0,7292800,560448,7168,1152,1250496,138644,0,381208
.long 564544,125056,104576,9924608,3444736,3448960,3453184,19574272,73344,4294901760,19836928,19886080,19738624,19787776,3,0
.long 7770112,7766016,7770112,1270656,176,393244,106652,0,7374720,560512,14336,1152,1270976,139152,0,385304
.long 564608,124928,104704,9986048,3445760,3449984,3454208,19769344,73472,4294901760,19898368,19750912,19800064,19849216,3,0
.long 7761920,7766016,7770112,1291136,184,393244,110748,0,7456640,560576,21504,1152,1291456,139156,0,389400
.long 564672,125056,104832,10047488,3446784,3451008,3455232,19770880,73600,4294901760,19763200,19812352,19861504,19910656,3,0
.long 7782400,7786496,7790592,1884416,160,393356,33052,1,5901184,580864,0,1152,1884736,142480,0,377216
.long 584960,126976,43008,8880128,3464832,3469056,3473280,21121024,11776,4294901760,21348352,21397504,21446656,21299200,771,0
.long 7786496,7786496,7790592,1904896,168,393356,37148,1,5983104,580928,7168,1152,1905216,142484,0,381312
.long 585024,127104,43136,8941568,3465856,3470080,3474304,21122560,11904,4294901760,21409792,21458944,21311488,21360640,771,0
.long 7790592,7786496,7790592,1925376,176,393356,41244,1,6065024,580992,14336,1152,1925696,142992,0,385408
.long 585088,126976,43264,9003008,3466880,3471104,3475328,21317632,12032,4294901760,21471232,21323776,21372928,21422080,771,0
.long 7782400,7786496,7790592,1945856,184,393356,45340,1,6146944,581056,21504,1152,1946176,142996,0,389504
.long 585152,127104,43392,9064448,3467904,3472128,3476352,21319168,12160,4294901760,21336064,21385216,21434368,21483520,771,0
.long 7802880,7806976,7811072,1885056,192,393356,98588,0,7211904,580864,0,0,1885376,142736,0,377224
.long 584960,127232,108544,9863168,3688704,3692928,3697152,21145600,77312,4294901760,21348352,21397504,21446656,21299200,3,0
.long 7806976,7806976,7811072,1905536,200,393356,102684,0,7293824,580928,7168,0,1905856,142740,0,381320
.long 585024,127360,108672,9924608,3689728,3693952,3698176,21147136,77440,4294901760,21409792,21458944,21311488,21360640,3,0
.long 7811072,7806976,7811072,1926016,208,393356,106780,0,7375744,580992,14336,0,1926336,143248,0,385416
.long 585088,127232,108800,9986048,3690752,3694976,3699200,21342208,77568,4294901760,21471232,21323776,21372928,21422080,3,0
.long 7802880,7806976,7811072,1946496,216,393356,110876,0,7457664,581056,21504,0,1946816,143252,0,389512
.long 585152,127360,108928,10047488,3691776,3696000,3700224,21343744,77696,4294901760,21336064,21385216,21434368,21483520,3,0
.long 7823360,7827456,7831552,2539776,192,393372,33180,1,5902208,601344,0,0,2540096,146576,0,377232
.long 605440,129280,47104,8880128,3709824,3714048,3718272,22693888,15872,4294901760,22921216,22970368,23019520,22872064,771,0
.long 7827456,7827456,7831552,2560256,200,393372,37276,1,5984128,601408,7168,0,2560576,146580,0,381328
.long 605504,129408,47232,8941568,3710848,3715072,3719296,22695424,16000,4294901760,22982656,23031808,22884352,22933504,771,0
.long 7831552,7827456,7831552,2580736,208,393372,41372,1,6066048,601472,14336,0,2581056,147088,0,385424
.long 605568,129280,47360,9003008,3711872,3716096,3720320,22890496,16128,4294901760,23044096,22896640,22945792,22994944,771,0
.long 7823360,7827456,7831552,2601216,216,393372,45468,1,6147968,601536,21504,0,2601536,147092,0,389520
.long 605632,129408,47488,9064448,3712896,3717120,3721344,22892032,16256,4294901760,22908928,22958080,23007232,23056384,771,0
.long 7843840,7847936,7852032,2540416,224,393372,98716,0,7212928,601344,0,128,2540736,146832,0,377240
.long 605440,129280,112640,9863168,3730944,3735168,3739392,22718464,81408,4294901760,22921216,22970368,23019520,22872064,3,0
.long 7847936,7847936,7852032,2560896,232,393372,102812,0,7294848,601408,7168,128,2561216,146836,0,381336
.long 605504,129408,112768,9924608,3731968,3736192,3740416,22720000,81536,4294901760,22982656,23031808,22884352,22933504,3,0
.long 7852032,7847936,7852032,2581376,240,393372,106908,0,7376768,601472,14336,128,2581696,147344,0,385432
.long 605568,129280,112896,9986048,3732992,3737216,3741440,22915072,81664,4294901760,23044096,22896640,22945792,22994944,3,0
.long 7843840,7847936,7852032,2601856,248,393372,111004,0,7458688,601536,21504,128,2602176,147348,0,389528
.long 605632,129408,113024,10047488,3734016,3738240,3742464,22916608,81792,4294901760,22908928,22958080,23007232,23056384,3,0
.long 7712768,7716864,84901888,573824,128,393228,49180,1,6226816,539904,0,1024,574048,134296,0,377092
.long 544000,122880,51200,9125888,3393024,3397248,83886080,17978368,3584,4294901760,18202624,18251776,18300928,18153472,771,0
.long 7716864,7716864,84901888,594304,136,393228,53276,1,6308736,539968,7168,1024,594528,134300,0,381188
.long 544064,123008,51328,9187328,3394048,3398272,83886080,17979904,3712,4294901760,18264064,18313216,18165760,18214912,771,0
.long 84901888,7716864,84901888,614784,144,393228,57372,1,6390656,540032,14336,1024,615008,134808,0,385284
.long 544128,122880,51456,9248768,3395072,3399296,83886080,18174976,3840,4294901760,18325504,18178048,18227200,18276352,771,0
.long 7712768,7716864,84901888,635264,152,393228,61468,1,6472576,540096,21504,1024,635488,134812,0,389380
.long 544192,123008,51584,9310208,3396096,3400320,83886080,18176512,3968,4294901760,18190336,18239488,18288640,18337792,771,0
.long 7733248,7737344,84905984,574464,160,393228,114716,1,7537536,539904,0,1152,574688,134552,0,377100
.long 544000,122880,116736,10108928,3414144,3418368,83886080,18002944,69120,4294901760,18202624,18251776,18300928,18153472,771,0
.long 7737344,7737344,84905984,594944,168,393228,118812,1,7619456,539968,7168,1152,595168,134556,0,381196
.long 544064,123008,116864,10170368,3415168,3419392,83886080,18004480,69248,4294901760,18264064,18313216,18165760,18214912,771,0
.long 84905984,7737344,84905984,615424,176,393228,122908,1,7701376,540032,14336,1152,615648,135064,0,385292
.long 544128,122880,116992,10231808,3416192,3420416,83886080,18199552,69376,4294901760,18325504,18178048,18227200,18276352,771,0
.long 7733248,7737344,84905984,635904,184,393228,127004,1,7783296,540096,21504,1152,636128,135068,0,389388
.long 544192,123008,117120,10293248,3417216,3421440,83886080,18201088,69504,4294901760,18190336,18239488,18288640,18337792,771,0
.long 7753728,7757824,84910080,1229184,160,393244,49308,1,6227840,560384,0,1152,1229408,138392,0,377108
.long 564480,124928,55296,9125888,3435264,3439488,83886080,19551232,7680,4294901760,19775488,19824640,19873792,19726336,771,0
.long 7757824,7757824,84910080,1249664,168,393244,53404,1,6309760,560448,7168,1152,1249888,138396,0,381204
.long 564544,125056,55424,9187328,3436288,3440512,83886080,19552768,7808,4294901760,19836928,19886080,19738624,19787776,771,0
.long 84910080,7757824,84910080,1270144,176,393244,57500,1,6391680,560512,14336,1152,1270368,138904,0,385300
.long 564608,124928,55552,9248768,3437312,3441536,83886080,19747840,7936,4294901760,19898368,19750912,19800064,19849216,771,0
.long 7753728,7757824,84910080,1290624,184,393244,61596,1,6473600,560576,21504,1152,1290848,138908,0,389396
.long 564672,125056,55680,9310208,3438336,3442560,83886080,19749376,8064,4294901760,19763200,19812352,19861504,19910656,771,0
.long 7774208,7778304,84914176,1229824,192,393244,114844,1,7538560,560384,0,0,1230048,138648,0,377116
.long 564480,124928,120832,10108928,3456384,3460608,83886080,19575808,73216,4294901760,19775488,19824640,19873792,19726336,771,0
.long 7778304,7778304,84914176,1250304,200,393244,118940,1,7620480,560448,7168,0,1250528,138652,0,381212
.long 564544,125056,120960,10170368,3457408,3461632,83886080,19577344,73344,4294901760,19836928,19886080,19738624,19787776,771,0
.long 84914176,7778304,84914176,1270784,208,393244,123036,1,7702400,560512,14336,0,1271008,139160,0,385308
.long 564608,124928,121088,10231808,3458432,3462656,83886080,19772416,73472,4294901760,19898368,19750912,19800064,19849216,771,0
.long 7774208,7778304,84914176,1291264,216,393244,127132,1,7784320,560576,21504,0,1291488,139164,0,389404
.long 564672,125056,121216,10293248,3459456,3463680,83886080,19773952,73600,4294901760,19763200,19812352,19861504,19910656,771,0
.long 7794688,7798784,84918272,1884544,192,393356,49436,1,6228864,580864,0,0,1884768,142488,0,377220
.long 584960,126976,59392,9125888,3477504,3684480,83886080,21124096,11776,4294901760,21348352,21397504,21446656,21299200,771,0
.long 7798784,7798784,84918272,1905024,200,393356,53532,1,6310784,580928,7168,0,1905248,142492,0,381316
.long 585024,127104,59520,9187328,3478528,3685504,83886080,21125632,11904,4294901760,21409792,21458944,21311488,21360640,771,0
.long 84918272,7798784,84918272,1925504,208,393356,57628,1,6392704,580992,14336,0,1925728,143000,0,385412
.long 585088,127232,59648,9248768,3479552,3686528,83886080,21320704,12032,4294901760,21471232,21323776,21372928,21422080,771,0
.long 7794688,7798784,84918272,1945984,216,393356,61724,1,6474624,581056,21504,0,1946208,143004,0,389508
.long 585152,127360,59776,9310208,3480576,3687552,83886080,21322240,12160,4294901760,21336064,21385216,21434368,21483520,771,0
.long 7815168,7819264,84922368,1885184,224,393356,114972,1,7539584,580864,0,128,1885408,142744,0,377228
.long 584960,127232,124928,10108928,3701376,3705600,83886080,21148672,77312,4294901760,21348352,21397504,21446656,21299200,771,0
.long 7819264,7819264,84922368,1905664,232,393356,119068,1,7621504,580928,7168,128,1905888,142748,0,381324
.long 585024,127360,125056,10170368,3702400,3706624,83886080,21150208,77440,4294901760,21409792,21458944,21311488,21360640,771,0
.long 84922368,7819264,84922368,1926144,240,393356,123164,1,7703424,580992,14336,128,1926368,143256,0,385420
.long 585088,127232,125184,10231808,3703424,3707648,83886080,21345280,77568,4294901760,21471232,21323776,21372928,21422080,771,0
.long 7815168,7819264,84922368,1946624,248,393356,127260,1,7785344,581056,21504,128,1946848,143260,0,389516
.long 585152,127360,125312,10293248,3704448,3708672,83886080,21346816,77696,4294901760,21336064,21385216,21434368,21483520,771,0
.long 7835648,7839744,84926464,2539904,224,393372,49564,1,6229888,601344,0,128,2540128,146584,0,377236
.long 605440,129280,63488,9125888,3722496,3726720,83886080,22696960,15872,4294901760,22921216,22970368,23019520,22872064,771,0
.long 7839744,7839744,84926464,2560384,232,393372,53660,1,6311808,601408,7168,128,2560608,146588,0,381332
.long 605504,129408,63616,9187328,3723520,3727744,83886080,22698496,16000,4294901760,22982656,23031808,22884352,22933504,771,0
.long 84926464,7839744,84926464,2580864,240,393372,57756,1,6393728,601472,14336,128,2581088,147096,0,385428
.long 605568,129280,63744,9248768,3724544,3728768,83886080,22893568,16128,4294901760,23044096,22896640,22945792,22994944,771,0
.long 7835648,7839744,84926464,2601344,248,393372,61852,1,6475648,601536,21504,128,2601568,147100,0,389524
.long 605632,129408,63872,9310208,3725568,3729792,83886080,22895104,16256,4294901760,22908928,22958080,23007232,23056384,771,0
.long 7856128,7860224,84930560,2540544,152,393628,115100,1,7540608,601344,0,256,2540768,146840,0,377244
.long 605440,129280,129024,10108928,3743616,3747840,83886080,22721536,81408,4294901760,22921216,22970368,23019520,22872064,771,0
.long 7860224,7860224,84930560,2561024,184,393628,119196,1,7622528,601408,7168,256,2561248,146844,0,381340
.long 605504,129408,129152,10170368,3744640,3748864,83886080,22723072,81536,4294901760,22982656,23031808,22884352,22933504,771,0
.long 84930560,7860224,84930560,2581504,216,393628,123292,1,7704448,601472,14336,256,2581728,147352,0,385436
.long 605568,129280,129280,10231808,3745664,3749888,83886080,22918144,81664,4294901760,23044096,22896640,22945792,22994944,771,0
.long 7856128,7860224,84930560,2601984,248,393628,127388,1,7786368,601536,21504,256,2602208,147356,0,389532
.long 605632,129408,129408,10293248,3746688,3750912,83886080,22919680,81792,4294901760,22908928,22958080,23007232,23056384,771,0
.size L_stab, 131072
.section .rodata,"a"
.p2align 6
.amdhsa_kernel gated_mix__ssm_conv_s4__dense_activation_silu__prompt_kernel
.amdhsa_next_free_vgpr 512
.amdhsa_next_free_sgpr 102
.amdhsa_accum_offset 256
.amdhsa_group_segment_fixed_size 0
.amdhsa_kernarg_size 128
.amdhsa_user_sgpr_count 2
.amdhsa_user_sgpr_kernarg_segment_ptr 1
.amdhsa_system_sgpr_workgroup_id_x 1
.end_amdhsa_kernel
```
